```python
import torch

def _softmax(x, axis=-1):
    return torch.softmax(x, dim=axis)
def _gelu(x):
    return torch.nn.functional.gelu(x, approximate="tanh")
def _silu(x):
    return torch.nn.functional.silu(x)
def _sigmoid(x):
    return torch.sigmoid(x)
def _layernorm(x, axis=-1, eps=1e-5):
    m = x.mean(dim=axis, keepdim=True)
    v = x.var(dim=axis, keepdim=True, unbiased=False)
    return (x - m) / torch.sqrt(v + eps)
def _scatter_add(tgt, idx, src, axis=0):
    return tgt.clone().index_add_(axis, idx, src)
def _segment_sum(src, seg, n):
    out = torch.zeros((n,) + src.shape[1:], dtype=src.dtype)
    return out.index_add_(0, seg, src)
def _pad(x, pw):
    flat = tuple(v for pair in reversed(pw) for v in pair)
    return torch.nn.functional.pad(x, flat)

kernel_name = 'gated_mix__ssm_conv_s5__glu_gated_swiglu__prompt'

def setup_inputs():

    _w = (lambda a: (lambda t: t.to(torch.bfloat16) if t.is_floating_point() else t)(torch.as_tensor(a)))
    def _A_setup():
        B, S, D = 1, 2048, 640
        P = D
        Lambda_re = -0.5 * (lambda _x: torch.exp(torch.as_tensor(_x)))((lambda *s: torch.randn(*s, dtype=torch.bfloat16) * 0.2)(P))
        Lambda_im = (lambda *s: torch.randn(*s, dtype=torch.bfloat16) * 0.4)(P) * 1.0
        B_re = (lambda *s: torch.randn(*s, dtype=torch.bfloat16) * 0.2)(P, D) * (D ** -0.5)
        B_im = (lambda *s: torch.randn(*s, dtype=torch.bfloat16) * 0.2)(P, D) * (D ** -0.5)
        C_re = (lambda *s: torch.randn(*s, dtype=torch.bfloat16) * 0.2)(D, P) * (P ** -0.5)
        C_im = (lambda *s: torch.randn(*s, dtype=torch.bfloat16) * 0.2)(D, P) * (P ** -0.5)
        log_dt = (lambda *s: torch.randn(*s, dtype=torch.bfloat16) * 0.2)(P) * 0.3 - 2.0
        Dskip = (lambda *s: torch.randn(*s, dtype=torch.bfloat16) * 0.05)(D)
        return {
            "x": _w((lambda *s: torch.randn(*s, dtype=torch.bfloat16) * 0.05)(B, S, D)),
            "Lambda_re": _w(Lambda_re),
            "Lambda_im": _w(Lambda_im),
            "B_re": _w(B_re),
            "B_im": _w(B_im),
            "C_re": _w(C_re),
            "C_im": _w(C_im),
            "log_dt": _w(log_dt),
            "Dskip": _w(Dskip),
        }
    _A_in = _A_setup()

    def _B_setup():
        B, S, D, F = 1, 2048, 640, 1728
        return {
            "x": _w((lambda *s: torch.randn(*s, dtype=torch.bfloat16) * 0.05)(B, S, D)),
            "w1": _w((lambda *s: torch.randn(*s, dtype=torch.bfloat16) * 0.8)(D, F) * (2.0 / D) ** 0.5),
            "w3": _w((lambda *s: torch.randn(*s, dtype=torch.bfloat16) * 0.8)(D, F) * (2.0 / D) ** 0.5),
            "w2": _w((lambda *s: torch.randn(*s, dtype=torch.bfloat16) * 0.8)(F, D) * (2.0 / F) ** 0.5),
        }
    _B_in = _B_setup()

    return {
        "A_x": _A_in["x"],
        "A_Lambda_re": _A_in["Lambda_re"],
        "A_Lambda_im": _A_in["Lambda_im"],
        "A_B_re": _A_in["B_re"],
        "A_B_im": _A_in["B_im"],
        "A_C_re": _A_in["C_re"],
        "A_C_im": _A_in["C_im"],
        "A_log_dt": _A_in["log_dt"],
        "A_Dskip": _A_in["Dskip"],
        "B_x": _B_in["x"],
        "B_w1": _B_in["w1"],
        "B_w3": _B_in["w3"],
        "B_w2": _B_in["w2"],
        "gate_w": _w((lambda *s: torch.randn(*s, dtype=torch.bfloat16) * 0.05)(640) * 16.0),
    }

def reference(A_x, A_Lambda_re, A_Lambda_im, A_B_re, A_B_im, A_C_re, A_C_im, A_log_dt, A_Dskip, B_x, B_w1, B_w3, B_w2, gate_w):
    def _A_ref(x, Lambda_re, Lambda_im, B_re, B_im, C_re, C_im, log_dt, Dskip):
        Bsz, L, H = x.shape
        Lam = Lambda_re + 1j * Lambda_im
        Bmat = B_re + 1j * B_im
        Cmat = C_re + 1j * C_im
        dt = torch.exp(log_dt)
        Lam_bar = torch.exp(dt * Lam)
        B_bar = ((Lam_bar - 1.0) / Lam)[:, None] * Bmat
        Bu = torch.einsum("bld,pd->blp", x + 0j, B_bar)
        h = torch.zeros_like(Bu[:, 0, :])
        hs = []
        for t in range(L):
            h = Lam_bar[None, :] * h + Bu[:, t, :]
            hs.append(h)
        hseq = torch.stack(hs, 1)
        y = 2.0 * torch.einsum("blp,dp->bld", hseq, Cmat).real + x * Dskip[None, None, :]
        return y

    def _B_ref(x, w1, w3, w2):
        gate = torch.einsum("bsd,df->bsf", x, w1)
        up = torch.einsum("bsd,df->bsf", x, w3)
        h = _silu(gate) * up
        out = torch.einsum("bsf,fd->bsd", h, w2)
        return out

    x = A_x
    g = _sigmoid((x * gate_w).sum(-1, keepdims=True))
    a = _A_ref(x, A_Lambda_re, A_Lambda_im, A_B_re, A_B_im, A_C_re, A_C_im, A_log_dt, A_Dskip)
    b = _B_ref(x, B_w1, B_w3, B_w2)
    return g * a + (1 - g) * b
```

```asm
; @launch grid=(256,1,1) block=(256,1,1) lds=163840
.amdgcn_target "amdgcn-amd-amdhsa--gfx950"
.text
.globl gated_mix__ssm_conv_s5__glu_gated_swiglu__prompt_kernel
.p2align 8
.type gated_mix__ssm_conv_s5__glu_gated_swiglu__prompt_kernel,@function
gated_mix__ssm_conv_s5__glu_gated_swiglu__prompt_kernel:
    s_cmp_ge_u32 s2, 256
    s_cbranch_scc1 L_end
    s_load_dwordx16 s[64:79], s[0:1], 0
    s_load_dwordx16 s[80:95], s[0:1], 64
    s_load_dwordx2 s[96:97], s[0:1], 128
    s_memrealtime s[98:99]
    s_getpc_b64 s[44:45]
L_pc:
    s_sub_u32 s44, s44, L_pc-gated_mix__ssm_conv_s5__glu_gated_swiglu__prompt_kernel
    s_subb_u32 s45, s45, 0
    s_lshr_b32 s3, s2, 3
    v_lshrrev_b32 v94, 4, v0
    v_lshl_add_u32 v94, v94, 5, s3
    v_lshlrev_b32 v94, 7, v94
    v_min_u32 v94, L_codeend-gated_mix__ssm_conv_s5__glu_gated_swiglu__prompt_kernel, v94
    global_load_dword v95, v94, s[44:45]
    v_lshrrev_b32 v2, 6, v0
    v_and_b32 v1, 63, v0
    s_bfe_u32 s52, s2, 0x20003
    v_readfirstlane_b32 s4, v2
    s_and_b32 s5, s2, 1
    s_lshl_b32 s5, s5, 2
    s_add_u32 s5, s5, s52
    s_lshr_b32 s49, s2, 5
    s_add_u32 s3, s52, s49
    s_and_b32 s53, s3, 1
    s_mul_i32 s60, s53, 640
    s_lshl_b32 s57, s4, 14
    v_and_b32 v25, 7, v1
    v_lshrrev_b32 v26, 4, v1
    v_xor_b32 v25, v25, v26
    v_and_b32 v24, 0xe0, v0
    v_bfe_u32 v26, v1, 3, 2
    s_lshl_b32 s3, s5, 8
    v_add3_u32 v24, v24, v26, s3
    v_mul_u32_u24 v24, 1280, v24
    v_lshl_add_u32 v2, v25, 4, v24
    v_xor_b32 v27, 64, v2
    s_mov_b32 m0, s57
    s_mov_b32 s10, 2621440
    s_mov_b32 s11, 0x20000
    v_add_u32 v3, 4096, v27
    s_waitcnt lgkmcnt(0)
    s_mov_b64 s[8:9], s[64:65]
    v_add_u32 v4, 8192, v2
    buffer_load_dwordx4 v2, s[8:11], s60 offen lds
    v_add_u32 v5, 12288, v27
    buffer_load_dwordx4 v3, s[8:11], s60 offen offset:1024 lds
    v_add_u32 v6, 20480, v2
    buffer_load_dwordx4 v4, s[8:11], s60 offen offset:2048 lds
    v_add_u32 v7, 24576, v27
    buffer_load_dwordx4 v5, s[8:11], s60 offen offset:3072 lds
    s_add_u32 m0, s57, 4096
    v_add_u32 v8, 28672, v2
    buffer_load_dwordx4 v6, s[8:11], s60 offen lds
    v_add_u32 v9, 32768, v27
    buffer_load_dwordx4 v7, s[8:11], s60 offen offset:1024 lds
    buffer_load_dwordx4 v8, s[8:11], s60 offen offset:2048 lds
    buffer_load_dwordx4 v9, s[8:11], s60 offen offset:3072 lds
    s_mul_i32 s61, s53, 1105920
    s_bfe_u32 s6, s2, 0x20001
    s_lshl_b32 s53, s49, 2
    s_add_u32 s6, s6, s53
    s_mul_i32 s54, s6, 3
    s_sub_u32 s54, s54, 54
    s_cmp_lt_u32 s6, 27
    s_cselect_b32 s54, s6, s54
    s_and_b32 s3, s4, 1
    s_lshl_b32 s7, s3, 3
    s_lshl_b32 s58, s54, 4
    s_add_u32 s7, s7, s58
    v_lshrrev_b32 v24, 3, v1
    v_add_u32 v26, s7, v24
    v_mul_u32_u24 v26, 1280, v26
    s_lshl_b32 s3, s3, 2
    v_xor_b32 v27, s3, v25
    v_lshl_add_u32 v12, v27, 4, v26
    s_cmp_ge_u32 s6, 27
    s_cbranch_scc1 L_classB
    s_lshl_b32 s3, s4, 4
    v_lshrrev_b32 v24, 2, v1
    v_add_u32 v24, s3, v24
    v_mul_u32_u24 v24, 3456, v24
    v_and_b32 v27, 3, v1
    v_lshl_add_u32 v24, v27, 4, v24
    s_lshl_b32 s3, s6, 7
    v_add_u32 v10, s3, v24
    v_add_u32 v11, 64, v10
    s_lshl_b32 s59, s4, 10
    s_add_u32 s59, s59, 65536
    s_lshl_b32 s58, s4, 12
    s_add_u32 s58, s58, 118784
    s_waitcnt lgkmcnt(0)
    s_mov_b32 s12, s84
    s_mov_b32 s13, s85
    s_mov_b32 s14, 2211840
    s_mov_b32 s15, 0x20000
    s_mov_b32 s16, s86
    s_mov_b32 s17, s87
    s_mov_b32 s18, 2211840
    s_mov_b32 s19, 0x20000
    s_cmp_lt_u32 s4, 2
    s_cselect_b32 s20, s70, s72
    s_cselect_b32 s21, s71, s73
    s_mov_b32 s22, 819200
    s_mov_b32 s23, 0x20000
    s_add_u32 m0, s59, 0
    s_nop 0
    buffer_load_dwordx4 v10, s[12:15], s61 offen lds
    s_add_u32 m0, s59, 69632
    s_nop 0
    buffer_load_dwordx4 v11, s[12:15], s61 offen lds
    s_add_u32 m0, s59, 4096
    s_nop 0
    buffer_load_dwordx4 v10, s[16:19], s61 offen lds
    s_add_u32 m0, s59, 73728
    s_nop 0
    buffer_load_dwordx4 v11, s[16:19], s61 offen lds
    s_add_u32 m0, s59, 8192
    s_nop 0
    buffer_load_dwordx4 v12, s[20:23], s60 offen lds
    s_add_u32 s60, s60, 128
    s_add_u32 s61, s61, 221184
    s_mov_b32 s32, s96
    s_mov_b32 s33, s97
    s_mov_b32 s34, 268435456
    s_mov_b32 s35, 0x20000
    s_mov_b32 s40, s94
    s_mov_b32 s41, s95
    s_mov_b32 s42, 256
    s_mov_b32 s43, 0x20000
    s_mov_b32 s64, s92
    s_mov_b32 s65, s93
    v_and_b32 v24, 31, v1
    v_lshrrev_b32 v25, 5, v1
    v_bfe_u32 v26, v1, 1, 3
    v_xor_b32 v25, v25, v26
    v_lshlrev_b32 v24, 7, v24
    v_xor_b32 v26, 0, v25
    v_lshl_add_u32 v26, v26, 4, v24
    v_add_u32 v13, s57, v26
    v_add_u32 v17, 65536, v26
    v_xor_b32 v26, 2, v25
    v_lshl_add_u32 v26, v26, 4, v24
    v_add_u32 v14, s57, v26
    v_add_u32 v18, 65536, v26
    v_xor_b32 v26, 4, v25
    v_lshl_add_u32 v26, v26, 4, v24
    v_add_u32 v15, s57, v26
    v_add_u32 v19, 65536, v26
    v_xor_b32 v26, 6, v25
    v_lshl_add_u32 v26, v26, 4, v24
    v_add_u32 v16, s57, v26
    v_add_u32 v20, 65536, v26
    v_lshrrev_b32 v24, 5, v1
    v_lshlrev_b32 v24, 3, v24
    v_bfe_u32 v25, v1, 2, 2
    v_add_u32 v24, v24, v25
    v_lshlrev_b32 v24, 6, v24
    v_bfe_u32 v25, v1, 4, 1
    v_lshl_add_u32 v24, v25, 5, v24
    v_and_b32 v25, 3, v1
    v_lshl_add_u32 v24, v25, 3, v24
    v_add_u32 v21, 65536, v24
    v_add_u32 v22, 102400, v24
    s_mov_b32 s48, s2
    s_mul_i32 s95, s48, 293
    s_lshr_b32 s95, s95, 12
    s_mul_i32 s3, s95, 14
    s_sub_u32 s3, s48, s3
    s_lshl_b32 s56, s3, 2
    s_add_u32 s56, s56, s4
    s_cmp_lt_u32 s48, 252
    s_cselect_b32 s55, 0, 2130706432
    s_cselect_b32 s95, s95, 0
    s_cmp_lt_u32 s95, 10
    s_cselect_b32 s62, 1, 0
    s_cselect_b32 s24, s88, s74
    s_cselect_b32 s25, s89, s75
    s_cselect_b32 s28, s88, s76
    s_cselect_b32 s29, s89, s77
    s_mov_b32 s26, 819200
    s_cmov_b32 s26, 2211840
    s_mov_b32 s53, 0
    s_cmov_b32 s53, 20480
    s_mov_b32 s85, 40960
    s_cmov_b32 s85, 1024
    s_mov_b32 s30, s26
    s_mov_b32 s27, 0x20000
    s_mov_b32 s31, 0x20000
    v_lshrrev_b32 v31, 3, v1
    v_mul_u32_u24 v31, 1280, v31
    v_and_b32 v29, 7, v1
    v_lshl_add_u32 v31, v29, 4, v31
    v_lshlrev_b32 v33, 4, v1
    s_add_u32 s3, s56, 0
    s_mul_i32 s7, s3, 26
    s_lshr_b32 s7, s7, 8
    s_mul_i32 s92, s7, 10
    s_sub_u32 s92, s3, s92
    s_sub_u32 s93, s95, 10
    s_mul_i32 s93, s93, 5
    s_add_u32 s7, s7, s93
    s_mul_i32 s84, s92, 163840
    s_lshl_b32 s93, s7, 10
    s_add_u32 s84, s84, s93
    s_add_u32 s84, s84, 14794752
    s_mul_i32 s52, s7, 20480
    s_lshl_b32 s92, s92, 7
    s_add_u32 s52, s52, s92
    s_mul_i32 s7, s3, 40960
    s_lshl_b32 s92, s95, 7
    s_add_u32 s7, s7, s92
    s_lshr_b32 s92, s3, 1
    s_and_b32 s93, s3, 1
    s_mul_i32 s93, s93, 27
    s_add_u32 s92, s92, s93
    s_mul_i32 s92, s92, 40960
    s_lshl_b32 s93, s95, 12
    s_add_u32 s92, s92, s93
    s_add_u32 s92, s92, 12582912
    s_cmp_eq_u32 s62, 1
    s_cmov_b32 s52, s7
    s_cmov_b32 s84, s92
    s_cselect_b32 s7, 54, 50
    s_cmp_lt_u32 s3, s7
    s_cselect_b32 s3, s55, 2130706432
    s_cselect_b32 s52, s52, 0
    v_or_b32 v28, s3, v31
    v_or_b32 v38, s3, v33
    v_lshrrev_b32 v33, 5, v1
    v_lshlrev_b32 v33, 4, v33
    v_bfe_u32 v30, v1, 2, 3
    v_add_u32 v30, v33, v30
    v_and_b32 v32, 3, v1
    v_lshlrev_b32 v32, 3, v32
    v_add_u32 v32, s58, v32
    v_lshl_add_u32 v30, v30, 7, v32
    v_and_b32 v32, 15, v1
    v_add_u32 v32, v33, v32
    v_lshlrev_b32 v32, 7, v32
    v_bfe_u32 v33, v1, 4, 1
    v_lshl_add_u32 v32, v33, 4, v32
    v_add_u32 v32, s58, v32
    s_bfe_u32 s83, s2, 0x10002
    s_and_b32 s82, s2, 1
    s_lshl_b32 s82, s82, 1
    s_bfe_u32 s3, s2, 0x10001
    s_add_u32 s82, s82, s3
    s_lshl_b32 s82, s82, 2
    s_bfe_u32 s3, s2, 0x20003
    s_add_u32 s82, s82, s3
    s_lshl_b32 s82, s82, 1
    s_add_u32 s82, s82, s83
    s_mul_i32 s88, s83, 1638400
    s_add_u32 s88, s88, 13156352
    s_cmp_lt_u32 s4, 2
    s_cselect_b32 s63, 0, 2130706432
    s_cmp_ge_u32 s2, 8
    s_cbranch_scc1 L_noelect_1
    s_cmp_lg_u32 s4, 0
    s_cbranch_scc1 L_noelect_1
    s_or_b32 s98, s98, 1
    v_mov_b32 v24, s98
    v_mov_b32 v25, s99
    v_mov_b32 v26, 0
    v_mov_b32 v27, 0
    s_mov_b64 exec, 1
    buffer_atomic_cmpswap_x2 v[24:27], v26, s[40:43], 0 offen sc1
    s_mov_b64 exec, -1
    s_nop 1
L_noelect_1:
    s_add_u32 m0, s59, 12288
    s_nop 0
    buffer_load_dwordx4 v10, s[12:15], s61 offen lds
    s_add_u32 m0, s59, 77824
    s_nop 0
    buffer_load_dwordx4 v11, s[12:15], s61 offen lds
    s_add_u32 m0, s59, 16384
    s_nop 0
    buffer_load_dwordx4 v10, s[16:19], s61 offen lds
    s_add_u32 m0, s59, 81920
    s_nop 0
    buffer_load_dwordx4 v11, s[16:19], s61 offen lds
    s_add_u32 m0, s59, 20480
    s_nop 0
    buffer_load_dwordx4 v12, s[20:23], s60 offen lds
    s_add_u32 m0, s57, 8192
    s_nop 0
    buffer_load_dwordx4 v2, s[8:11], s60 offen lds
    buffer_load_dwordx4 v3, s[8:11], s60 offen offset:1024 lds
    buffer_load_dwordx4 v4, s[8:11], s60 offen offset:2048 lds
    buffer_load_dwordx4 v5, s[8:11], s60 offen offset:3072 lds
    s_add_u32 m0, s57, 12288
    s_nop 0
    buffer_load_dwordx4 v6, s[8:11], s60 offen lds
    buffer_load_dwordx4 v7, s[8:11], s60 offen offset:1024 lds
    buffer_load_dwordx4 v8, s[8:11], s60 offen offset:2048 lds
    buffer_load_dwordx4 v9, s[8:11], s60 offen offset:3072 lds
    s_add_u32 s60, s60, 128
    s_add_u32 s61, s61, 221184
    s_waitcnt vmcnt(13)
    s_barrier
    ds_read_b128 a[160:163], v13 offset:0
    ds_read_b128 a[164:167], v13 offset:4096
    ds_read_b64_tr_b16 v[40:41], v21 offset:0
    ds_read_b64_tr_b16 v[42:43], v21 offset:256
    ds_read_b64_tr_b16 v[44:45], v21 offset:4096
    ds_read_b64_tr_b16 v[46:47], v21 offset:4352
    ds_read_b128 v[48:51], v17 offset:8192
    ds_read_b64_tr_b16 v[52:53], v22 offset:32768
    ds_read_b64_tr_b16 v[54:55], v22 offset:33024
    ds_read_b64_tr_b16 v[56:57], v22 offset:36864
    ds_read_b64_tr_b16 v[58:59], v22 offset:37120
    ds_read_b128 a[168:171], v14 offset:0
    ds_read_b128 a[172:175], v14 offset:4096
    s_waitcnt lgkmcnt(11)
    s_waitcnt lgkmcnt(9)
    v_mfma_f32_32x32x16_bf16 v[96:111], v[40:43], a[160:163], 0
    ds_read_b64_tr_b16 v[60:61], v21 offset:1024
    ds_read_b64_tr_b16 v[62:63], v21 offset:1280
    v_mfma_f32_32x32x16_bf16 v[112:127], v[40:43], a[164:167], 0
    ds_read_b64_tr_b16 v[64:65], v21 offset:5120
    ds_read_b64_tr_b16 v[66:67], v21 offset:5376
    s_add_u32 m0, s59, 24576
    s_nop 0
    buffer_load_dwordx4 v10, s[12:15], s61 offen lds
    s_waitcnt lgkmcnt(11)
    v_mfma_f32_32x32x16_bf16 v[128:143], v[44:47], a[160:163], 0
    ds_read_b128 v[68:71], v18 offset:8192
    ds_read_b64_tr_b16 v[72:73], v22 offset:33792
    v_mfma_f32_32x32x16_bf16 v[144:159], v[44:47], a[164:167], 0
    ds_read_b64_tr_b16 v[74:75], v22 offset:34048
    ds_read_b64_tr_b16 v[76:77], v22 offset:37888
    s_add_u32 m0, s59, 86016
    s_nop 0
    buffer_load_dwordx4 v11, s[12:15], s61 offen lds
    s_waitcnt lgkmcnt(14)
    v_mfma_f32_32x32x16_bf16 v[160:175], a[160:163], v[48:51], 0
    ds_read_b64_tr_b16 v[78:79], v22 offset:38144
    ds_read_b128 a[176:179], v15 offset:0
    v_mfma_f32_32x32x16_bf16 v[176:191], a[164:167], v[48:51], 0
    ds_read_b128 a[180:183], v15 offset:4096
    ds_read_b128 a[184:187], v16 offset:0
    s_add_u32 m0, s59, 28672
    s_nop 0
    buffer_load_dwordx4 v10, s[16:19], s61 offen lds
    s_waitcnt lgkmcnt(15)
    v_mfma_f32_32x32x16_bf16 v[192:207], v[52:55], a[160:163], 0
    ds_read_b128 a[188:191], v16 offset:4096
    v_mfma_f32_32x32x16_bf16 v[208:223], v[52:55], a[164:167], 0
    s_add_u32 m0, s59, 90112
    s_nop 0
    buffer_load_dwordx4 v11, s[16:19], s61 offen lds
    s_waitcnt lgkmcnt(15)
    v_mfma_f32_32x32x16_bf16 v[224:239], v[56:59], a[160:163], 0
    v_mfma_f32_32x32x16_bf16 v[240:255], v[56:59], a[164:167], 0
    s_add_u32 m0, s59, 32768
    s_nop 0
    buffer_load_dwordx4 v12, s[20:23], s60 offen lds
    s_waitcnt lgkmcnt(13)
    s_waitcnt lgkmcnt(11)
    v_mfma_f32_32x32x16_bf16 v[96:111], v[60:63], a[168:171], v[96:111]
    ds_read_b64_tr_b16 v[40:41], v21 offset:2048
    ds_read_b64_tr_b16 v[42:43], v21 offset:2304
    v_mfma_f32_32x32x16_bf16 v[112:127], v[60:63], a[172:175], v[112:127]
    ds_read_b64_tr_b16 v[44:45], v21 offset:6144
    ds_read_b64_tr_b16 v[46:47], v21 offset:6400
    s_waitcnt lgkmcnt(4)
    s_add_u32 m0, s57, 0
    s_nop 0
    buffer_load_dwordx4 v2, s[8:11], s60 offen lds
    v_mfma_f32_32x32x16_bf16 v[128:143], v[64:67], a[168:171], v[128:143]
    ds_read_b128 v[48:51], v19 offset:8192
    ds_read_b64_tr_b16 v[52:53], v22 offset:34816
    v_mfma_f32_32x32x16_bf16 v[144:159], v[64:67], a[172:175], v[144:159]
    ds_read_b64_tr_b16 v[54:55], v22 offset:35072
    ds_read_b64_tr_b16 v[56:57], v22 offset:38912
    buffer_load_dwordx4 v3, s[8:11], s60 offen offset:1024 lds
    v_mfma_f32_32x32x16_bf16 v[160:175], a[168:171], v[68:71], v[160:175]
    ds_read_b64_tr_b16 v[58:59], v22 offset:39168
    v_mfma_f32_32x32x16_bf16 v[176:191], a[172:175], v[68:71], v[176:191]
    buffer_load_dwordx4 v4, s[8:11], s60 offen offset:2048 lds
    v_mfma_f32_32x32x16_bf16 v[192:207], v[72:75], a[168:171], v[192:207]
    v_mfma_f32_32x32x16_bf16 v[208:223], v[72:75], a[172:175], v[208:223]
    buffer_load_dwordx4 v5, s[8:11], s60 offen offset:3072 lds
    v_mfma_f32_32x32x16_bf16 v[224:239], v[76:79], a[168:171], v[224:239]
    v_mfma_f32_32x32x16_bf16 v[240:255], v[76:79], a[172:175], v[240:255]
    s_add_u32 m0, s57, 4096
    s_nop 0
    buffer_load_dwordx4 v6, s[8:11], s60 offen lds
    s_waitcnt lgkmcnt(7)
    v_mfma_f32_32x32x16_bf16 v[96:111], v[40:43], a[176:179], v[96:111]
    ds_read_b64_tr_b16 v[60:61], v21 offset:3072
    ds_read_b64_tr_b16 v[62:63], v21 offset:3328
    v_mfma_f32_32x32x16_bf16 v[112:127], v[40:43], a[180:183], v[112:127]
    ds_read_b64_tr_b16 v[64:65], v21 offset:7168
    ds_read_b64_tr_b16 v[66:67], v21 offset:7424
    buffer_load_dwordx4 v7, s[8:11], s60 offen offset:1024 lds
    s_waitcnt lgkmcnt(9)
    v_mfma_f32_32x32x16_bf16 v[128:143], v[44:47], a[176:179], v[128:143]
    ds_read_b128 v[68:71], v20 offset:8192
    ds_read_b64_tr_b16 v[72:73], v22 offset:35840
    v_mfma_f32_32x32x16_bf16 v[144:159], v[44:47], a[180:183], v[144:159]
    ds_read_b64_tr_b16 v[74:75], v22 offset:36096
    ds_read_b64_tr_b16 v[76:77], v22 offset:39936
    buffer_load_dwordx4 v8, s[8:11], s60 offen offset:2048 lds
    s_waitcnt lgkmcnt(12)
    v_mfma_f32_32x32x16_bf16 v[160:175], a[176:179], v[48:51], v[160:175]
    ds_read_b64_tr_b16 v[78:79], v22 offset:40192
    v_mfma_f32_32x32x16_bf16 v[176:191], a[180:183], v[48:51], v[176:191]
    buffer_load_dwordx4 v9, s[8:11], s60 offen offset:3072 lds
    s_add_u32 s60, s60, 128
    s_add_u32 s61, s61, 221184
    s_waitcnt lgkmcnt(11)
    v_mfma_f32_32x32x16_bf16 v[192:207], v[52:55], a[176:179], v[192:207]
    v_mfma_f32_32x32x16_bf16 v[208:223], v[52:55], a[180:183], v[208:223]
    v_and_b32 v23, 15, v1
    s_lshl_b32 s3, s54, 4
    v_add_u32 v23, s3, v23
    v_lshlrev_b32 v23, 1, v23
    s_waitcnt lgkmcnt(9)
    v_mfma_f32_32x32x16_bf16 v[224:239], v[56:59], a[176:179], v[224:239]
    v_mfma_f32_32x32x16_bf16 v[240:255], v[56:59], a[180:183], v[240:255]
    s_mov_b32 s44, s66
    s_mov_b32 s45, s67
    s_mov_b32 s46, 1280
    s_mov_b32 s47, 0x20000
    buffer_load_ushort v24, v23, s[44:47], 0 offen offset:0
    s_waitcnt lgkmcnt(7)
    v_mfma_f32_32x32x16_bf16 v[96:111], v[60:63], a[184:187], v[96:111]
    s_waitcnt lgkmcnt(0)
    s_mov_b32 s44, s68
    s_mov_b32 s45, s69
    s_mov_b32 s46, 1280
    s_mov_b32 s47, 0x20000
    buffer_load_ushort v25, v23, s[44:47], 0 offen offset:0
    s_mov_b32 s44, s78
    s_mov_b32 s45, s79
    s_mov_b32 s46, 1280
    s_mov_b32 s47, 0x20000
    buffer_load_ushort v26, v23, s[44:47], 0 offen offset:0
    s_mov_b32 s44, s80
    s_mov_b32 s45, s81
    s_mov_b32 s46, 1280
    s_mov_b32 s47, 0x20000
    v_lshlrev_b32 v94, 7, v1
    buffer_load_dword v95, v94, s[44:47], 0 offen
    s_add_u32 m0, s58, 0
    s_mov_b32 s3, s52
    buffer_load_dwordx4 v28, s[24:27], s3 offen nt lds
    s_add_u32 m0, s58, 1024
    s_add_u32 s3, s52, 10240
    buffer_load_dwordx4 v28, s[24:27], s3 offen nt lds
    s_add_u32 m0, s58, 2048
    s_add_u32 s3, s52, s53
    buffer_load_dwordx4 v28, s[28:31], s3 offen nt lds
    s_add_u32 m0, s58, 3072
    s_add_u32 s3, s52, s53
    s_add_u32 s3, s3, 10240
    buffer_load_dwordx4 v28, s[28:31], s3 offen nt lds
    s_waitcnt vmcnt(21)
    s_barrier
    ds_read_b128 a[192:195], v13 offset:8192
    ds_read_b128 a[196:199], v13 offset:12288
    v_mfma_f32_32x32x16_bf16 v[112:127], v[60:63], a[188:191], v[112:127]
    ds_read_b64_tr_b16 v[40:41], v21 offset:12288
    ds_read_b64_tr_b16 v[42:43], v21 offset:12544
    s_add_u32 m0, s59, 0
    s_nop 0
    buffer_load_dwordx4 v10, s[12:15], s61 offen lds
    v_mfma_f32_32x32x16_bf16 v[128:143], v[64:67], a[184:187], v[128:143]
    ds_read_b64_tr_b16 v[44:45], v21 offset:16384
    ds_read_b64_tr_b16 v[46:47], v21 offset:16640
    v_mfma_f32_32x32x16_bf16 v[144:159], v[64:67], a[188:191], v[144:159]
    ds_read_b128 v[48:51], v17 offset:20480
    ds_read_b64_tr_b16 v[52:53], v22 offset:40960
    s_add_u32 m0, s59, 69632
    s_nop 0
    buffer_load_dwordx4 v11, s[12:15], s61 offen lds
    v_mfma_f32_32x32x16_bf16 v[160:175], a[184:187], v[68:71], v[160:175]
    ds_read_b64_tr_b16 v[54:55], v22 offset:41216
    ds_read_b64_tr_b16 v[56:57], v22 offset:45056
    v_mfma_f32_32x32x16_bf16 v[176:191], a[188:191], v[68:71], v[176:191]
    ds_read_b64_tr_b16 v[58:59], v22 offset:45312
    ds_read_b128 a[200:203], v14 offset:8192
    s_add_u32 m0, s59, 4096
    s_nop 0
    buffer_load_dwordx4 v10, s[16:19], s61 offen lds
    v_mfma_f32_32x32x16_bf16 v[192:207], v[72:75], a[184:187], v[192:207]
    ds_read_b128 a[204:207], v14 offset:12288
    v_mfma_f32_32x32x16_bf16 v[208:223], v[72:75], a[188:191], v[208:223]
    s_add_u32 m0, s59, 73728
    s_nop 0
    buffer_load_dwordx4 v11, s[16:19], s61 offen lds
    v_mfma_f32_32x32x16_bf16 v[224:239], v[76:79], a[184:187], v[224:239]
    v_mfma_f32_32x32x16_bf16 v[240:255], v[76:79], a[188:191], v[240:255]
    s_add_u32 m0, s59, 8192
    s_nop 0
    buffer_load_dwordx4 v12, s[20:23], s60 offen lds
    s_waitcnt lgkmcnt(11)
    s_waitcnt lgkmcnt(9)
    v_mfma_f32_32x32x16_bf16 v[96:111], v[40:43], a[192:195], v[96:111]
    ds_read_b64_tr_b16 v[60:61], v21 offset:13312
    ds_read_b64_tr_b16 v[62:63], v21 offset:13568
    v_mfma_f32_32x32x16_bf16 v[112:127], v[40:43], a[196:199], v[112:127]
    ds_read_b64_tr_b16 v[64:65], v21 offset:17408
    ds_read_b64_tr_b16 v[66:67], v21 offset:17664
    s_waitcnt lgkmcnt(11)
    v_mfma_f32_32x32x16_bf16 v[128:143], v[44:47], a[192:195], v[128:143]
    ds_read_b128 v[68:71], v18 offset:20480
    ds_read_b64_tr_b16 v[72:73], v22 offset:41984
    v_mfma_f32_32x32x16_bf16 v[144:159], v[44:47], a[196:199], v[144:159]
    ds_read_b64_tr_b16 v[74:75], v22 offset:42240
    ds_read_b64_tr_b16 v[76:77], v22 offset:46080
    s_waitcnt lgkmcnt(14)
    v_mfma_f32_32x32x16_bf16 v[160:175], a[192:195], v[48:51], v[160:175]
    ds_read_b64_tr_b16 v[78:79], v22 offset:46336
    ds_read_b128 a[208:211], v15 offset:8192
    v_mfma_f32_32x32x16_bf16 v[176:191], a[196:199], v[48:51], v[176:191]
    ds_read_b128 a[212:215], v15 offset:12288
    ds_read_b128 a[216:219], v16 offset:8192
    s_waitcnt lgkmcnt(15)
    v_mfma_f32_32x32x16_bf16 v[192:207], v[52:55], a[192:195], v[192:207]
    ds_read_b128 a[220:223], v16 offset:12288
    v_mfma_f32_32x32x16_bf16 v[208:223], v[52:55], a[196:199], v[208:223]
    s_waitcnt lgkmcnt(15)
    v_mfma_f32_32x32x16_bf16 v[224:239], v[56:59], a[192:195], v[224:239]
    v_mfma_f32_32x32x16_bf16 v[240:255], v[56:59], a[196:199], v[240:255]
    s_waitcnt lgkmcnt(13)
    s_waitcnt lgkmcnt(11)
    v_mfma_f32_32x32x16_bf16 v[96:111], v[60:63], a[200:203], v[96:111]
    ds_read_b64_tr_b16 v[40:41], v21 offset:14336
    ds_read_b64_tr_b16 v[42:43], v21 offset:14592
    v_mfma_f32_32x32x16_bf16 v[112:127], v[60:63], a[204:207], v[112:127]
    ds_read_b64_tr_b16 v[44:45], v21 offset:18432
    ds_read_b64_tr_b16 v[46:47], v21 offset:18688
    s_waitcnt lgkmcnt(4)
    s_add_u32 m0, s57, 8192
    s_nop 0
    buffer_load_dwordx4 v2, s[8:11], s60 offen lds
    v_mfma_f32_32x32x16_bf16 v[128:143], v[64:67], a[200:203], v[128:143]
    ds_read_b128 v[48:51], v19 offset:20480
    ds_read_b64_tr_b16 v[52:53], v22 offset:43008
    v_mfma_f32_32x32x16_bf16 v[144:159], v[64:67], a[204:207], v[144:159]
    ds_read_b64_tr_b16 v[54:55], v22 offset:43264
    ds_read_b64_tr_b16 v[56:57], v22 offset:47104
    buffer_load_dwordx4 v3, s[8:11], s60 offen offset:1024 lds
    v_mfma_f32_32x32x16_bf16 v[160:175], a[200:203], v[68:71], v[160:175]
    ds_read_b64_tr_b16 v[58:59], v22 offset:47360
    v_mfma_f32_32x32x16_bf16 v[176:191], a[204:207], v[68:71], v[176:191]
    buffer_load_dwordx4 v4, s[8:11], s60 offen offset:2048 lds
    v_mfma_f32_32x32x16_bf16 v[192:207], v[72:75], a[200:203], v[192:207]
    v_mfma_f32_32x32x16_bf16 v[208:223], v[72:75], a[204:207], v[208:223]
    buffer_load_dwordx4 v5, s[8:11], s60 offen offset:3072 lds
    v_mfma_f32_32x32x16_bf16 v[224:239], v[76:79], a[200:203], v[224:239]
    v_mfma_f32_32x32x16_bf16 v[240:255], v[76:79], a[204:207], v[240:255]
    s_add_u32 m0, s57, 12288
    s_nop 0
    buffer_load_dwordx4 v6, s[8:11], s60 offen lds
    s_waitcnt lgkmcnt(7)
    v_mfma_f32_32x32x16_bf16 v[96:111], v[40:43], a[208:211], v[96:111]
    ds_read_b64_tr_b16 v[60:61], v21 offset:15360
    ds_read_b64_tr_b16 v[62:63], v21 offset:15616
    v_mfma_f32_32x32x16_bf16 v[112:127], v[40:43], a[212:215], v[112:127]
    ds_read_b64_tr_b16 v[64:65], v21 offset:19456
    ds_read_b64_tr_b16 v[66:67], v21 offset:19712
    buffer_load_dwordx4 v7, s[8:11], s60 offen offset:1024 lds
    s_waitcnt lgkmcnt(9)
    v_mfma_f32_32x32x16_bf16 v[128:143], v[44:47], a[208:211], v[128:143]
    ds_read_b128 v[68:71], v20 offset:20480
    ds_read_b64_tr_b16 v[72:73], v22 offset:44032
    v_mfma_f32_32x32x16_bf16 v[144:159], v[44:47], a[212:215], v[144:159]
    ds_read_b64_tr_b16 v[74:75], v22 offset:44288
    ds_read_b64_tr_b16 v[76:77], v22 offset:48128
    buffer_load_dwordx4 v8, s[8:11], s60 offen offset:2048 lds
    s_waitcnt lgkmcnt(12)
    v_mfma_f32_32x32x16_bf16 v[160:175], a[208:211], v[48:51], v[160:175]
    ds_read_b64_tr_b16 v[78:79], v22 offset:48384
    v_mfma_f32_32x32x16_bf16 v[176:191], a[212:215], v[48:51], v[176:191]
    buffer_load_dwordx4 v9, s[8:11], s60 offen offset:3072 lds
    s_add_u32 s60, s60, 128
    s_add_u32 s61, s61, 221184
    s_waitcnt vmcnt(13)
    s_cmp_eq_u32 s62, 1
    s_cbranch_scc0 L_rpc_2
    ds_read_b64_tr_b16 a[224:225], v30 offset:0
    ds_read_b64_tr_b16 a[226:227], v30 offset:1024
    ds_read_b64_tr_b16 a[228:229], v30 offset:32
    ds_read_b64_tr_b16 a[230:231], v30 offset:1056
    s_branch L_rpd_3
L_rpc_2:
    ds_read_b128 a[224:227], v32 offset:0
    ds_read_b128 a[228:231], v32 offset:32
L_rpd_3:
    s_waitcnt lgkmcnt(11)
    v_mfma_f32_32x32x16_bf16 v[192:207], v[52:55], a[208:211], v[192:207]
    s_cmp_eq_u32 s62, 1
    s_cbranch_scc0 L_rpc_4
    ds_read_b64_tr_b16 a[232:233], v30 offset:64
    ds_read_b64_tr_b16 a[234:235], v30 offset:1088
    ds_read_b64_tr_b16 a[236:237], v30 offset:96
    ds_read_b64_tr_b16 a[238:239], v30 offset:1120
    s_branch L_rpd_5
L_rpc_4:
    ds_read_b128 a[232:235], v32 offset:64
    ds_read_b128 a[236:239], v32 offset:96
L_rpd_5:
    v_mfma_f32_32x32x16_bf16 v[208:223], v[52:55], a[212:215], v[208:223]
    s_waitcnt lgkmcnt(9)
    v_mfma_f32_32x32x16_bf16 v[224:239], v[56:59], a[208:211], v[224:239]
    v_mfma_f32_32x32x16_bf16 v[240:255], v[56:59], a[212:215], v[240:255]
    s_waitcnt lgkmcnt(7)
    v_mfma_f32_32x32x16_bf16 v[96:111], v[60:63], a[216:219], v[96:111]
    s_waitcnt lgkmcnt(0)
    s_barrier
    ds_read_b128 a[160:163], v13 offset:0
    ds_read_b128 a[164:167], v13 offset:4096
    v_lshrrev_b32 v34, 4, v1
    v_lshl_add_u32 v32, s4, 2, v34
    v_mfma_f32_32x32x16_bf16 v[112:127], v[60:63], a[220:223], v[112:127]
    ds_read_b64_tr_b16 v[40:41], v21 offset:24576
    ds_read_b64_tr_b16 v[42:43], v21 offset:24832
    s_add_u32 m0, s59, 12288
    s_nop 0
    buffer_load_dwordx4 v10, s[12:15], s61 offen lds
    v_lshlrev_b32 v32, 4, v32
    v_cvt_f32_u32 v32, v32
    v_mfma_f32_32x32x16_bf16 v[128:143], v[64:67], a[216:219], v[128:143]
    ds_read_b64_tr_b16 v[44:45], v21 offset:28672
    ds_read_b64_tr_b16 v[46:47], v21 offset:28928
    v_sub_u32 v34, s5, v34
    v_add_u32 v34, -1, v34
    v_lshlrev_b32 v34, 8, v34
    v_mfma_f32_32x32x16_bf16 v[144:159], v[64:67], a[220:223], v[144:159]
    ds_read_b128 v[48:51], v17 offset:32768
    ds_read_b64_tr_b16 v[52:53], v22 offset:49152
    s_add_u32 m0, s59, 36864
    s_nop 0
    buffer_load_dwordx4 v11, s[12:15], s61 offen lds
    v_cvt_f32_i32 v33, v34
    v_add_f32 v34, 0xc4800000, v33
    v_mfma_f32_32x32x16_bf16 v[160:175], a[216:219], v[68:71], v[160:175]
    ds_read_b64_tr_b16 v[54:55], v22 offset:49408
    ds_read_b64_tr_b16 v[56:57], v22 offset:53248
    v_lshlrev_b32 v24, 16, v24
    v_lshlrev_b32 v25, 16, v25
    v_lshlrev_b32 v26, 16, v26
    v_mfma_f32_32x32x16_bf16 v[176:191], a[220:223], v[68:71], v[176:191]
    ds_read_b64_tr_b16 v[58:59], v22 offset:53504
    ds_read_b128 a[168:171], v14 offset:0
    s_add_u32 m0, s59, 16384
    s_nop 0
    buffer_load_dwordx4 v10, s[16:19], s61 offen lds
    v_mul_f32 v26, 0x3fb8aa3b, v26
    v_exp_f32 v26, v26
    v_mfma_f32_32x32x16_bf16 v[192:207], v[72:75], a[216:219], v[192:207]
    ds_read_b128 a[172:175], v14 offset:4096
    v_mul_f32 v30, v24, v24
    v_cvt_pk_bf16_f32 v26, v26, v26
    v_fmac_f32 v30, v25, v25
    v_lshlrev_b32 v26, 16, v26
    v_mfma_f32_32x32x16_bf16 v[208:223], v[72:75], a[220:223], v[208:223]
    s_add_u32 m0, s59, 40960
    s_nop 0
    buffer_load_dwordx4 v11, s[16:19], s61 offen lds
    v_rcp_f32 v30, v30
    v_mul_f32 v27, v26, v24
    v_mul_f32 v28, v26, v25
    v_mul_f32 v27, 0x3fb8aa3b, v27
    v_mfma_f32_32x32x16_bf16 v[224:239], v[76:79], a[216:219], v[224:239]
    v_mul_f32 v28, 0x3e22f983, v28
    v_exp_f32 v26, v27
    v_mov_b32 v29, v28
    v_rndne_f32 v31, v29
    v_sub_f32 v29, v29, v31
    v_mfma_f32_32x32x16_bf16 v[240:255], v[76:79], a[220:223], v[240:255]
    s_add_u32 m0, s59, 20480
    s_nop 0
    buffer_load_dwordx4 v12, s[20:23], s60 offen lds
    v_cos_f32 v80, v29
    v_sin_f32 v81, v29
    s_nop 0
    v_mul_f32 v80, v26, v80
    s_waitcnt lgkmcnt(11)
    s_waitcnt lgkmcnt(9)
    v_mfma_f32_32x32x16_bf16 v[96:111], v[40:43], a[160:163], v[96:111]
    ds_read_b64_tr_b16 v[60:61], v21 offset:25600
    ds_read_b64_tr_b16 v[62:63], v21 offset:25856
    v_mul_f32 v81, v26, v81
    v_add_f32 v29, -1.0, v80
    v_mfma_f32_32x32x16_bf16 v[112:127], v[40:43], a[164:167], v[112:127]
    ds_read_b64_tr_b16 v[64:65], v21 offset:29696
    ds_read_b64_tr_b16 v[66:67], v21 offset:29952
    v_add_f32 v30, v30, v30
    v_mul_f32 v82, v29, v24
    v_mul_f32 v83, v81, v24
    s_waitcnt lgkmcnt(11)
    v_mfma_f32_32x32x16_bf16 v[128:143], v[44:47], a[160:163], v[128:143]
    ds_read_b128 v[68:71], v18 offset:32768
    ds_read_b64_tr_b16 v[72:73], v22 offset:50176
    v_fmac_f32 v82, v81, v25
    v_fma_f32 v83, -v29, v25, v83
    v_mfma_f32_32x32x16_bf16 v[144:159], v[44:47], a[164:167], v[144:159]
    ds_read_b64_tr_b16 v[74:75], v22 offset:50432
    ds_read_b64_tr_b16 v[76:77], v22 offset:54272
    v_mul_f32 v82, v82, v30
    v_mul_f32 v83, v83, v30
    v_mul_f32 v26, 0x41800000, v27
    s_waitcnt lgkmcnt(14)
    v_mfma_f32_32x32x16_bf16 v[160:175], a[160:163], v[48:51], v[160:175]
    ds_read_b64_tr_b16 v[78:79], v22 offset:54528
    ds_read_b128 a[176:179], v15 offset:0
    v_mul_f32 v29, 0x41800000, v28
    v_exp_f32 v26, v26
    v_mfma_f32_32x32x16_bf16 v[176:191], a[164:167], v[48:51], v[176:191]
    ds_read_b128 a[180:183], v15 offset:4096
    ds_read_b128 a[184:187], v16 offset:0
    v_rndne_f32 v31, v29
    v_sub_f32 v29, v29, v31
    v_cos_f32 v84, v29
    s_waitcnt lgkmcnt(15)
    v_mfma_f32_32x32x16_bf16 v[192:207], v[52:55], a[160:163], v[192:207]
    ds_read_b128 a[188:191], v16 offset:4096
    v_sin_f32 v85, v29
    s_nop 0
    v_mul_f32 v84, v26, v84
    v_mfma_f32_32x32x16_bf16 v[208:223], v[52:55], a[164:167], v[208:223]
    v_mul_f32 v85, v26, v85
    v_mul_f32 v26, v32, v27
    v_mul_f32 v29, v32, v28
    v_exp_f32 v26, v26
    v_rndne_f32 v31, v29
    s_waitcnt lgkmcnt(15)
    v_mfma_f32_32x32x16_bf16 v[224:239], v[56:59], a[160:163], v[224:239]
    v_sub_f32 v29, v29, v31
    v_cos_f32 v86, v29
    v_sin_f32 v87, v29
    s_nop 0
    v_mfma_f32_32x32x16_bf16 v[240:255], v[56:59], a[164:167], v[240:255]
    v_mul_f32 v86, v26, v86
    v_mul_f32 v87, v26, v87
    v_mul_f32 v26, v33, v27
    v_mul_f32 v29, v33, v28
    v_exp_f32 v26, v26
    s_waitcnt lgkmcnt(13)
    s_waitcnt lgkmcnt(11)
    v_mfma_f32_32x32x16_bf16 v[96:111], v[60:63], a[168:171], v[96:111]
    ds_read_b64_tr_b16 v[40:41], v21 offset:26624
    ds_read_b64_tr_b16 v[42:43], v21 offset:26880
    v_rndne_f32 v31, v29
    v_cmp_le_f32 vcc, 0, v33
    v_mfma_f32_32x32x16_bf16 v[112:127], v[60:63], a[172:175], v[112:127]
    ds_read_b64_tr_b16 v[44:45], v21 offset:30720
    ds_read_b64_tr_b16 v[46:47], v21 offset:30976
    s_waitcnt lgkmcnt(4)
    s_add_u32 m0, s57, 0
    s_nop 0
    buffer_load_dwordx4 v2, s[8:11], s60 offen lds
    v_sub_f32 v29, v29, v31
    v_cos_f32 v88, v29
    v_mfma_f32_32x32x16_bf16 v[128:143], v[64:67], a[168:171], v[128:143]
    ds_read_b128 v[48:51], v19 offset:32768
    ds_read_b64_tr_b16 v[52:53], v22 offset:51200
    v_sin_f32 v89, v29
    v_cndmask_b32 v26, 0, v26, vcc
    v_mul_f32 v88, v26, v88
    v_mfma_f32_32x32x16_bf16 v[144:159], v[64:67], a[172:175], v[144:159]
    ds_read_b64_tr_b16 v[54:55], v22 offset:51456
    ds_read_b64_tr_b16 v[56:57], v22 offset:55296
    buffer_load_dwordx4 v3, s[8:11], s60 offen offset:1024 lds
    v_mul_f32 v89, v26, v89
    v_mul_f32 v26, v34, v27
    v_mfma_f32_32x32x16_bf16 v[160:175], a[168:171], v[68:71], v[160:175]
    ds_read_b64_tr_b16 v[58:59], v22 offset:55552
    v_mul_f32 v29, v34, v28
    v_exp_f32 v26, v26
    v_rndne_f32 v31, v29
    v_cmp_le_f32 vcc, 0, v34
    v_mfma_f32_32x32x16_bf16 v[176:191], a[172:175], v[68:71], v[176:191]
    buffer_load_dwordx4 v4, s[8:11], s60 offen offset:2048 lds
    v_sub_f32 v29, v29, v31
    v_cos_f32 v90, v29
    v_sin_f32 v91, v29
    v_cndmask_b32 v26, 0, v26, vcc
    v_mfma_f32_32x32x16_bf16 v[192:207], v[72:75], a[168:171], v[192:207]
    v_mul_f32 v90, v26, v90
    v_mul_f32 v91, v26, v91
    v_mfma_f32_32x32x16_bf16 v[208:223], v[72:75], a[172:175], v[208:223]
    buffer_load_dwordx4 v5, s[8:11], s60 offen offset:3072 lds
    v_mfma_f32_32x32x16_bf16 v[224:239], v[76:79], a[168:171], v[224:239]
    v_mfma_f32_32x32x16_bf16 v[240:255], v[76:79], a[172:175], v[240:255]
    s_add_u32 m0, s57, 4096
    s_nop 0
    buffer_load_dwordx4 v6, s[8:11], s60 offen lds
    s_waitcnt lgkmcnt(7)
    v_mfma_f32_32x32x16_bf16 v[96:111], v[40:43], a[176:179], v[96:111]
    ds_read_b64_tr_b16 v[60:61], v21 offset:27648
    ds_read_b64_tr_b16 v[62:63], v21 offset:27904
    v_mfma_f32_32x32x16_bf16 v[112:127], v[40:43], a[180:183], v[112:127]
    ds_read_b64_tr_b16 v[64:65], v21 offset:31744
    ds_read_b64_tr_b16 v[66:67], v21 offset:32000
    buffer_load_dwordx4 v7, s[8:11], s60 offen offset:1024 lds
    s_waitcnt lgkmcnt(9)
    v_mfma_f32_32x32x16_bf16 v[128:143], v[44:47], a[176:179], v[128:143]
    ds_read_b128 v[68:71], v20 offset:32768
    ds_read_b64_tr_b16 v[72:73], v22 offset:52224
    v_mfma_f32_32x32x16_bf16 v[144:159], v[44:47], a[180:183], v[144:159]
    ds_read_b64_tr_b16 v[74:75], v22 offset:52480
    ds_read_b64_tr_b16 v[76:77], v22 offset:56320
    buffer_load_dwordx4 v8, s[8:11], s60 offen offset:2048 lds
    s_waitcnt lgkmcnt(12)
    v_mfma_f32_32x32x16_bf16 v[160:175], a[176:179], v[48:51], v[160:175]
    ds_read_b64_tr_b16 v[78:79], v22 offset:56576
    v_mfma_f32_32x32x16_bf16 v[176:191], a[180:183], v[48:51], v[176:191]
    buffer_load_dwordx4 v9, s[8:11], s60 offen offset:3072 lds
    s_add_u32 s60, s60, 128
    s_add_u32 s61, s61, 221184
    s_cmp_ge_u32 s60, 1280
    s_cmov_b32 s60, 0
    s_cmov_b32 s61, 0
    s_waitcnt lgkmcnt(11)
    v_mfma_f32_32x32x16_bf16 v[192:207], v[52:55], a[176:179], v[192:207]
    v_mfma_f32_32x32x16_bf16 v[208:223], v[52:55], a[180:183], v[208:223]
    buffer_store_dwordx4 a[224:227], v38, s[32:35], s84 offen sc1
    s_add_u32 s84, s84, s85
    s_waitcnt lgkmcnt(9)
    v_mfma_f32_32x32x16_bf16 v[224:239], v[56:59], a[176:179], v[224:239]
    v_mfma_f32_32x32x16_bf16 v[240:255], v[56:59], a[180:183], v[240:255]
    buffer_store_dwordx4 a[228:231], v38, s[32:35], s84 offen sc1
    s_add_u32 s84, s84, s85
    s_waitcnt lgkmcnt(7)
    v_mfma_f32_32x32x16_bf16 v[96:111], v[60:63], a[184:187], v[96:111]
    s_waitcnt lgkmcnt(0)
    buffer_store_dwordx4 a[232:235], v38, s[32:35], s84 offen sc1
    s_add_u32 s84, s84, s85
    buffer_store_dwordx4 a[236:239], v38, s[32:35], s84 offen sc1
    s_waitcnt vmcnt(17)
    s_barrier
    ds_read_b128 a[192:195], v13 offset:8192
    ds_read_b128 a[196:199], v13 offset:12288
    v_mfma_f32_32x32x16_bf16 v[112:127], v[60:63], a[188:191], v[112:127]
    ds_read_b64_tr_b16 v[40:41], v21 offset:0
    ds_read_b64_tr_b16 v[42:43], v21 offset:256
    v_mov_b32 v93, 0
    s_mov_b64 exec, 0x1
    buffer_load_dwordx2 v[92:93], v93, s[40:43], 0 offen sc1
    s_mov_b64 exec, -1
    v_mfma_f32_32x32x16_bf16 v[128:143], v[64:67], a[184:187], v[128:143]
    ds_read_b64_tr_b16 v[44:45], v21 offset:4096
    ds_read_b64_tr_b16 v[46:47], v21 offset:4352
    v_mfma_f32_32x32x16_bf16 v[144:159], v[64:67], a[188:191], v[144:159]
    ds_read_b128 v[48:51], v17 offset:8192
    ds_read_b64_tr_b16 v[52:53], v22 offset:32768
    s_add_u32 m0, s59, 24576
    s_nop 0
    buffer_load_dwordx4 v10, s[12:15], s61 offen lds
    v_mfma_f32_32x32x16_bf16 v[160:175], a[184:187], v[68:71], v[160:175]
    ds_read_b64_tr_b16 v[54:55], v22 offset:33024
    ds_read_b64_tr_b16 v[56:57], v22 offset:36864
    v_mfma_f32_32x32x16_bf16 v[176:191], a[188:191], v[68:71], v[176:191]
    ds_read_b64_tr_b16 v[58:59], v22 offset:37120
    ds_read_b128 a[200:203], v14 offset:8192
    s_add_u32 m0, s59, 45056
    s_nop 0
    buffer_load_dwordx4 v11, s[12:15], s61 offen lds
    v_mfma_f32_32x32x16_bf16 v[192:207], v[72:75], a[184:187], v[192:207]
    ds_read_b128 a[204:207], v14 offset:12288
    v_mfma_f32_32x32x16_bf16 v[208:223], v[72:75], a[188:191], v[208:223]
    s_add_u32 m0, s59, 28672
    s_nop 0
    buffer_load_dwordx4 v10, s[16:19], s61 offen lds
    v_mfma_f32_32x32x16_bf16 v[224:239], v[76:79], a[184:187], v[224:239]
    v_mfma_f32_32x32x16_bf16 v[240:255], v[76:79], a[188:191], v[240:255]
    s_add_u32 m0, s59, 49152
    s_nop 0
    buffer_load_dwordx4 v11, s[16:19], s61 offen lds
    s_waitcnt lgkmcnt(11)
    s_waitcnt lgkmcnt(9)
    v_mfma_f32_32x32x16_bf16 v[96:111], v[40:43], a[192:195], v[96:111]
    ds_read_b64_tr_b16 v[60:61], v21 offset:1024
    ds_read_b64_tr_b16 v[62:63], v21 offset:1280
    v_mfma_f32_32x32x16_bf16 v[112:127], v[40:43], a[196:199], v[112:127]
    ds_read_b64_tr_b16 v[64:65], v21 offset:5120
    ds_read_b64_tr_b16 v[66:67], v21 offset:5376
    s_add_u32 m0, s59, 32768
    s_nop 0
    buffer_load_dwordx4 v12, s[20:23], s60 offen lds
    s_waitcnt lgkmcnt(11)
    v_mfma_f32_32x32x16_bf16 v[128:143], v[44:47], a[192:195], v[128:143]
    ds_read_b128 v[68:71], v18 offset:8192
    ds_read_b64_tr_b16 v[72:73], v22 offset:33792
    v_mfma_f32_32x32x16_bf16 v[144:159], v[44:47], a[196:199], v[144:159]
    ds_read_b64_tr_b16 v[74:75], v22 offset:34048
    ds_read_b64_tr_b16 v[76:77], v22 offset:37888
    s_waitcnt lgkmcnt(14)
    v_mfma_f32_32x32x16_bf16 v[160:175], a[192:195], v[48:51], v[160:175]
    ds_read_b64_tr_b16 v[78:79], v22 offset:38144
    ds_read_b128 a[208:211], v15 offset:8192
    v_mfma_f32_32x32x16_bf16 v[176:191], a[196:199], v[48:51], v[176:191]
    ds_read_b128 a[212:215], v15 offset:12288
    ds_read_b128 a[216:219], v16 offset:8192
    s_waitcnt lgkmcnt(15)
    v_mfma_f32_32x32x16_bf16 v[192:207], v[52:55], a[192:195], v[192:207]
    ds_read_b128 a[220:223], v16 offset:12288
    v_mfma_f32_32x32x16_bf16 v[208:223], v[52:55], a[196:199], v[208:223]
    s_waitcnt lgkmcnt(15)
    v_mfma_f32_32x32x16_bf16 v[224:239], v[56:59], a[192:195], v[224:239]
    v_mfma_f32_32x32x16_bf16 v[240:255], v[56:59], a[196:199], v[240:255]
    s_waitcnt lgkmcnt(13)
    s_waitcnt lgkmcnt(11)
    v_mfma_f32_32x32x16_bf16 v[96:111], v[60:63], a[200:203], v[96:111]
    ds_read_b64_tr_b16 v[40:41], v21 offset:2048
    ds_read_b64_tr_b16 v[42:43], v21 offset:2304
    v_mfma_f32_32x32x16_bf16 v[112:127], v[60:63], a[204:207], v[112:127]
    ds_read_b64_tr_b16 v[44:45], v21 offset:6144
    ds_read_b64_tr_b16 v[46:47], v21 offset:6400
    s_waitcnt lgkmcnt(4)
    s_add_u32 m0, s57, 8192
    s_nop 0
    buffer_load_dwordx4 v2, s[8:11], s60 offen lds
    v_mfma_f32_32x32x16_bf16 v[128:143], v[64:67], a[200:203], v[128:143]
    ds_read_b128 v[48:51], v19 offset:8192
    ds_read_b64_tr_b16 v[52:53], v22 offset:34816
    v_mfma_f32_32x32x16_bf16 v[144:159], v[64:67], a[204:207], v[144:159]
    ds_read_b64_tr_b16 v[54:55], v22 offset:35072
    ds_read_b64_tr_b16 v[56:57], v22 offset:38912
    buffer_load_dwordx4 v3, s[8:11], s60 offen offset:1024 lds
    v_mfma_f32_32x32x16_bf16 v[160:175], a[200:203], v[68:71], v[160:175]
    ds_read_b64_tr_b16 v[58:59], v22 offset:39168
    v_mfma_f32_32x32x16_bf16 v[176:191], a[204:207], v[68:71], v[176:191]
    buffer_load_dwordx4 v4, s[8:11], s60 offen offset:2048 lds
    v_mfma_f32_32x32x16_bf16 v[192:207], v[72:75], a[200:203], v[192:207]
    v_mfma_f32_32x32x16_bf16 v[208:223], v[72:75], a[204:207], v[208:223]
    buffer_load_dwordx4 v5, s[8:11], s60 offen offset:3072 lds
    v_mfma_f32_32x32x16_bf16 v[224:239], v[76:79], a[200:203], v[224:239]
    v_mfma_f32_32x32x16_bf16 v[240:255], v[76:79], a[204:207], v[240:255]
    s_add_u32 m0, s57, 12288
    s_nop 0
    buffer_load_dwordx4 v6, s[8:11], s60 offen lds
    s_waitcnt lgkmcnt(7)
    v_mfma_f32_32x32x16_bf16 v[96:111], v[40:43], a[208:211], v[96:111]
    ds_read_b64_tr_b16 v[60:61], v21 offset:3072
    ds_read_b64_tr_b16 v[62:63], v21 offset:3328
    v_mfma_f32_32x32x16_bf16 v[112:127], v[40:43], a[212:215], v[112:127]
    ds_read_b64_tr_b16 v[64:65], v21 offset:7168
    ds_read_b64_tr_b16 v[66:67], v21 offset:7424
    buffer_load_dwordx4 v7, s[8:11], s60 offen offset:1024 lds
    s_waitcnt lgkmcnt(9)
    v_mfma_f32_32x32x16_bf16 v[128:143], v[44:47], a[208:211], v[128:143]
    ds_read_b128 v[68:71], v20 offset:8192
    ds_read_b64_tr_b16 v[72:73], v22 offset:35840
    v_mfma_f32_32x32x16_bf16 v[144:159], v[44:47], a[212:215], v[144:159]
    ds_read_b64_tr_b16 v[74:75], v22 offset:36096
    ds_read_b64_tr_b16 v[76:77], v22 offset:39936
    buffer_load_dwordx4 v8, s[8:11], s60 offen offset:2048 lds
    s_waitcnt lgkmcnt(12)
    v_mfma_f32_32x32x16_bf16 v[160:175], a[208:211], v[48:51], v[160:175]
    ds_read_b64_tr_b16 v[78:79], v22 offset:40192
    v_mfma_f32_32x32x16_bf16 v[176:191], a[212:215], v[48:51], v[176:191]
    buffer_load_dwordx4 v9, s[8:11], s60 offen offset:3072 lds
    s_add_u32 s60, s60, 128
    s_add_u32 s61, s61, 221184
    s_waitcnt lgkmcnt(11)
    v_mfma_f32_32x32x16_bf16 v[192:207], v[52:55], a[208:211], v[192:207]
    v_mfma_f32_32x32x16_bf16 v[208:223], v[52:55], a[212:215], v[208:223]
    s_waitcnt lgkmcnt(9)
    v_mfma_f32_32x32x16_bf16 v[224:239], v[56:59], a[208:211], v[224:239]
    v_mfma_f32_32x32x16_bf16 v[240:255], v[56:59], a[212:215], v[240:255]
    s_waitcnt lgkmcnt(7)
    v_mfma_f32_32x32x16_bf16 v[96:111], v[60:63], a[216:219], v[96:111]
    s_waitcnt lgkmcnt(0)
    s_waitcnt vmcnt(18)
    s_waitcnt vmcnt(13)
    s_barrier
    v_readfirstlane_b32 s50, v92
    v_readfirstlane_b32 s51, v93
    s_nop 0
    s_cmp_lg_u64 s[50:51], 0
    s_cbranch_scc0 L_tagslow_6
L_tagok_7:
    ds_read_b128 a[0:3], v13 offset:0
    ds_read_b128 a[4:7], v13 offset:4096
    v_mov_b32 v36, s50
    v_mov_b32 v37, s51
    v_mfma_f32_32x32x16_bf16 v[112:127], v[60:63], a[220:223], v[112:127]
    ds_read_b64_tr_b16 v[40:41], v21 offset:12288
    ds_read_b64_tr_b16 v[42:43], v21 offset:12544
    s_add_u32 m0, s59, 0
    s_nop 0
    buffer_load_dwordx4 v10, s[12:15], s61 offen lds
    v_lshrrev_b32 v38, 4, v1
    v_lshlrev_b32 v38, 29, v38
    v_mfma_f32_32x32x16_bf16 v[128:143], v[64:67], a[216:219], v[128:143]
    ds_read_b64_tr_b16 v[44:45], v21 offset:16384
    ds_read_b64_tr_b16 v[46:47], v21 offset:16640
    v_lshl_add_u32 v38, v1, 3, v38
    s_cmp_eq_u32 s4, 0
    s_cselect_b32 s3, s55, 2130706432
    v_or_b32 v38, s3, v38
    s_lshl_b32 s3, s48, 7
    s_add_u32 s3, s3, 22020096
    buffer_store_dwordx2 v[36:37], v38, s[32:35], s3 offen sc1
    v_lshrrev_b32 v38, 4, v1
    v_mfma_f32_32x32x16_bf16 v[144:159], v[64:67], a[220:223], v[144:159]
    ds_read_b128 v[48:51], v17 offset:20480
    ds_read_b128 a[8:11], v14 offset:0
    s_add_u32 m0, s59, 53248
    s_nop 0
    buffer_load_dwordx4 v11, s[12:15], s61 offen lds
    v_lshlrev_b32 v38, 29, v38
    v_lshl_add_u32 v38, v1, 3, v38
    v_mfma_f32_32x32x16_bf16 v[160:175], a[216:219], v[68:71], v[160:175]
    ds_read_b128 a[12:15], v14 offset:4096
    s_mul_i32 s85, s4, 40960
    s_mul_i32 s52, s49, 5120
    s_add_u32 s85, s85, s52
    v_lshlrev_b32 v23, 4, v1
    v_mfma_f32_32x32x16_bf16 v[176:191], a[220:223], v[68:71], v[176:191]
    s_add_u32 m0, s59, 4096
    s_nop 0
    buffer_load_dwordx4 v10, s[16:19], s61 offen lds
    v_add_u32 v30, s85, v23
    v_add_u32 v31, 4096, v30
    v_add_u32 v32, s63, v30
    v_add_u32 v33, s63, v31
    v_mfma_f32_32x32x16_bf16 v[192:207], v[72:75], a[216:219], v[192:207]
    v_lshlrev_b32 v35, 3, v1
    v_lshl_add_u32 v35, s4, 9, v35
    v_add_u32 v35, 159744, v35
    v_mov_b32 v28, 0
    v_mov_b32 v29, 0
    v_mfma_f32_32x32x16_bf16 v[208:223], v[72:75], a[220:223], v[208:223]
    s_add_u32 m0, s59, 57344
    s_nop 0
    buffer_load_dwordx4 v11, s[16:19], s61 offen lds
    s_mov_b32 s53, 22020096
    ds_write_b64 v35, v[28:29] offset:0
    s_lshl_b32 s3, s5, 2
    s_add_u32 s3, s3, s4
    s_lshl_b32 s3, s3, 5
    s_add_u32 s3, s3, s6
    v_mov_b32 v94, s3
    s_xor_b32 s3, s2, 4
    s_lshl_b32 s3, s3, 2
    s_add_u32 s3, s3, s4
    v_mov_b32 v95, s3
    v_cmp_gt_u32 s[98:99], 48, v1
    s_nop 1
    v_cndmask_b32 v94, v95, v94, s[98:99]
    v_lshrrev_b32 v95, 4, v1
    v_mfma_f32_32x32x16_bf16 v[224:239], v[76:79], a[216:219], v[224:239]
    v_lshl_add_u32 v94, v95, 10, v94
    v_lshlrev_b32 v94, 7, v94
    v_and_b32 v95, 15, v1
    v_lshl_add_u32 v94, v95, 3, v94
    s_mov_b32 s3, 22052864
    buffer_store_dwordx2 v[28:29], v94, s[32:35], s3 offen sc1
    v_mfma_f32_32x32x16_bf16 v[240:255], v[76:79], a[220:223], v[240:255]
    s_add_u32 m0, s59, 8192
    s_nop 0
    buffer_load_dwordx4 v12, s[20:23], s60 offen lds
    s_cmp_eq_u32 s4, 3
    s_cselect_b32 s3, 0, 2130706432
    v_lshrrev_b32 v94, 5, v1
    v_lshlrev_b32 v94, 29, v94
    v_lshl_add_u32 v94, v1, 3, v94
    v_or_b32 v94, s3, v94
    s_lshl_b32 s3, s54, 3
    s_add_u32 s3, s3, s5
    s_lshl_b32 s3, s3, 8
    s_add_u32 s3, s3, 16515072
    buffer_store_dwordx2 v[28:29], v94, s[32:35], s3 offen sc1
    s_waitcnt lgkmcnt(8)
    s_waitcnt lgkmcnt(6)
    v_mfma_f32_32x32x16_bf16 v[96:111], v[40:43], a[0:3], v[96:111]
    ds_read_b64_tr_b16 v[60:61], v21 offset:13312
    ds_read_b64_tr_b16 v[62:63], v21 offset:13568
    v_mfma_f32_32x32x16_bf16 v[112:127], v[40:43], a[4:7], v[112:127]
    ds_read_b64_tr_b16 v[64:65], v21 offset:17408
    ds_read_b64_tr_b16 v[66:67], v21 offset:17664
    s_waitcnt lgkmcnt(8)
    v_mfma_f32_32x32x16_bf16 v[128:143], v[44:47], a[0:3], v[128:143]
    ds_read_b128 v[68:71], v18 offset:20480
    ds_read_b128 a[16:19], v15 offset:0
    v_mfma_f32_32x32x16_bf16 v[144:159], v[44:47], a[4:7], v[144:159]
    ds_read_b128 a[20:23], v15 offset:4096
    ds_read_b128 a[24:27], v16 offset:0
    s_waitcnt lgkmcnt(11)
    v_mfma_f32_32x32x16_bf16 v[160:175], a[0:3], v[48:51], v[160:175]
    ds_read_b128 a[28:31], v16 offset:4096
    v_mfma_f32_32x32x16_bf16 v[176:191], a[4:7], v[48:51], v[176:191]
    s_waitcnt lgkmcnt(10)
    s_waitcnt lgkmcnt(7)
    v_mfma_f32_32x32x16_bf16 v[96:111], v[60:63], a[8:11], v[96:111]
    ds_read_b64_tr_b16 v[40:41], v21 offset:14336
    ds_read_b64_tr_b16 v[42:43], v21 offset:14592
    s_waitcnt lgkmcnt(2)
    s_add_u32 m0, s57, 0
    s_nop 0
    buffer_load_dwordx4 v2, s[8:11], s60 offen lds
    v_mfma_f32_32x32x16_bf16 v[112:127], v[60:63], a[12:15], v[112:127]
    ds_read_b64_tr_b16 v[44:45], v21 offset:18432
    ds_read_b64_tr_b16 v[46:47], v21 offset:18688
    buffer_load_dwordx4 v3, s[8:11], s60 offen offset:1024 lds
    v_mfma_f32_32x32x16_bf16 v[128:143], v[64:67], a[8:11], v[128:143]
    ds_read_b128 v[48:51], v19 offset:20480
    buffer_load_dwordx4 v4, s[8:11], s60 offen offset:2048 lds
    v_mfma_f32_32x32x16_bf16 v[144:159], v[64:67], a[12:15], v[144:159]
    buffer_load_dwordx4 v5, s[8:11], s60 offen offset:3072 lds
    v_mfma_f32_32x32x16_bf16 v[160:175], a[8:11], v[68:71], v[160:175]
    s_add_u32 m0, s57, 4096
    s_nop 0
    buffer_load_dwordx4 v6, s[8:11], s60 offen lds
    v_mfma_f32_32x32x16_bf16 v[176:191], a[12:15], v[68:71], v[176:191]
    buffer_load_dwordx4 v7, s[8:11], s60 offen offset:1024 lds
    s_waitcnt lgkmcnt(3)
    v_mfma_f32_32x32x16_bf16 v[96:111], v[40:43], a[16:19], v[96:111]
    ds_read_b64_tr_b16 v[60:61], v21 offset:15360
    ds_read_b64_tr_b16 v[62:63], v21 offset:15616
    buffer_load_dwordx4 v8, s[8:11], s60 offen offset:2048 lds
    v_mfma_f32_32x32x16_bf16 v[112:127], v[40:43], a[20:23], v[112:127]
    ds_read_b64_tr_b16 v[64:65], v21 offset:19456
    ds_read_b64_tr_b16 v[66:67], v21 offset:19712
    buffer_load_dwordx4 v9, s[8:11], s60 offen offset:3072 lds
    s_add_u32 s60, s60, 128
    s_add_u32 s61, s61, 221184
    s_waitcnt lgkmcnt(5)
    v_mfma_f32_32x32x16_bf16 v[128:143], v[44:47], a[16:19], v[128:143]
    ds_read_b128 v[68:71], v20 offset:20480
    v_mfma_f32_32x32x16_bf16 v[144:159], v[44:47], a[20:23], v[144:159]
    s_waitcnt lgkmcnt(5)
    v_mfma_f32_32x32x16_bf16 v[160:175], a[16:19], v[48:51], v[160:175]
    v_mfma_f32_32x32x16_bf16 v[176:191], a[20:23], v[48:51], v[176:191]
    s_waitcnt lgkmcnt(3)
    v_mfma_f32_32x32x16_bf16 v[96:111], v[60:63], a[24:27], v[96:111]
    s_waitcnt lgkmcnt(0)
    s_waitcnt vmcnt(16)
    s_barrier
    ds_read_b128 a[32:35], v13 offset:8192
    ds_read_b128 a[36:39], v13 offset:12288
    v_bfe_u32 v24, v1, 4, 1
    v_lshlrev_b32 v24, 5, v24
    v_mfma_f32_32x32x16_bf16 v[112:127], v[60:63], a[28:31], v[112:127]
    ds_read_b64_tr_b16 v[40:41], v21 offset:24576
    ds_read_b64_tr_b16 v[42:43], v21 offset:24832
    s_add_u32 m0, s59, 12288
    s_nop 0
    buffer_load_dwordx4 v10, s[12:15], s61 offen lds
    v_lshrrev_b32 v25, 5, v1
    v_lshl_add_u32 v24, v25, 2, v24
    v_mfma_f32_32x32x16_bf16 v[128:143], v[64:67], a[24:27], v[128:143]
    ds_read_b64_tr_b16 v[44:45], v21 offset:28672
    ds_read_b64_tr_b16 v[46:47], v21 offset:28928
    v_bfe_u32 v25, v1, 2, 2
    v_add_u32 v24, v24, v25
    s_lshl_b32 s3, s82, 6
    s_lshl_b32 s7, s4, 3
    s_add_u32 s3, s3, s7
    v_add_u32 v24, s3, v24
    v_mfma_f32_32x32x16_bf16 v[144:159], v[64:67], a[28:31], v[144:159]
    ds_read_b128 v[48:51], v17 offset:32768
    ds_read_b128 a[40:43], v14 offset:8192
    s_add_u32 m0, s59, 61440
    s_nop 0
    buffer_load_dwordx4 v11, s[12:15], s61 offen lds
    v_and_b32 v25, 3, v1
    v_mul_u32_u24 v24, 1280, v24
    v_mfma_f32_32x32x16_bf16 v[160:175], a[24:27], v[68:71], v[160:175]
    ds_read_b128 a[44:47], v14 offset:12288
    v_lshl_add_u32 v24, v25, 3, v24
    s_mul_i32 s3, s49, 160
    v_add_u32 v72, s3, v24
    s_mul_i32 s3, s49, 5
    s_lshr_b32 s3, s3, 2
    s_mul_i32 s3, s3, 14
    s_mul_i32 s7, s49, 14
    s_add_u32 s7, s7, 112
    v_mov_b32 v24, s3
    v_mov_b32 v25, s7
    s_mul_i32 s3, s4, 11
    v_min_u32 v73, 10, v1
    v_add_u32 v73, s3, v73
    v_min_u32 v73, 41, v73
    v_cmp_gt_u32 s[98:99], 28, v73
    s_nop 1
    v_cndmask_b32 v24, v25, v24, s[98:99]
    v_add_lshl_u32 v73, v73, v24, 7
    v_mfma_f32_32x32x16_bf16 v[176:191], a[28:31], v[68:71], v[176:191]
    s_add_u32 m0, s59, 16384
    s_nop 0
    buffer_load_dwordx4 v10, s[16:19], s61 offen lds
    v_cmp_lt_u32 vcc, 9, v1
    v_add_u32 v28, -10, v1
    s_xor_b32 s3, s82, 1
    v_cndmask_b32 v28, v1, v28, vcc
    v_mov_b32 v29, s3
    v_mov_b32 v27, s82
    v_cndmask_b32 v29, v29, v27, vcc
    s_cmp_eq_u32 s83, 0
    s_cselect_b32 s3, 14, 0
    s_add_u32 s3, s3, s4
    v_lshl_add_u32 v28, v28, 2, s3
    v_add_u32 v27, -27, v28
    v_mul_u32_u24 v26, 43, v27
    s_waitcnt lgkmcnt(7)
    s_waitcnt lgkmcnt(5)
    v_mfma_f32_32x32x16_bf16 v[96:111], v[40:43], a[32:35], v[96:111]
    ds_read_b64_tr_b16 v[60:61], v21 offset:25600
    ds_read_b64_tr_b16 v[62:63], v21 offset:25856
    v_lshrrev_b32 v26, 7, v26
    v_add_u32 v26, 27, v26
    v_mfma_f32_32x32x16_bf16 v[112:127], v[40:43], a[36:39], v[112:127]
    ds_read_b64_tr_b16 v[64:65], v21 offset:29696
    ds_read_b64_tr_b16 v[66:67], v21 offset:29952
    s_add_u32 m0, s59, 65536
    s_nop 0
    buffer_load_dwordx4 v11, s[16:19], s61 offen lds
    s_cmp_eq_u32 s83, 0
    s_cselect_b64 vcc, -1, 0
    v_cndmask_b32 v27, v26, v27, vcc
    v_add_u32 v27, 2048, v27
    s_waitcnt lgkmcnt(7)
    v_mfma_f32_32x32x16_bf16 v[128:143], v[44:47], a[32:35], v[128:143]
    ds_read_b128 v[68:71], v18 offset:32768
    ds_read_b128 a[48:51], v15 offset:8192
    s_lshl_b32 s3, s83, 10
    v_add_u32 v26, s3, v28
    v_cmp_gt_u32 vcc, 27, v28
    s_nop 1
    v_cndmask_b32 v27, v27, v26, vcc
    v_cmp_gt_u32 vcc, 20, v1
    v_mov_b32 v26, 2079
    s_nop 0
    v_cndmask_b32 v27, v26, v27, vcc
    v_mfma_f32_32x32x16_bf16 v[144:159], v[44:47], a[36:39], v[144:159]
    ds_read_b128 a[52:55], v15 offset:12288
    ds_read_b128 a[56:59], v16 offset:8192
    s_add_u32 m0, s59, 20480
    s_nop 0
    buffer_load_dwordx4 v12, s[20:23], s60 offen lds
    v_lshl_add_u32 v29, v29, 5, v27
    v_lshlrev_b32 v29, 7, v29
    s_waitcnt lgkmcnt(10)
    v_mfma_f32_32x32x16_bf16 v[160:175], a[32:35], v[48:51], v[160:175]
    ds_read_b128 a[60:63], v16 offset:12288
    v_and_b32 v34, 15, v1
    v_lshlrev_b32 v34, 4, v34
    s_lshl_b32 s55, s54, 11
    v_mfma_f32_32x32x16_bf16 v[176:191], a[36:39], v[48:51], v[176:191]
    s_add_u32 s55, s55, 16515072
    s_lshl_b32 s62, s5, 8
    s_add_u32 s62, s62, s55
    s_add_u32 s58, s55, 4096
    v_mov_b32 v27, 2130706432
    s_waitcnt lgkmcnt(9)
    s_waitcnt lgkmcnt(7)
    v_mfma_f32_32x32x16_bf16 v[96:111], v[60:63], a[40:43], v[96:111]
    ds_read_b64_tr_b16 v[40:41], v21 offset:26624
    ds_read_b64_tr_b16 v[42:43], v21 offset:26880
    s_waitcnt lgkmcnt(2)
    s_add_u32 m0, s57, 8192
    s_nop 0
    buffer_load_dwordx4 v2, s[8:11], s60 offen lds
    s_cmp_eq_u32 s4, 3
    s_cselect_b32 s3, 48, 64
    v_cmp_le_u32 vcc, s3, v1
    v_lshrrev_b32 v26, 4, v1
    s_nop 0
    v_cndmask_b32 v39, v27, v34, vcc
    v_mfma_f32_32x32x16_bf16 v[112:127], v[60:63], a[44:47], v[112:127]
    ds_read_b64_tr_b16 v[44:45], v21 offset:30720
    ds_read_b64_tr_b16 v[46:47], v21 offset:30976
    buffer_load_dwordx4 v3, s[8:11], s60 offen offset:1024 lds
    v_lshl_add_u32 v24, v26, 8, v34
    v_add_u32 v25, 1024, v24
    v_mfma_f32_32x32x16_bf16 v[128:143], v[64:67], a[40:43], v[128:143]
    ds_read_b128 v[48:51], v19 offset:32768
    buffer_load_dwordx4 v4, s[8:11], s60 offen offset:2048 lds
    v_cmp_le_u32 s[84:85], s5, v26
    v_add_u32 v26, 4, v26
    v_cmp_le_u32 s[86:87], s5, v26
    v_mfma_f32_32x32x16_bf16 v[144:159], v[64:67], a[44:47], v[144:159]
    buffer_load_dwordx4 v5, s[8:11], s60 offen offset:3072 lds
    s_lshl_b32 s90, s5, 2
    s_add_u32 s90, s90, s4
    v_cndmask_b32 v24, v24, v27, s[84:85]
    v_cndmask_b32 v25, v25, v27, s[86:87]
    v_mfma_f32_32x32x16_bf16 v[160:175], a[40:43], v[68:71], v[160:175]
    s_add_u32 m0, s57, 12288
    s_nop 0
    buffer_load_dwordx4 v6, s[8:11], s60 offen lds
    s_lshl_b32 s91, s90, 5
    s_add_u32 s91, s91, s6
    s_lshl_b32 s91, s91, 7
    s_mul_i32 s93, s90, 221184
    v_mfma_f32_32x32x16_bf16 v[176:191], a[44:47], v[68:71], v[176:191]
    buffer_load_dwordx4 v7, s[8:11], s60 offen offset:1024 lds
    s_lshl_b32 s92, s6, 12
    s_add_u32 s93, s93, s92
    s_add_u32 s92, s93, 110592
    s_mov_b32 s89, 0xbfb8aa3b
    s_waitcnt lgkmcnt(3)
    v_mfma_f32_32x32x16_bf16 v[96:111], v[40:43], a[48:51], v[96:111]
    ds_read_b64_tr_b16 v[60:61], v21 offset:27648
    ds_read_b64_tr_b16 v[62:63], v21 offset:27904
    buffer_load_dwordx4 v8, s[8:11], s60 offen offset:2048 lds
    s_mul_i32 s90, s90, 163840
    v_mfma_f32_32x32x16_bf16 v[112:127], v[40:43], a[52:55], v[112:127]
    ds_read_b64_tr_b16 v[64:65], v21 offset:31744
    ds_read_b64_tr_b16 v[66:67], v21 offset:32000
    buffer_load_dwordx4 v9, s[8:11], s60 offen offset:3072 lds
    s_add_u32 s60, s60, 128
    s_add_u32 s61, s61, 221184
    s_lshl_b32 s94, s54, 12
    s_add_u32 s90, s90, s94
    s_waitcnt lgkmcnt(5)
    v_mfma_f32_32x32x16_bf16 v[128:143], v[44:47], a[48:51], v[128:143]
    ds_read_b128 v[68:71], v20 offset:32768
    s_add_u32 s90, s90, 7340032
    v_bfe_u32 v28, v1, 4, 1
    v_lshlrev_b32 v28, 10, v28
    v_mfma_f32_32x32x16_bf16 v[144:159], v[44:47], a[52:55], v[144:159]
    v_lshrrev_b32 v26, 5, v1
    v_lshl_add_u32 v28, v26, 8, v28
    v_add_u32 v28, v28, v34
    s_add_u32 s94, s57, 5120
    v_and_b32 v94, 15, v1
    s_waitcnt lgkmcnt(5)
    v_mfma_f32_32x32x16_bf16 v[160:175], a[48:51], v[48:51], v[160:175]
    v_mul_u32_u24 v94, 144, v94
    v_lshrrev_b32 v95, 4, v1
    v_lshl_add_u32 v94, v95, 5, v94
    v_add_u32 v94, s94, v94
    v_mfma_f32_32x32x16_bf16 v[176:191], a[52:55], v[48:51], v[176:191]
    v_lshlrev_b32 v95, 3, v95
    v_bfe_u32 v26, v1, 2, 2
    v_add_u32 v95, v95, v26
    v_mul_u32_u24 v95, 144, v95
    v_and_b32 v26, 1, v1
    s_waitcnt lgkmcnt(3)
    v_mfma_f32_32x32x16_bf16 v[96:111], v[60:63], a[56:59], v[96:111]
    s_waitcnt lgkmcnt(0)
    s_waitcnt vmcnt(13)
    s_barrier
    ds_read_b128 a[64:67], v13 offset:0
    ds_read_b128 a[68:71], v13 offset:4096
    v_lshl_add_u32 v95, v26, 6, v95
    v_bfe_u32 v26, v1, 1, 1
    v_mfma_f32_32x32x16_bf16 v[112:127], v[60:63], a[60:63], v[112:127]
    ds_read_b64_tr_b16 v[40:41], v21 offset:0
    ds_read_b64_tr_b16 v[42:43], v21 offset:256
    s_add_u32 m0, s59, 24576
    s_nop 0
    buffer_load_dwordx4 v10, s[12:15], s61 offen lds
    v_lshl_add_u32 v95, v26, 3, v95
    v_add_u32 v95, s94, v95
    v_mfma_f32_32x32x16_bf16 v[128:143], v[64:67], a[56:59], v[128:143]
    ds_read_b64_tr_b16 v[44:45], v21 offset:4096
    ds_read_b64_tr_b16 v[46:47], v21 offset:4352
    s_cmp_eq_u32 s83, 0
    s_cselect_b32 s3, 54, 40
    s_mov_b32 s7, 7340032
    s_cmov_b32 s7, 57344
    s_lshl_b32 s3, s3, 12
    s_mul_i32 s79, s82, s3
    s_add_u32 s79, s79, s7
    s_xor_b32 s78, s82, 1
    s_mul_i32 s78, s78, s3
    s_add_u32 s78, s78, s7
    s_add_u32 s3, s4, 1
    s_and_b32 s24, s3, 3
    s_lshl_b32 s3, s24, 10
    s_mul_i32 s7, s82, 221184
    s_add_u32 s66, s7, s3
    s_add_u32 s70, s78, s3
    s_add_u32 s74, s79, s3
    s_add_u32 s3, s4, 2
    s_and_b32 s25, s3, 3
    s_lshl_b32 s3, s25, 10
    s_mul_i32 s7, s82, 221184
    s_add_u32 s67, s7, s3
    s_add_u32 s71, s78, s3
    s_add_u32 s75, s79, s3
    v_mfma_f32_32x32x16_bf16 v[144:159], v[64:67], a[60:63], v[144:159]
    ds_read_b128 v[48:51], v17 offset:8192
    ds_read_b128 a[72:75], v14 offset:0
    s_add_u32 m0, s59, 69632
    s_nop 0
    buffer_load_dwordx4 v11, s[12:15], s61 offen lds
    s_add_u32 s3, s4, 3
    s_and_b32 s26, s3, 3
    s_lshl_b32 s3, s26, 10
    s_mul_i32 s7, s82, 221184
    s_add_u32 s68, s7, s3
    s_add_u32 s72, s78, s3
    s_add_u32 s76, s79, s3
    s_add_u32 s3, s4, 4
    s_and_b32 s27, s3, 3
    s_lshl_b32 s3, s27, 10
    s_mul_i32 s7, s82, 221184
    s_add_u32 s69, s7, s3
    s_add_u32 s73, s78, s3
    s_add_u32 s77, s79, s3
    v_mfma_f32_32x32x16_bf16 v[160:175], a[56:59], v[68:71], v[160:175]
    ds_read_b128 a[76:79], v14 offset:4096
    v_mfma_f32_32x32x16_bf16 v[176:191], a[60:63], v[68:71], v[176:191]
    s_add_u32 m0, s59, 28672
    s_nop 0
    buffer_load_dwordx4 v10, s[16:19], s61 offen lds
    s_waitcnt lgkmcnt(7)
    s_waitcnt lgkmcnt(5)
    v_mfma_f32_32x32x16_bf16 v[96:111], v[40:43], a[64:67], v[96:111]
    ds_read_b64_tr_b16 v[60:61], v21 offset:1024
    ds_read_b64_tr_b16 v[62:63], v21 offset:1280
    v_mfma_f32_32x32x16_bf16 v[112:127], v[40:43], a[68:71], v[112:127]
    ds_read_b64_tr_b16 v[64:65], v21 offset:5120
    ds_read_b64_tr_b16 v[66:67], v21 offset:5376
    s_add_u32 m0, s59, 73728
    s_nop 0
    buffer_load_dwordx4 v11, s[16:19], s61 offen lds
    s_waitcnt lgkmcnt(7)
    v_mfma_f32_32x32x16_bf16 v[128:143], v[44:47], a[64:67], v[128:143]
    ds_read_b128 v[68:71], v18 offset:8192
    ds_read_b128 a[80:83], v15 offset:0
    v_mfma_f32_32x32x16_bf16 v[144:159], v[44:47], a[68:71], v[144:159]
    ds_read_b128 a[84:87], v15 offset:4096
    ds_read_b128 a[88:91], v16 offset:0
    s_add_u32 m0, s59, 32768
    s_nop 0
    buffer_load_dwordx4 v12, s[20:23], s60 offen lds
    s_waitcnt lgkmcnt(10)
    v_mfma_f32_32x32x16_bf16 v[160:175], a[64:67], v[48:51], v[160:175]
    ds_read_b128 a[92:95], v16 offset:4096
    v_mfma_f32_32x32x16_bf16 v[176:191], a[68:71], v[48:51], v[176:191]
    s_waitcnt lgkmcnt(9)
    s_waitcnt lgkmcnt(7)
    v_mfma_f32_32x32x16_bf16 v[96:111], v[60:63], a[72:75], v[96:111]
    ds_read_b64_tr_b16 v[40:41], v21 offset:2048
    ds_read_b64_tr_b16 v[42:43], v21 offset:2304
    s_waitcnt lgkmcnt(2)
    s_add_u32 m0, s57, 0
    s_nop 0
    buffer_load_dwordx4 v2, s[8:11], s60 offen lds
    v_mfma_f32_32x32x16_bf16 v[112:127], v[60:63], a[76:79], v[112:127]
    ds_read_b64_tr_b16 v[44:45], v21 offset:6144
    ds_read_b64_tr_b16 v[46:47], v21 offset:6400
    buffer_load_dwordx4 v3, s[8:11], s60 offen offset:1024 lds
    v_mfma_f32_32x32x16_bf16 v[128:143], v[64:67], a[72:75], v[128:143]
    ds_read_b128 v[48:51], v19 offset:8192
    buffer_load_dwordx4 v4, s[8:11], s60 offen offset:2048 lds
    v_mfma_f32_32x32x16_bf16 v[144:159], v[64:67], a[76:79], v[144:159]
    buffer_load_dwordx4 v5, s[8:11], s60 offen offset:3072 lds
    v_mfma_f32_32x32x16_bf16 v[160:175], a[72:75], v[68:71], v[160:175]
    s_add_u32 m0, s57, 4096
    s_nop 0
    buffer_load_dwordx4 v6, s[8:11], s60 offen lds
    v_mfma_f32_32x32x16_bf16 v[176:191], a[76:79], v[68:71], v[176:191]
    buffer_load_dwordx4 v7, s[8:11], s60 offen offset:1024 lds
    s_waitcnt lgkmcnt(3)
    v_mfma_f32_32x32x16_bf16 v[96:111], v[40:43], a[80:83], v[96:111]
    ds_read_b64_tr_b16 v[60:61], v21 offset:3072
    ds_read_b64_tr_b16 v[62:63], v21 offset:3328
    buffer_load_dwordx4 v8, s[8:11], s60 offen offset:2048 lds
    v_mfma_f32_32x32x16_bf16 v[112:127], v[40:43], a[84:87], v[112:127]
    ds_read_b64_tr_b16 v[64:65], v21 offset:7168
    ds_read_b64_tr_b16 v[66:67], v21 offset:7424
    buffer_load_dwordx4 v9, s[8:11], s60 offen offset:3072 lds
    s_add_u32 s60, s60, 128
    s_add_u32 s61, s61, 221184
    s_waitcnt lgkmcnt(5)
    v_mfma_f32_32x32x16_bf16 v[128:143], v[44:47], a[80:83], v[128:143]
    ds_read_b128 v[68:71], v20 offset:8192
    v_mfma_f32_32x32x16_bf16 v[144:159], v[44:47], a[84:87], v[144:159]
    s_waitcnt lgkmcnt(5)
    v_mfma_f32_32x32x16_bf16 v[160:175], a[80:83], v[48:51], v[160:175]
    v_mfma_f32_32x32x16_bf16 v[176:191], a[84:87], v[48:51], v[176:191]
    s_waitcnt lgkmcnt(3)
    v_mfma_f32_32x32x16_bf16 v[96:111], v[60:63], a[88:91], v[96:111]
    s_waitcnt lgkmcnt(0)
    s_waitcnt vmcnt(13)
    s_barrier
    ds_read_b128 a[96:99], v13 offset:8192
    ds_read_b128 a[100:103], v13 offset:12288
    v_mfma_f32_32x32x16_bf16 v[112:127], v[60:63], a[92:95], v[112:127]
    ds_read_b64_tr_b16 v[40:41], v21 offset:12288
    ds_read_b64_tr_b16 v[42:43], v21 offset:12544
    s_mov_b64 exec, 0x7ff
    buffer_load_dwordx2 v[92:93], v73, s[32:35], s53 offen sc1
    s_mov_b64 exec, -1
    v_mfma_f32_32x32x16_bf16 v[128:143], v[64:67], a[88:91], v[128:143]
    ds_read_b64_tr_b16 v[44:45], v21 offset:16384
    ds_read_b64_tr_b16 v[46:47], v21 offset:16640
    v_mfma_f32_32x32x16_bf16 v[144:159], v[64:67], a[92:95], v[144:159]
    ds_read_b128 v[48:51], v17 offset:20480
    ds_read_b128 a[104:107], v14 offset:8192
    s_add_u32 m0, s59, 0
    s_nop 0
    buffer_load_dwordx4 v10, s[12:15], s61 offen lds
    v_mfma_f32_32x32x16_bf16 v[160:175], a[88:91], v[68:71], v[160:175]
    ds_read_b128 a[108:111], v14 offset:12288
    v_mfma_f32_32x32x16_bf16 v[176:191], a[92:95], v[68:71], v[176:191]
    s_add_u32 m0, s59, 77824
    s_nop 0
    buffer_load_dwordx4 v11, s[12:15], s61 offen lds
    s_waitcnt lgkmcnt(7)
    s_waitcnt lgkmcnt(5)
    v_mfma_f32_32x32x16_bf16 v[96:111], v[40:43], a[96:99], v[96:111]
    ds_read_b64_tr_b16 v[60:61], v21 offset:13312
    ds_read_b64_tr_b16 v[62:63], v21 offset:13568
    v_mfma_f32_32x32x16_bf16 v[112:127], v[40:43], a[100:103], v[112:127]
    ds_read_b64_tr_b16 v[64:65], v21 offset:17408
    ds_read_b64_tr_b16 v[66:67], v21 offset:17664
    s_add_u32 m0, s59, 4096
    s_nop 0
    buffer_load_dwordx4 v10, s[16:19], s61 offen lds
    s_waitcnt lgkmcnt(7)
    v_mfma_f32_32x32x16_bf16 v[128:143], v[44:47], a[96:99], v[128:143]
    ds_read_b128 v[68:71], v18 offset:20480
    ds_read_b128 a[112:115], v15 offset:8192
    v_mfma_f32_32x32x16_bf16 v[144:159], v[44:47], a[100:103], v[144:159]
    ds_read_b128 a[116:119], v15 offset:12288
    ds_read_b128 a[120:123], v16 offset:8192
    s_add_u32 m0, s59, 81920
    s_nop 0
    buffer_load_dwordx4 v11, s[16:19], s61 offen lds
    s_waitcnt lgkmcnt(10)
    v_mfma_f32_32x32x16_bf16 v[160:175], a[96:99], v[48:51], v[160:175]
    ds_read_b128 a[124:127], v16 offset:12288
    v_mfma_f32_32x32x16_bf16 v[176:191], a[100:103], v[48:51], v[176:191]
    s_add_u32 m0, s59, 8192
    s_nop 0
    buffer_load_dwordx4 v12, s[20:23], s60 offen lds
    s_waitcnt lgkmcnt(9)
    s_waitcnt lgkmcnt(7)
    v_mfma_f32_32x32x16_bf16 v[96:111], v[60:63], a[104:107], v[96:111]
    ds_read_b64_tr_b16 v[40:41], v21 offset:14336
    ds_read_b64_tr_b16 v[42:43], v21 offset:14592
    s_waitcnt lgkmcnt(2)
    s_add_u32 m0, s57, 8192
    s_nop 0
    buffer_load_dwordx4 v2, s[8:11], s60 offen lds
    v_mfma_f32_32x32x16_bf16 v[112:127], v[60:63], a[108:111], v[112:127]
    ds_read_b64_tr_b16 v[44:45], v21 offset:18432
    ds_read_b64_tr_b16 v[46:47], v21 offset:18688
    buffer_load_dwordx4 v3, s[8:11], s60 offen offset:1024 lds
    v_mfma_f32_32x32x16_bf16 v[128:143], v[64:67], a[104:107], v[128:143]
    ds_read_b128 v[48:51], v19 offset:20480
    buffer_load_dwordx4 v4, s[8:11], s60 offen offset:2048 lds
    v_mfma_f32_32x32x16_bf16 v[144:159], v[64:67], a[108:111], v[144:159]
    buffer_load_dwordx4 v5, s[8:11], s60 offen offset:3072 lds
    v_mfma_f32_32x32x16_bf16 v[160:175], a[104:107], v[68:71], v[160:175]
    s_add_u32 m0, s57, 12288
    s_nop 0
    buffer_load_dwordx4 v6, s[8:11], s60 offen lds
    v_mfma_f32_32x32x16_bf16 v[176:191], a[108:111], v[68:71], v[176:191]
    buffer_load_dwordx4 v7, s[8:11], s60 offen offset:1024 lds
    s_waitcnt lgkmcnt(3)
    v_mfma_f32_32x32x16_bf16 v[96:111], v[40:43], a[112:115], v[96:111]
    ds_read_b64_tr_b16 v[60:61], v21 offset:15360
    ds_read_b64_tr_b16 v[62:63], v21 offset:15616
    buffer_load_dwordx4 v8, s[8:11], s60 offen offset:2048 lds
    v_mfma_f32_32x32x16_bf16 v[112:127], v[40:43], a[116:119], v[112:127]
    ds_read_b64_tr_b16 v[64:65], v21 offset:19456
    ds_read_b64_tr_b16 v[66:67], v21 offset:19712
    buffer_load_dwordx4 v9, s[8:11], s60 offen offset:3072 lds
    s_add_u32 s60, s60, 128
    s_add_u32 s61, s61, 221184
    s_waitcnt lgkmcnt(5)
    v_mfma_f32_32x32x16_bf16 v[128:143], v[44:47], a[112:115], v[128:143]
    ds_read_b128 v[68:71], v20 offset:20480
    v_mfma_f32_32x32x16_bf16 v[144:159], v[44:47], a[116:119], v[144:159]
    s_waitcnt lgkmcnt(5)
    v_mfma_f32_32x32x16_bf16 v[160:175], a[112:115], v[48:51], v[160:175]
    v_mfma_f32_32x32x16_bf16 v[176:191], a[116:119], v[48:51], v[176:191]
    s_waitcnt lgkmcnt(3)
    v_mfma_f32_32x32x16_bf16 v[96:111], v[60:63], a[120:123], v[96:111]
    s_waitcnt vmcnt(14)
    s_waitcnt vmcnt(13)
    v_cmp_eq_u64 vcc, s[50:51], v[92:93]
    s_nop 0
    s_and_b32 s3, vcc_lo, 0x7ff
    s_cmp_eq_u32 s3, 0x7ff
    s_cbranch_scc0 L_prslow_9
L_prok_10:
    s_barrier
    ds_read_b128 a[128:131], v13 offset:0
    ds_read_b128 a[132:135], v13 offset:4096
    v_mfma_f32_32x32x16_bf16 v[112:127], v[60:63], a[124:127], v[112:127]
    ds_read_b128 v[40:43], v17 offset:32768
    ds_read_b128 a[136:139], v14 offset:0
    buffer_load_dwordx2 a[240:241], v72, s[8:11], 0 offen offset:0
    s_waitcnt lgkmcnt(5)
    v_mfma_f32_32x32x16_bf16 v[128:143], v[64:67], a[120:123], v[128:143]
    ds_read_b128 a[140:143], v14 offset:4096
    ds_read_b128 v[44:47], v18 offset:32768
    v_mfma_f32_32x32x16_bf16 v[144:159], v[64:67], a[124:127], v[144:159]
    ds_read_b128 a[144:147], v15 offset:0
    ds_read_b128 a[148:151], v15 offset:4096
    buffer_load_dwordx2 a[242:243], v72, s[8:11], 0 offen offset:32
    s_waitcnt lgkmcnt(8)
    v_mfma_f32_32x32x16_bf16 v[160:175], a[120:123], v[68:71], v[160:175]
    ds_read_b128 v[48:51], v19 offset:32768
    ds_read_b128 a[152:155], v16 offset:0
    v_mfma_f32_32x32x16_bf16 v[176:191], a[124:127], v[68:71], v[176:191]
    ds_read_b128 a[156:159], v16 offset:4096
    ds_read_b128 v[52:55], v20 offset:32768
    buffer_load_dwordx2 a[244:245], v72, s[8:11], 0 offen offset:64
    s_waitcnt lgkmcnt(9)
    v_mfma_f32_32x32x16_bf16 v[160:175], a[128:131], v[40:43], v[160:175]
    s_waitcnt vmcnt(3)
    s_barrier
    ds_read_b128 a[160:163], v13 offset:8192
    ds_read_b128 a[164:167], v13 offset:12288
    v_mfma_f32_32x32x16_bf16 v[176:191], a[132:135], v[40:43], v[176:191]
    ds_read_b128 v[56:59], v17 offset:8192
    ds_read_b128 a[168:171], v14 offset:8192
    buffer_load_dwordx2 a[246:247], v72, s[8:11], 0 offen offset:96
    s_waitcnt lgkmcnt(10)
    v_mfma_f32_32x32x16_bf16 v[160:175], a[136:139], v[44:47], v[160:175]
    ds_read_b128 a[172:175], v14 offset:12288
    ds_read_b128 v[60:63], v18 offset:8192
    v_mfma_f32_32x32x16_bf16 v[176:191], a[140:143], v[44:47], v[176:191]
    ds_read_b128 a[176:179], v15 offset:8192
    ds_read_b128 a[180:183], v15 offset:12288
    buffer_load_dwordx2 a[248:249], v72, s[8:11], 0 offen offset:128
    s_waitcnt lgkmcnt(11)
    v_mfma_f32_32x32x16_bf16 v[160:175], a[144:147], v[48:51], v[160:175]
    ds_read_b128 v[40:43], v19 offset:8192
    ds_read_b128 a[184:187], v16 offset:8192
    v_mfma_f32_32x32x16_bf16 v[176:191], a[148:151], v[48:51], v[176:191]
    ds_read_b128 a[188:191], v16 offset:12288
    ds_read_b128 v[44:47], v20 offset:8192
    s_add_u32 s56, s88, 819200
    buffer_load_dwordx4 a[192:195], v30, s[32:35], s56 offen offset:3072 sc1
    s_waitcnt lgkmcnt(12)
    v_mfma_f32_32x32x16_bf16 v[160:175], a[152:155], v[52:55], v[160:175]
    ds_read_b64_tr_b16 v[48:49], v21 offset:24576
    ds_read_b64_tr_b16 v[50:51], v21 offset:24832
    v_mfma_f32_32x32x16_bf16 v[176:191], a[156:159], v[52:55], v[176:191]
    ds_read_b64_tr_b16 v[52:53], v21 offset:28672
    ds_read_b64_tr_b16 v[54:55], v21 offset:28928
    buffer_load_dwordx4 a[196:199], v31, s[32:35], s56 offen offset:0 sc1
    s_waitcnt lgkmcnt(13)
    v_mfma_f32_32x32x16_bf16 v[160:175], a[160:163], v[56:59], v[160:175]
    v_mfma_f32_32x32x16_bf16 v[176:191], a[164:167], v[56:59], v[176:191]
    ds_read_b64_tr_b16 v[56:57], v21 offset:25600
    ds_read_b64_tr_b16 v[58:59], v21 offset:25856
    s_add_u32 s56, s88, 983040
    buffer_load_dwordx4 a[200:203], v30, s[32:35], s56 offen offset:0 sc1
    s_waitcnt lgkmcnt(12)
    v_mfma_f32_32x32x16_bf16 v[160:175], a[168:171], v[60:63], v[160:175]
    v_mfma_f32_32x32x16_bf16 v[176:191], a[172:175], v[60:63], v[176:191]
    ds_read_b64_tr_b16 v[60:61], v21 offset:29696
    ds_read_b64_tr_b16 v[62:63], v21 offset:29952
    buffer_load_dwordx4 a[204:207], v30, s[32:35], s56 offen offset:1024 sc1
    s_waitcnt lgkmcnt(11)
    v_mfma_f32_32x32x16_bf16 v[160:175], a[176:179], v[40:43], v[160:175]
    v_mfma_f32_32x32x16_bf16 v[176:191], a[180:183], v[40:43], v[176:191]
    ds_read_b64_tr_b16 v[40:41], v21 offset:26624
    ds_read_b64_tr_b16 v[42:43], v21 offset:26880
    buffer_load_dwordx4 a[208:211], v30, s[32:35], s56 offen offset:2048 sc1
    s_waitcnt lgkmcnt(10)
    v_mfma_f32_32x32x16_bf16 v[160:175], a[184:187], v[44:47], v[160:175]
    v_mfma_f32_32x32x16_bf16 v[176:191], a[188:191], v[44:47], v[176:191]
    ds_read_b64_tr_b16 v[44:45], v21 offset:30720
    ds_read_b64_tr_b16 v[46:47], v21 offset:30976
    buffer_load_dwordx4 a[212:215], v30, s[32:35], s56 offen offset:3072 sc1
    s_waitcnt lgkmcnt(10)
    v_mfma_f32_32x32x16_bf16 v[96:111], v[48:51], a[128:131], v[96:111]
    s_nop 6
    v_permlane16_swap_b32 v160, v176
    v_permlane16_swap_b32 v161, v177
    v_permlane16_swap_b32 v162, v178
    v_permlane16_swap_b32 v163, v179
    v_permlane16_swap_b32 v164, v180
    v_permlane16_swap_b32 v165, v181
    v_mfma_f32_32x32x16_bf16 v[112:127], v[48:51], a[132:135], v[112:127]
    ds_read_b64_tr_b16 v[48:49], v21 offset:27648
    ds_read_b64_tr_b16 v[50:51], v21 offset:27904
    buffer_load_dwordx4 a[216:219], v31, s[32:35], s56 offen offset:0 sc1
    v_permlane16_swap_b32 v166, v182
    v_permlane16_swap_b32 v167, v183
    v_permlane16_swap_b32 v168, v184
    v_permlane16_swap_b32 v169, v185
    s_waitcnt lgkmcnt(10)
    v_mfma_f32_32x32x16_bf16 v[128:143], v[52:55], a[128:131], v[128:143]
    v_permlane16_swap_b32 v170, v186
    v_permlane16_swap_b32 v171, v187
    v_permlane16_swap_b32 v172, v188
    v_permlane16_swap_b32 v173, v189
    v_permlane16_swap_b32 v174, v190
    v_permlane16_swap_b32 v175, v191
    v_mfma_f32_32x32x16_bf16 v[144:159], v[52:55], a[132:135], v[144:159]
    ds_read_b64_tr_b16 v[52:53], v21 offset:31744
    ds_read_b64_tr_b16 v[54:55], v21 offset:32000
    s_add_u32 s56, s88, 1146880
    buffer_load_dwordx4 a[220:223], v30, s[32:35], s56 offen offset:0 sc1
    v_fma_f32 v10, v80, v160, v161
    v_fma_f32 v11, v80, v176, v177
    v_fma_f32 v10, -v81, v176, v10
    v_fmac_f32 v11, v81, v160
    s_waitcnt lgkmcnt(10)
    v_mfma_f32_32x32x16_bf16 v[96:111], v[56:59], a[136:139], v[96:111]
    v_fma_f32 v12, v80, v10, v162
    v_fma_f32 v13, v80, v11, v178
    v_fma_f32 v12, -v81, v11, v12
    v_fmac_f32 v13, v81, v10
    v_fma_f32 v10, v80, v12, v163
    v_fma_f32 v11, v80, v13, v179
    v_mfma_f32_32x32x16_bf16 v[112:127], v[56:59], a[140:143], v[112:127]
    ds_read_b64_tr_b16 v[56:57], v21 offset:0
    ds_read_b64_tr_b16 v[58:59], v21 offset:256
    buffer_load_dwordx4 a[224:227], v30, s[32:35], s56 offen offset:1024 sc1
    v_fma_f32 v10, -v81, v13, v10
    v_fmac_f32 v11, v81, v12
    v_fma_f32 v12, v80, v10, v164
    v_fma_f32 v13, v80, v11, v180
    s_waitcnt lgkmcnt(10)
    v_mfma_f32_32x32x16_bf16 v[128:143], v[60:63], a[136:139], v[128:143]
    v_fma_f32 v12, -v81, v11, v12
    v_fmac_f32 v13, v81, v10
    v_fma_f32 v10, v80, v12, v165
    v_fma_f32 v11, v80, v13, v181
    v_fma_f32 v10, -v81, v13, v10
    v_fmac_f32 v11, v81, v12
    v_mfma_f32_32x32x16_bf16 v[144:159], v[60:63], a[140:143], v[144:159]
    ds_read_b64_tr_b16 v[60:61], v21 offset:4096
    ds_read_b64_tr_b16 v[62:63], v21 offset:4352
    buffer_load_dwordx4 a[228:231], v30, s[32:35], s56 offen offset:2048 sc1
    v_fma_f32 v12, v80, v10, v166
    v_fma_f32 v13, v80, v11, v182
    v_fma_f32 v12, -v81, v11, v12
    v_fmac_f32 v13, v81, v10
    s_waitcnt lgkmcnt(10)
    v_mfma_f32_32x32x16_bf16 v[96:111], v[40:43], a[144:147], v[96:111]
    v_fma_f32 v10, v80, v12, v167
    v_fma_f32 v11, v80, v13, v183
    v_fma_f32 v10, -v81, v13, v10
    v_fmac_f32 v11, v81, v12
    v_fma_f32 v12, v80, v10, v168
    v_fma_f32 v13, v80, v11, v184
    v_mfma_f32_32x32x16_bf16 v[112:127], v[40:43], a[148:151], v[112:127]
    ds_read_b64_tr_b16 v[40:41], v21 offset:1024
    ds_read_b64_tr_b16 v[42:43], v21 offset:1280
    buffer_load_dwordx4 a[232:235], v30, s[32:35], s56 offen offset:3072 sc1
    v_fma_f32 v12, -v81, v11, v12
    v_fmac_f32 v13, v81, v10
    v_fma_f32 v10, v80, v12, v169
    v_fma_f32 v11, v80, v13, v185
    s_waitcnt lgkmcnt(10)
    v_mfma_f32_32x32x16_bf16 v[128:143], v[44:47], a[144:147], v[128:143]
    v_fma_f32 v10, -v81, v13, v10
    v_fmac_f32 v11, v81, v12
    v_fma_f32 v12, v80, v10, v170
    v_fma_f32 v13, v80, v11, v186
    v_fma_f32 v12, -v81, v11, v12
    v_fmac_f32 v13, v81, v10
    v_mfma_f32_32x32x16_bf16 v[144:159], v[44:47], a[148:151], v[144:159]
    ds_read_b64_tr_b16 v[44:45], v21 offset:5120
    ds_read_b64_tr_b16 v[46:47], v21 offset:5376
    buffer_load_dwordx4 a[236:239], v31, s[32:35], s56 offen offset:0 sc1
    v_fma_f32 v10, v80, v12, v171
    v_fma_f32 v11, v80, v13, v187
    v_fma_f32 v10, -v81, v13, v10
    v_fmac_f32 v11, v81, v12
    s_waitcnt lgkmcnt(10)
    v_mfma_f32_32x32x16_bf16 v[96:111], v[48:51], a[152:155], v[96:111]
    v_fma_f32 v12, v80, v10, v172
    v_fma_f32 v13, v80, v11, v188
    v_fma_f32 v12, -v81, v11, v12
    v_fmac_f32 v13, v81, v10
    v_fma_f32 v10, v80, v12, v173
    v_fma_f32 v11, v80, v13, v189
    v_mfma_f32_32x32x16_bf16 v[112:127], v[48:51], a[156:159], v[112:127]
    ds_read_b64_tr_b16 v[48:49], v21 offset:2048
    ds_read_b64_tr_b16 v[50:51], v21 offset:2304
    s_add_u32 s56, s88, 1310720
    s_add_u32 m0, s57, 0
    s_nop 0
    buffer_load_dwordx4 v30, s[32:35], s56 offen offset:0 sc1 lds
    v_fma_f32 v10, -v81, v13, v10
    v_fmac_f32 v11, v81, v12
    v_fma_f32 v12, v80, v10, v174
    v_fma_f32 v13, v80, v11, v190
    s_waitcnt lgkmcnt(10)
    v_mfma_f32_32x32x16_bf16 v[128:143], v[52:55], a[152:155], v[128:143]
    v_fma_f32 v12, -v81, v11, v12
    v_fmac_f32 v13, v81, v10
    v_fma_f32 v10, v80, v12, v175
    v_fma_f32 v11, v80, v13, v191
    v_fma_f32 v10, -v81, v13, v10
    v_fmac_f32 v11, v81, v12
    v_mfma_f32_32x32x16_bf16 v[144:159], v[52:55], a[156:159], v[144:159]
    ds_read_b64_tr_b16 v[52:53], v21 offset:6144
    ds_read_b64_tr_b16 v[54:55], v21 offset:6400
    buffer_load_dwordx4 v30, s[32:35], s56 offen offset:1024 sc1 lds
    ds_write_b64 v35, v[10:11] offset:2048
    s_waitcnt lgkmcnt(0)
    s_barrier
    ds_read_b64 v[64:65], v35 offset:0
    ds_read_b64 v[66:67], v35 offset:128
    v_mfma_f32_32x32x16_bf16 v[96:111], v[56:59], a[160:163], v[96:111]
    ds_read_b64 v[68:69], v35 offset:256
    ds_read_b64 v[70:71], v35 offset:384
    ds_read_b64 v[72:73], v35 offset:512
    ds_read_b64 v[74:75], v35 offset:640
    ds_read_b64 v[76:77], v35 offset:768
    ds_read_b64 v[78:79], v35 offset:896
    s_waitcnt lgkmcnt(0)
    v_mfma_f32_32x32x16_bf16 v[112:127], v[56:59], a[164:167], v[112:127]
    ds_read_b64_tr_b16 v[56:57], v21 offset:3072
    ds_read_b64_tr_b16 v[58:59], v21 offset:3328
    buffer_load_dwordx4 v30, s[32:35], s56 offen offset:2048 sc1 lds
    v_fma_f32 v12, v84, v66, v68
    v_fma_f32 v13, v84, v67, v69
    v_fma_f32 v12, -v85, v67, v12
    v_fmac_f32 v13, v85, v66
    v_mfma_f32_32x32x16_bf16 v[128:143], v[60:63], a[160:163], v[128:143]
    v_fma_f32 v16, v84, v12, v70
    v_fma_f32 v17, v84, v13, v71
    v_fma_f32 v16, -v85, v13, v16
    v_fmac_f32 v17, v85, v12
    v_fma_f32 v12, v84, v16, v72
    v_fma_f32 v13, v84, v17, v73
    v_fma_f32 v12, -v85, v17, v12
    v_mfma_f32_32x32x16_bf16 v[144:159], v[60:63], a[164:167], v[144:159]
    ds_read_b64_tr_b16 v[60:61], v21 offset:7168
    ds_read_b64_tr_b16 v[62:63], v21 offset:7424
    buffer_load_dwordx4 v30, s[32:35], s56 offen offset:3072 sc1 lds
    v_fmac_f32 v13, v85, v16
    v_fma_f32 v16, v84, v12, v74
    v_fma_f32 v17, v84, v13, v75
    v_fma_f32 v16, -v85, v13, v16
    v_mfma_f32_32x32x16_bf16 v[96:111], v[40:43], a[168:171], v[96:111]
    v_fmac_f32 v17, v85, v12
    v_fma_f32 v12, v84, v16, v76
    v_fma_f32 v13, v84, v17, v77
    v_fma_f32 v12, -v85, v17, v12
    v_fmac_f32 v13, v85, v16
    v_fma_f32 v16, v84, v12, v78
    v_fma_f32 v17, v84, v13, v79
    v_mfma_f32_32x32x16_bf16 v[112:127], v[40:43], a[172:175], v[112:127]
    ds_read_b64_tr_b16 v[40:41], v22 offset:0
    ds_read_b64_tr_b16 v[42:43], v22 offset:256
    s_add_u32 m0, s57, 4096
    s_nop 0
    buffer_load_dwordx4 v31, s[32:35], s56 offen offset:0 sc1 lds
    v_fma_f32 v16, -v85, v13, v16
    v_fmac_f32 v17, v85, v12
    ds_read_b64 v[64:65], v35 offset:1024
    ds_read_b64 v[66:67], v35 offset:1152
    v_mfma_f32_32x32x16_bf16 v[128:143], v[44:47], a[168:171], v[128:143]
    ds_read_b64 v[68:69], v35 offset:1280
    ds_read_b64 v[70:71], v35 offset:1408
    ds_read_b64 v[72:73], v35 offset:1536
    ds_read_b64 v[74:75], v35 offset:1664
    ds_read_b64 v[76:77], v35 offset:1792
    ds_read_b64 v[78:79], v35 offset:1920
    s_waitcnt lgkmcnt(0)
    v_mfma_f32_32x32x16_bf16 v[144:159], v[44:47], a[172:175], v[144:159]
    ds_read_b64_tr_b16 v[44:45], v22 offset:4096
    ds_read_b64_tr_b16 v[46:47], v22 offset:4352
    s_add_u32 s56, s88, 1474560
    s_add_u32 m0, s57, 11264
    s_nop 0
    buffer_load_dwordx4 v30, s[32:35], s56 offen offset:0 sc1 lds
    v_fma_f32 v12, v84, v16, v64
    v_fma_f32 v13, v84, v17, v65
    v_fma_f32 v12, -v85, v17, v12
    v_fmac_f32 v13, v85, v16
    v_mfma_f32_32x32x16_bf16 v[96:111], v[48:51], a[176:179], v[96:111]
    v_fma_f32 v16, v84, v12, v66
    v_fma_f32 v17, v84, v13, v67
    v_fma_f32 v16, -v85, v13, v16
    v_fmac_f32 v17, v85, v12
    v_fma_f32 v12, v84, v16, v68
    v_fma_f32 v13, v84, v17, v69
    v_fma_f32 v12, -v85, v17, v12
    v_mfma_f32_32x32x16_bf16 v[112:127], v[48:51], a[180:183], v[112:127]
    ds_read_b64_tr_b16 v[48:49], v22 offset:1024
    ds_read_b64_tr_b16 v[50:51], v22 offset:1280
    buffer_load_dwordx4 v30, s[32:35], s56 offen offset:1024 sc1 lds
    v_fmac_f32 v13, v85, v16
    v_fma_f32 v16, v84, v12, v70
    v_fma_f32 v17, v84, v13, v71
    v_fma_f32 v16, -v85, v13, v16
    v_mfma_f32_32x32x16_bf16 v[128:143], v[52:55], a[176:179], v[128:143]
    v_fmac_f32 v17, v85, v12
    v_fma_f32 v12, v84, v16, v72
    v_fma_f32 v13, v84, v17, v73
    v_fma_f32 v12, -v85, v17, v12
    v_fmac_f32 v13, v85, v16
    v_fma_f32 v16, v84, v12, v74
    v_fma_f32 v17, v84, v13, v75
    v_mfma_f32_32x32x16_bf16 v[144:159], v[52:55], a[180:183], v[144:159]
    ds_read_b64_tr_b16 v[52:53], v22 offset:5120
    ds_read_b64_tr_b16 v[54:55], v22 offset:5376
    buffer_load_dwordx4 v30, s[32:35], s56 offen offset:2048 sc1 lds
    v_fma_f32 v16, -v85, v13, v16
    v_fmac_f32 v17, v85, v12
    v_fma_f32 v12, v84, v16, v76
    v_fma_f32 v13, v84, v17, v77
    v_mfma_f32_32x32x16_bf16 v[96:111], v[56:59], a[184:187], v[96:111]
    v_fma_f32 v12, -v85, v17, v12
    v_fmac_f32 v13, v85, v16
    v_fma_f32 v16, v84, v12, v78
    v_fma_f32 v17, v84, v13, v79
    v_fma_f32 v16, -v85, v13, v16
    v_fmac_f32 v17, v85, v12
    v_fma_f32 v64, v84, v16, v10
    v_mfma_f32_32x32x16_bf16 v[112:127], v[56:59], a[188:191], v[112:127]
    ds_read_b64_tr_b16 v[56:57], v22 offset:2048
    ds_read_b64_tr_b16 v[58:59], v22 offset:2304
    buffer_load_dwordx4 v30, s[32:35], s56 offen offset:3072 sc1 lds
    v_fma_f32 v65, v84, v17, v11
    v_fma_f32 v64, -v85, v17, v64
    v_fmac_f32 v65, v85, v16
    v_mov_b32 v66, s50
    v_mfma_f32_32x32x16_bf16 v[128:143], v[60:63], a[184:187], v[128:143]
    v_mov_b32 v67, s51
    buffer_store_dwordx4 v[64:67], v39, s[32:35], s62 offen offset:0 sc1
    v_mfma_f32_32x32x16_bf16 v[144:159], v[60:63], a[188:191], v[144:159]
    ds_read_b64_tr_b16 v[60:61], v22 offset:6144
    ds_read_b64_tr_b16 v[62:63], v22 offset:6400
    s_add_u32 m0, s57, 15360
    s_nop 0
    buffer_load_dwordx4 v31, s[32:35], s56 offen offset:0 sc1 lds
    v_mfma_f32_32x32x16_bf16 v[192:207], v[40:43], a[0:3], v[192:207]
    s_nop 2
    v_mul_f32 v128, v128, v96
    v_mul_f32 v96, s89, v96
    v_mul_f32 v129, v129, v97
    v_mul_f32 v97, s89, v97
    v_mul_f32 v130, v130, v98
    v_mul_f32 v98, s89, v98
    v_mul_f32 v131, v131, v99
    v_mfma_f32_32x32x16_bf16 v[208:223], v[40:43], a[4:7], v[208:223]
    ds_read_b64_tr_b16 v[40:41], v22 offset:3072
    ds_read_b64_tr_b16 v[42:43], v22 offset:3328
    v_mul_f32 v99, s89, v99
    v_mul_f32 v132, v132, v100
    v_mul_f32 v100, s89, v100
    v_mul_f32 v133, v133, v101
    v_mul_f32 v101, s89, v101
    s_waitcnt lgkmcnt(10)
    v_mfma_f32_32x32x16_bf16 v[224:239], v[44:47], a[0:3], v[224:239]
    v_mul_f32 v134, v134, v102
    v_mul_f32 v102, s89, v102
    v_mul_f32 v135, v135, v103
    v_mul_f32 v103, s89, v103
    v_exp_f32 v96, v96
    v_mfma_f32_32x32x16_bf16 v[240:255], v[44:47], a[4:7], v[240:255]
    ds_read_b64_tr_b16 v[44:45], v22 offset:7168
    ds_read_b64_tr_b16 v[46:47], v22 offset:7424
    v_exp_f32 v97, v97
    v_exp_f32 v98, v98
    v_exp_f32 v99, v99
    s_waitcnt lgkmcnt(10)
    v_mfma_f32_32x32x16_bf16 v[192:207], v[48:51], a[8:11], v[192:207]
    v_exp_f32 v100, v100
    v_exp_f32 v101, v101
    v_exp_f32 v102, v102
    v_mfma_f32_32x32x16_bf16 v[208:223], v[48:51], a[12:15], v[208:223]
    ds_read_b64_tr_b16 v[48:49], v22 offset:8192
    ds_read_b64_tr_b16 v[50:51], v22 offset:8448
    s_mov_b32 s56, 12582912
    buffer_load_dwordx4 a[0:3], v30, s[32:35], s56 offen offset:0 sc1
    v_exp_f32 v103, v103
    v_add_f32 v96, 1.0, v96
    v_add_f32 v97, 1.0, v97
    s_waitcnt lgkmcnt(10)
    v_mfma_f32_32x32x16_bf16 v[224:239], v[52:55], a[8:11], v[224:239]
    v_add_f32 v98, 1.0, v98
    v_add_f32 v99, 1.0, v99
    v_add_f32 v100, 1.0, v100
    v_add_f32 v101, 1.0, v101
    v_add_f32 v102, 1.0, v102
    v_add_f32 v103, 1.0, v103
    v_mfma_f32_32x32x16_bf16 v[240:255], v[52:55], a[12:15], v[240:255]
    ds_read_b64_tr_b16 v[52:53], v22 offset:12288
    ds_read_b64_tr_b16 v[54:55], v22 offset:12544
    buffer_load_dwordx4 a[4:7], v30, s[32:35], s56 offen offset:1024 sc1
    v_rcp_f32 v96, v96
    v_rcp_f32 v97, v97
    s_waitcnt lgkmcnt(10)
    v_mfma_f32_32x32x16_bf16 v[192:207], v[56:59], a[16:19], v[192:207]
    v_rcp_f32 v98, v98
    v_rcp_f32 v99, v99
    v_rcp_f32 v100, v100
    v_mfma_f32_32x32x16_bf16 v[208:223], v[56:59], a[20:23], v[208:223]
    ds_read_b64_tr_b16 v[56:57], v22 offset:9216
    ds_read_b64_tr_b16 v[58:59], v22 offset:9472
    buffer_load_dwordx4 a[8:11], v30, s[32:35], s56 offen offset:2048 sc1
    v_rcp_f32 v101, v101
    v_rcp_f32 v102, v102
    s_waitcnt lgkmcnt(10)
    v_mfma_f32_32x32x16_bf16 v[224:239], v[60:63], a[16:19], v[224:239]
    v_rcp_f32 v103, v103
    v_mul_f32 v128, v128, v96
    v_mul_f32 v129, v129, v97
    v_mul_f32 v130, v130, v98
    v_mul_f32 v131, v131, v99
    v_mfma_f32_32x32x16_bf16 v[240:255], v[60:63], a[20:23], v[240:255]
    ds_read_b64_tr_b16 v[60:61], v22 offset:13312
    ds_read_b64_tr_b16 v[62:63], v22 offset:13568
    buffer_load_dwordx4 a[12:15], v30, s[32:35], s56 offen offset:3072 sc1
    v_mul_f32 v132, v132, v100
    v_mul_f32 v133, v133, v101
    v_mul_f32 v134, v134, v102
    v_mul_f32 v135, v135, v103
    s_waitcnt lgkmcnt(10)
    v_mfma_f32_32x32x16_bf16 v[192:207], v[40:43], a[24:27], v[192:207]
    v_cvt_pk_bf16_f32 v96, v128, v129
    v_cvt_pk_bf16_f32 v97, v130, v131
    v_cvt_pk_bf16_f32 v98, v132, v133
    v_cvt_pk_bf16_f32 v99, v134, v135
    buffer_store_dwordx4 v[96:99], v28, s[32:35], s93 offen offset:0 sc1
    v_mul_f32 v136, v136, v104
    v_mfma_f32_32x32x16_bf16 v[208:223], v[40:43], a[28:31], v[208:223]
    ds_read_b64_tr_b16 v[40:41], v22 offset:10240
    ds_read_b64_tr_b16 v[42:43], v22 offset:10496
    buffer_load_dwordx4 a[16:19], v31, s[32:35], s56 offen offset:0 sc1
    v_mul_f32 v104, s89, v104
    v_mul_f32 v137, v137, v105
    v_mul_f32 v105, s89, v105
    v_mul_f32 v138, v138, v106
    s_waitcnt lgkmcnt(10)
    v_mfma_f32_32x32x16_bf16 v[224:239], v[44:47], a[24:27], v[224:239]
    v_mul_f32 v106, s89, v106
    v_mul_f32 v139, v139, v107
    v_mul_f32 v107, s89, v107
    v_mul_f32 v140, v140, v108
    v_mul_f32 v108, s89, v108
    v_mul_f32 v141, v141, v109
    v_mfma_f32_32x32x16_bf16 v[240:255], v[44:47], a[28:31], v[240:255]
    ds_read_b64_tr_b16 v[44:45], v22 offset:14336
    ds_read_b64_tr_b16 v[46:47], v22 offset:14592
    s_mov_b32 s56, 12746752
    buffer_load_dwordx4 a[20:23], v30, s[32:35], s56 offen offset:0 sc1
    v_mul_f32 v109, s89, v109
    v_mul_f32 v142, v142, v110
    v_mul_f32 v110, s89, v110
    v_mul_f32 v143, v143, v111
    s_waitcnt lgkmcnt(10)
    v_mfma_f32_32x32x16_bf16 v[192:207], v[48:51], a[32:35], v[192:207]
    v_mul_f32 v111, s89, v111
    v_exp_f32 v104, v104
    v_exp_f32 v105, v105
    v_exp_f32 v106, v106
    v_mfma_f32_32x32x16_bf16 v[208:223], v[48:51], a[36:39], v[208:223]
    ds_read_b64_tr_b16 v[48:49], v22 offset:11264
    ds_read_b64_tr_b16 v[50:51], v22 offset:11520
    buffer_load_dwordx4 a[24:27], v30, s[32:35], s56 offen offset:1024 sc1
    v_exp_f32 v107, v107
    v_exp_f32 v108, v108
    s_waitcnt lgkmcnt(10)
    v_mfma_f32_32x32x16_bf16 v[224:239], v[52:55], a[32:35], v[224:239]
    v_exp_f32 v109, v109
    v_exp_f32 v110, v110
    v_exp_f32 v111, v111
    v_mfma_f32_32x32x16_bf16 v[240:255], v[52:55], a[36:39], v[240:255]
    ds_read_b64_tr_b16 v[52:53], v22 offset:15360
    ds_read_b64_tr_b16 v[54:55], v22 offset:15616
    buffer_load_dwordx4 a[28:31], v30, s[32:35], s56 offen offset:2048 sc1
    v_add_f32 v104, 1.0, v104
    v_add_f32 v105, 1.0, v105
    v_add_f32 v106, 1.0, v106
    v_add_f32 v107, 1.0, v107
    s_waitcnt lgkmcnt(10)
    v_mfma_f32_32x32x16_bf16 v[192:207], v[56:59], a[40:43], v[192:207]
    v_add_f32 v108, 1.0, v108
    v_add_f32 v109, 1.0, v109
    v_add_f32 v110, 1.0, v110
    v_add_f32 v111, 1.0, v111
    v_rcp_f32 v104, v104
    v_mfma_f32_32x32x16_bf16 v[208:223], v[56:59], a[44:47], v[208:223]
    ds_read_b64_tr_b16 v[56:57], v22 offset:16384
    ds_read_b64_tr_b16 v[58:59], v22 offset:16640
    buffer_load_dwordx4 a[32:35], v30, s[32:35], s56 offen offset:3072 sc1
    v_rcp_f32 v105, v105
    v_rcp_f32 v106, v106
    s_waitcnt lgkmcnt(10)
    v_mfma_f32_32x32x16_bf16 v[224:239], v[60:63], a[40:43], v[224:239]
    v_rcp_f32 v107, v107
    v_rcp_f32 v108, v108
    v_rcp_f32 v109, v109
    v_mfma_f32_32x32x16_bf16 v[240:255], v[60:63], a[44:47], v[240:255]
    ds_read_b64_tr_b16 v[60:61], v22 offset:20480
    ds_read_b64_tr_b16 v[62:63], v22 offset:20736
    buffer_load_dwordx4 a[36:39], v31, s[32:35], s56 offen offset:0 sc1
    v_rcp_f32 v110, v110
    v_rcp_f32 v111, v111
    s_waitcnt lgkmcnt(10)
    v_mfma_f32_32x32x16_bf16 v[192:207], v[40:43], a[48:51], v[192:207]
    v_mul_f32 v136, v136, v104
    v_mul_f32 v137, v137, v105
    v_mul_f32 v138, v138, v106
    v_mul_f32 v139, v139, v107
    v_mul_f32 v140, v140, v108
    v_mul_f32 v141, v141, v109
    v_mfma_f32_32x32x16_bf16 v[208:223], v[40:43], a[52:55], v[208:223]
    ds_read_b64_tr_b16 v[40:41], v22 offset:17408
    ds_read_b64_tr_b16 v[42:43], v22 offset:17664
    s_mov_b32 s56, 12910592
    buffer_load_dwordx4 a[40:43], v30, s[32:35], s56 offen offset:0 sc1
    v_mul_f32 v142, v142, v110
    v_mul_f32 v143, v143, v111
    v_cvt_pk_bf16_f32 v104, v136, v137
    v_cvt_pk_bf16_f32 v105, v138, v139
    s_waitcnt lgkmcnt(10)
    v_mfma_f32_32x32x16_bf16 v[224:239], v[44:47], a[48:51], v[224:239]
    v_cvt_pk_bf16_f32 v106, v140, v141
    v_cvt_pk_bf16_f32 v107, v142, v143
    buffer_store_dwordx4 v[104:107], v28, s[32:35], s93 offen offset:512 sc1
    v_mul_f32 v144, v144, v112
    v_mul_f32 v112, s89, v112
    v_mul_f32 v145, v145, v113
    v_mfma_f32_32x32x16_bf16 v[240:255], v[44:47], a[52:55], v[240:255]
    ds_read_b64_tr_b16 v[44:45], v22 offset:21504
    ds_read_b64_tr_b16 v[46:47], v22 offset:21760
    buffer_load_dwordx4 a[44:47], v30, s[32:35], s56 offen offset:1024 sc1
    v_mul_f32 v113, s89, v113
    v_mul_f32 v146, v146, v114
    v_mul_f32 v114, s89, v114
    v_mul_f32 v147, v147, v115
    s_waitcnt lgkmcnt(10)
    v_mfma_f32_32x32x16_bf16 v[192:207], v[48:51], a[56:59], v[192:207]
    v_mul_f32 v115, s89, v115
    v_mul_f32 v148, v148, v116
    v_mul_f32 v116, s89, v116
    v_mul_f32 v149, v149, v117
    v_mul_f32 v117, s89, v117
    v_mul_f32 v150, v150, v118
    v_mfma_f32_32x32x16_bf16 v[208:223], v[48:51], a[60:63], v[208:223]
    ds_read_b64_tr_b16 v[48:49], v22 offset:18432
    ds_read_b64_tr_b16 v[50:51], v22 offset:18688
    buffer_load_dwordx4 a[48:51], v30, s[32:35], s56 offen offset:2048 sc1
    v_mul_f32 v118, s89, v118
    v_mul_f32 v151, v151, v119
    v_mul_f32 v119, s89, v119
    v_exp_f32 v112, v112
    s_waitcnt lgkmcnt(10)
    v_mfma_f32_32x32x16_bf16 v[224:239], v[52:55], a[56:59], v[224:239]
    v_exp_f32 v113, v113
    v_exp_f32 v114, v114
    v_exp_f32 v115, v115
    v_mfma_f32_32x32x16_bf16 v[240:255], v[52:55], a[60:63], v[240:255]
    ds_read_b64_tr_b16 v[52:53], v22 offset:22528
    ds_read_b64_tr_b16 v[54:55], v22 offset:22784
    buffer_load_dwordx4 a[52:55], v30, s[32:35], s56 offen offset:3072 sc1
    v_exp_f32 v116, v116
    v_exp_f32 v117, v117
    s_waitcnt lgkmcnt(10)
    v_mfma_f32_32x32x16_bf16 v[192:207], v[56:59], a[64:67], v[192:207]
    v_exp_f32 v118, v118
    v_exp_f32 v119, v119
    v_add_f32 v112, 1.0, v112
    v_add_f32 v113, 1.0, v113
    v_mfma_f32_32x32x16_bf16 v[208:223], v[56:59], a[68:71], v[208:223]
    ds_read_b64_tr_b16 v[56:57], v22 offset:19456
    ds_read_b64_tr_b16 v[58:59], v22 offset:19712
    buffer_load_dwordx4 a[56:59], v31, s[32:35], s56 offen offset:0 sc1
    v_add_f32 v114, 1.0, v114
    v_add_f32 v115, 1.0, v115
    v_add_f32 v116, 1.0, v116
    v_add_f32 v117, 1.0, v117
    s_waitcnt lgkmcnt(10)
    v_mfma_f32_32x32x16_bf16 v[224:239], v[60:63], a[64:67], v[224:239]
    v_add_f32 v118, 1.0, v118
    v_add_f32 v119, 1.0, v119
    v_rcp_f32 v112, v112
    v_rcp_f32 v113, v113
    v_mfma_f32_32x32x16_bf16 v[240:255], v[60:63], a[68:71], v[240:255]
    ds_read_b64_tr_b16 v[60:61], v22 offset:23552
    ds_read_b64_tr_b16 v[62:63], v22 offset:23808
    s_mov_b32 s56, 13074432
    buffer_load_dwordx4 a[60:63], v32, s[32:35], s56 offen offset:0 sc1
    v_rcp_f32 v114, v114
    v_rcp_f32 v115, v115
    s_waitcnt lgkmcnt(10)
    v_mfma_f32_32x32x16_bf16 v[192:207], v[40:43], a[72:75], v[192:207]
    v_rcp_f32 v116, v116
    v_rcp_f32 v117, v117
    v_rcp_f32 v118, v118
    v_mfma_f32_32x32x16_bf16 v[208:223], v[40:43], a[76:79], v[208:223]
    ds_read_b64_tr_b16 v[40:41], v22 offset:24576
    ds_read_b64_tr_b16 v[42:43], v22 offset:24832
    buffer_load_dwordx4 a[64:67], v32, s[32:35], s56 offen offset:1024 sc1
    v_rcp_f32 v119, v119
    v_mul_f32 v144, v144, v112
    v_mul_f32 v145, v145, v113
    s_waitcnt lgkmcnt(10)
    v_mfma_f32_32x32x16_bf16 v[224:239], v[44:47], a[72:75], v[224:239]
    v_mul_f32 v146, v146, v114
    v_mul_f32 v147, v147, v115
    v_mul_f32 v148, v148, v116
    v_mul_f32 v149, v149, v117
    buffer_load_dwordx4 v[68:71], v24, s[32:35], s55 offen offset:0 sc1
    buffer_load_dwordx4 v[72:75], v25, s[32:35], s55 offen offset:0 sc1
    v_mfma_f32_32x32x16_bf16 v[240:255], v[44:47], a[76:79], v[240:255]
    ds_read_b64_tr_b16 v[44:45], v22 offset:28672
    ds_read_b64_tr_b16 v[46:47], v22 offset:28928
    buffer_load_dwordx4 a[68:71], v32, s[32:35], s56 offen offset:2048 sc1
    v_mul_f32 v150, v150, v118
    v_mul_f32 v151, v151, v119
    v_cvt_pk_bf16_f32 v112, v144, v145
    v_cvt_pk_bf16_f32 v113, v146, v147
    s_waitcnt lgkmcnt(10)
    v_mfma_f32_32x32x16_bf16 v[192:207], v[48:51], a[80:83], v[192:207]
    v_cvt_pk_bf16_f32 v114, v148, v149
    v_cvt_pk_bf16_f32 v115, v150, v151
    buffer_store_dwordx4 v[112:115], v28, s[32:35], s93 offen offset:2048 sc1
    v_mul_f32 v152, v152, v120
    v_mul_f32 v120, s89, v120
    v_mul_f32 v153, v153, v121
    v_mfma_f32_32x32x16_bf16 v[208:223], v[48:51], a[84:87], v[208:223]
    ds_read_b64_tr_b16 v[48:49], v22 offset:25600
    ds_read_b64_tr_b16 v[50:51], v22 offset:25856
    buffer_load_dwordx4 a[72:75], v32, s[32:35], s56 offen offset:3072 sc1
    v_mul_f32 v121, s89, v121
    v_mul_f32 v154, v154, v122
    v_mul_f32 v122, s89, v122
    v_mul_f32 v155, v155, v123
    s_waitcnt lgkmcnt(10)
    v_mfma_f32_32x32x16_bf16 v[224:239], v[52:55], a[80:83], v[224:239]
    v_mul_f32 v123, s89, v123
    v_mul_f32 v156, v156, v124
    v_mul_f32 v124, s89, v124
    v_mul_f32 v157, v157, v125
    v_mul_f32 v125, s89, v125
    v_mul_f32 v158, v158, v126
    v_mfma_f32_32x32x16_bf16 v[240:255], v[52:55], a[84:87], v[240:255]
    ds_read_b64_tr_b16 v[52:53], v22 offset:29696
    ds_read_b64_tr_b16 v[54:55], v22 offset:29952
    buffer_load_dwordx4 a[76:79], v33, s[32:35], s56 offen offset:0 sc1
    v_mul_f32 v126, s89, v126
    v_mul_f32 v159, v159, v127
    v_mul_f32 v127, s89, v127
    v_exp_f32 v120, v120
    s_waitcnt lgkmcnt(10)
    v_mfma_f32_32x32x16_bf16 v[192:207], v[56:59], a[88:91], v[192:207]
    v_exp_f32 v121, v121
    v_exp_f32 v122, v122
    v_exp_f32 v123, v123
    v_mfma_f32_32x32x16_bf16 v[208:223], v[56:59], a[92:95], v[208:223]
    ds_read_b64_tr_b16 v[56:57], v22 offset:26624
    ds_read_b64_tr_b16 v[58:59], v22 offset:26880
    s_add_u32 s56, s88, 0
    buffer_load_dwordx4 a[80:83], v30, s[32:35], s56 offen offset:0 sc1
    v_exp_f32 v124, v124
    v_exp_f32 v125, v125
    s_waitcnt lgkmcnt(10)
    v_mfma_f32_32x32x16_bf16 v[224:239], v[60:63], a[88:91], v[224:239]
    v_exp_f32 v126, v126
    v_exp_f32 v127, v127
    v_add_f32 v120, 1.0, v120
    v_add_f32 v121, 1.0, v121
    v_mfma_f32_32x32x16_bf16 v[240:255], v[60:63], a[92:95], v[240:255]
    ds_read_b64_tr_b16 v[60:61], v22 offset:30720
    ds_read_b64_tr_b16 v[62:63], v22 offset:30976
    buffer_load_dwordx4 a[84:87], v30, s[32:35], s56 offen offset:1024 sc1
    v_add_f32 v122, 1.0, v122
    v_add_f32 v123, 1.0, v123
    v_add_f32 v124, 1.0, v124
    v_add_f32 v125, 1.0, v125
    s_waitcnt lgkmcnt(10)
    v_mfma_f32_32x32x16_bf16 v[192:207], v[40:43], a[96:99], v[192:207]
    v_add_f32 v126, 1.0, v126
    v_add_f32 v127, 1.0, v127
    v_rcp_f32 v120, v120
    v_rcp_f32 v121, v121
    v_mfma_f32_32x32x16_bf16 v[208:223], v[40:43], a[100:103], v[208:223]
    ds_read_b64_tr_b16 v[40:41], v22 offset:27648
    ds_read_b64_tr_b16 v[42:43], v22 offset:27904
    buffer_load_dwordx4 a[88:91], v30, s[32:35], s56 offen offset:2048 sc1
    v_rcp_f32 v122, v122
    v_rcp_f32 v123, v123
    s_waitcnt lgkmcnt(10)
    v_mfma_f32_32x32x16_bf16 v[224:239], v[44:47], a[96:99], v[224:239]
    v_rcp_f32 v124, v124
    v_rcp_f32 v125, v125
    v_rcp_f32 v126, v126
    v_mfma_f32_32x32x16_bf16 v[240:255], v[44:47], a[100:103], v[240:255]
    ds_read_b64_tr_b16 v[44:45], v22 offset:31744
    ds_read_b64_tr_b16 v[46:47], v22 offset:32000
    buffer_load_dwordx4 a[92:95], v30, s[32:35], s56 offen offset:3072 sc1
    v_rcp_f32 v127, v127
    v_mul_f32 v152, v152, v120
    v_mul_f32 v153, v153, v121
    s_waitcnt lgkmcnt(10)
    v_mfma_f32_32x32x16_bf16 v[192:207], v[48:51], a[104:107], v[192:207]
    v_mul_f32 v154, v154, v122
    v_mul_f32 v155, v155, v123
    v_mul_f32 v156, v156, v124
    v_mul_f32 v157, v157, v125
    v_mul_f32 v158, v158, v126
    v_mul_f32 v159, v159, v127
    v_mfma_f32_32x32x16_bf16 v[208:223], v[48:51], a[108:111], v[208:223]
    ds_read_b64_tr_b16 v[48:49], v22 offset:32768
    ds_read_b64_tr_b16 v[50:51], v22 offset:33024
    buffer_load_dwordx4 a[96:99], v31, s[32:35], s56 offen offset:0 sc1
    v_cvt_pk_bf16_f32 v120, v152, v153
    v_cvt_pk_bf16_f32 v121, v154, v155
    v_cvt_pk_bf16_f32 v122, v156, v157
    v_cvt_pk_bf16_f32 v123, v158, v159
    s_waitcnt lgkmcnt(10)
    v_mfma_f32_32x32x16_bf16 v[224:239], v[52:55], a[104:107], v[224:239]
    buffer_store_dwordx4 v[120:123], v28, s[32:35], s93 offen offset:2560 sc1
    v_mul_f32 v92, v83, v160
    v_mul_f32 v160, v82, v160
    v_fma_f32 v160, -v83, v176, v160
    v_fma_f32 v176, v82, v176, v92
    v_mul_f32 v93, v83, v161
    v_mfma_f32_32x32x16_bf16 v[240:255], v[52:55], a[108:111], v[240:255]
    ds_read_b64_tr_b16 v[52:53], v22 offset:36864
    ds_read_b64_tr_b16 v[54:55], v22 offset:37120
    s_add_u32 s56, s88, 163840
    buffer_load_dwordx4 a[100:103], v30, s[32:35], s56 offen offset:0 sc1
    v_mul_f32 v161, v82, v161
    v_fma_f32 v161, -v83, v177, v161
    v_fma_f32 v177, v82, v177, v93
    v_mul_f32 v92, v83, v162
    s_waitcnt lgkmcnt(10)
    v_mfma_f32_32x32x16_bf16 v[192:207], v[56:59], a[112:115], v[192:207]
    v_mul_f32 v162, v82, v162
    v_fma_f32 v162, -v83, v178, v162
    v_fma_f32 v178, v82, v178, v92
    v_mul_f32 v93, v83, v163
    v_mul_f32 v163, v82, v163
    v_fma_f32 v163, -v83, v179, v163
    v_mfma_f32_32x32x16_bf16 v[208:223], v[56:59], a[116:119], v[208:223]
    ds_read_b64_tr_b16 v[56:57], v22 offset:33792
    ds_read_b64_tr_b16 v[58:59], v22 offset:34048
    buffer_load_dwordx4 a[104:107], v30, s[32:35], s56 offen offset:1024 sc1
    v_fma_f32 v179, v82, v179, v93
    v_mul_f32 v92, v83, v164
    v_mul_f32 v164, v82, v164
    v_fma_f32 v164, -v83, v180, v164
    s_waitcnt lgkmcnt(10)
    v_mfma_f32_32x32x16_bf16 v[224:239], v[60:63], a[112:115], v[224:239]
    v_fma_f32 v180, v82, v180, v92
    v_mul_f32 v93, v83, v165
    v_mul_f32 v165, v82, v165
    v_fma_f32 v165, -v83, v181, v165
    v_fma_f32 v181, v82, v181, v93
    v_mul_f32 v92, v83, v166
    v_mfma_f32_32x32x16_bf16 v[240:255], v[60:63], a[116:119], v[240:255]
    ds_read_b64_tr_b16 v[60:61], v22 offset:37888
    ds_read_b64_tr_b16 v[62:63], v22 offset:38144
    buffer_load_dwordx4 a[108:111], v30, s[32:35], s56 offen offset:2048 sc1
    v_mul_f32 v166, v82, v166
    v_fma_f32 v166, -v83, v182, v166
    v_fma_f32 v182, v82, v182, v92
    v_mul_f32 v93, v83, v167
    s_waitcnt lgkmcnt(10)
    v_mfma_f32_32x32x16_bf16 v[192:207], v[40:43], a[120:123], v[192:207]
    v_mul_f32 v167, v82, v167
    v_fma_f32 v167, -v83, v183, v167
    v_fma_f32 v183, v82, v183, v93
    v_mul_f32 v92, v83, v168
    v_mul_f32 v168, v82, v168
    v_fma_f32 v168, -v83, v184, v168
    v_mfma_f32_32x32x16_bf16 v[208:223], v[40:43], a[124:127], v[208:223]
    ds_read_b64_tr_b16 v[40:41], v22 offset:34816
    ds_read_b64_tr_b16 v[42:43], v22 offset:35072
    buffer_load_dwordx4 a[112:115], v30, s[32:35], s56 offen offset:3072 sc1
    v_fma_f32 v184, v82, v184, v92
    v_mul_f32 v93, v83, v169
    v_mul_f32 v169, v82, v169
    v_fma_f32 v169, -v83, v185, v169
    s_waitcnt lgkmcnt(10)
    v_mfma_f32_32x32x16_bf16 v[224:239], v[44:47], a[120:123], v[224:239]
    v_fma_f32 v185, v82, v185, v93
    v_mul_f32 v92, v83, v170
    v_mul_f32 v170, v82, v170
    v_fma_f32 v170, -v83, v186, v170
    v_fma_f32 v186, v82, v186, v92
    v_mul_f32 v93, v83, v171
    v_mfma_f32_32x32x16_bf16 v[240:255], v[44:47], a[124:127], v[240:255]
    ds_read_b64_tr_b16 v[44:45], v22 offset:38912
    ds_read_b64_tr_b16 v[46:47], v22 offset:39168
    buffer_load_dwordx4 a[116:119], v31, s[32:35], s56 offen offset:0 sc1
    v_mul_f32 v171, v82, v171
    v_fma_f32 v171, -v83, v187, v171
    v_fma_f32 v187, v82, v187, v93
    v_mul_f32 v92, v83, v172
    s_waitcnt lgkmcnt(10)
    v_mfma_f32_32x32x16_bf16 v[192:207], v[48:51], a[128:131], v[192:207]
    v_mul_f32 v172, v82, v172
    v_fma_f32 v172, -v83, v188, v172
    v_fma_f32 v188, v82, v188, v92
    v_mul_f32 v93, v83, v173
    v_mul_f32 v173, v82, v173
    v_fma_f32 v173, -v83, v189, v173
    v_mfma_f32_32x32x16_bf16 v[208:223], v[48:51], a[132:135], v[208:223]
    ds_read_b64_tr_b16 v[48:49], v22 offset:35840
    ds_read_b64_tr_b16 v[50:51], v22 offset:36096
    s_add_u32 s56, s88, 327680
    buffer_load_dwordx4 a[120:123], v30, s[32:35], s56 offen offset:0 sc1
    v_fma_f32 v189, v82, v189, v93
    v_mul_f32 v92, v83, v174
    v_mul_f32 v174, v82, v174
    v_fma_f32 v174, -v83, v190, v174
    s_waitcnt lgkmcnt(10)
    v_mfma_f32_32x32x16_bf16 v[224:239], v[52:55], a[128:131], v[224:239]
    v_fma_f32 v190, v82, v190, v92
    v_mul_f32 v93, v83, v175
    v_mul_f32 v175, v82, v175
    v_fma_f32 v175, -v83, v191, v175
    v_fma_f32 v191, v82, v191, v93
    v_mul_f32 v92, v83, v16
    v_mfma_f32_32x32x16_bf16 v[240:255], v[52:55], a[132:135], v[240:255]
    ds_read_b64_tr_b16 v[52:53], v22 offset:39936
    ds_read_b64_tr_b16 v[54:55], v22 offset:40192
    buffer_load_dwordx4 a[124:127], v30, s[32:35], s56 offen offset:1024 sc1
    v_mul_f32 v16, v82, v16
    v_fma_f32 v16, -v83, v17, v16
    v_fma_f32 v17, v82, v17, v92
    v_mul_f32 v93, v83, v86
    s_waitcnt lgkmcnt(10)
    v_mfma_f32_32x32x16_bf16 v[192:207], v[56:59], a[136:139], v[192:207]
    v_mul_f32 v86, v82, v86
    v_fma_f32 v86, -v83, v87, v86
    v_fma_f32 v87, v82, v87, v93
    s_waitcnt vmcnt(17)
    s_mov_b64 s[52:53], -1
    v_cmp_eq_u64 vcc, s[50:51], v[70:71]
    s_nop 0
    s_or_b64 vcc, vcc, s[84:85]
    s_and_b64 s[52:53], s[52:53], vcc
    v_cmp_eq_u64 vcc, s[50:51], v[74:75]
    s_nop 0
    s_or_b64 vcc, vcc, s[86:87]
    s_and_b64 s[52:53], s[52:53], vcc
    s_cmp_eq_u64 s[52:53], -1
    s_cbranch_scc0 L_aggslow_12
L_aggok_13:
    v_mul_f32 v70, v88, v68
    v_mul_f32 v71, v88, v69
    v_mfma_f32_32x32x16_bf16 v[208:223], v[56:59], a[140:143], v[208:223]
    ds_read_b64_tr_b16 v[56:57], v22 offset:40960
    ds_read_b64_tr_b16 v[58:59], v22 offset:41216
    buffer_load_dwordx4 a[128:131], v30, s[32:35], s56 offen offset:2048 sc1
    v_fma_f32 v70, -v89, v69, v70
    v_fmac_f32 v71, v89, v68
    v_fmac_f32 v70, v90, v72
    v_fmac_f32 v71, v90, v73
    s_waitcnt lgkmcnt(10)
    v_mfma_f32_32x32x16_bf16 v[224:239], v[60:63], a[136:139], v[224:239]
    v_fma_f32 v70, -v91, v73, v70
    v_fmac_f32 v71, v91, v72
    v_mov_b32 v68, v70
    v_mov_b32 v69, v71
    s_nop 0
    v_permlane16_swap_b32 v70, v68
    v_permlane16_swap_b32 v71, v69
    v_mfma_f32_32x32x16_bf16 v[240:255], v[60:63], a[140:143], v[240:255]
    ds_read_b64_tr_b16 v[60:61], v22 offset:45056
    ds_read_b64_tr_b16 v[62:63], v22 offset:45312
    buffer_load_dwordx4 a[132:135], v30, s[32:35], s56 offen offset:3072 sc1
    v_add_f32 v70, v70, v68
    v_add_f32 v71, v71, v69
    v_mov_b32 v68, v70
    v_mov_b32 v69, v71
    s_waitcnt lgkmcnt(10)
    v_mfma_f32_32x32x16_bf16 v[192:207], v[40:43], a[144:147], v[192:207]
    v_permlane32_swap_b32 v70, v68
    v_permlane32_swap_b32 v71, v69
    v_add_f32 v70, v70, v68
    v_add_f32 v71, v71, v69
    v_fmac_f32 v16, v86, v70
    v_fmac_f32 v17, v86, v71
    v_mfma_f32_32x32x16_bf16 v[208:223], v[40:43], a[148:151], v[208:223]
    ds_read_b64_tr_b16 v[40:41], v22 offset:41984
    ds_read_b64_tr_b16 v[42:43], v22 offset:42240
    buffer_load_dwordx4 a[136:139], v31, s[32:35], s56 offen offset:0 sc1
    v_fma_f32 v16, -v87, v71, v16
    v_fmac_f32 v17, v87, v70
    v_fmac_f32 v160, v80, v16
    v_fmac_f32 v176, v80, v17
    s_waitcnt lgkmcnt(10)
    v_mfma_f32_32x32x16_bf16 v[224:239], v[44:47], a[144:147], v[224:239]
    v_fma_f32 v160, -v81, v17, v160
    v_fmac_f32 v176, v81, v16
    s_waitcnt vmcnt(10)
    s_add_u32 s3, s91, 22052864
    buffer_store_dwordx2 v[36:37], v38, s[32:35], s3 offen sc1
    v_fmac_f32 v161, v80, v160
    v_fmac_f32 v177, v80, v176
    v_fma_f32 v161, -v81, v176, v161
    v_mfma_f32_32x32x16_bf16 v[240:255], v[44:47], a[148:151], v[240:255]
    ds_read_b64_tr_b16 v[44:45], v22 offset:46080
    ds_read_b64_tr_b16 v[46:47], v22 offset:46336
    s_add_u32 s56, s88, 491520
    buffer_load_dwordx4 a[140:143], v30, s[32:35], s56 offen offset:0 sc1
    v_fmac_f32 v177, v81, v160
    v_cvt_pk_bf16_f32 v64, v160, v161
    v_cvt_pk_bf16_f32 v72, -v176, -v177
    v_fmac_f32 v162, v80, v161
    s_waitcnt lgkmcnt(10)
    v_mfma_f32_32x32x16_bf16 v[192:207], v[48:51], a[152:155], v[192:207]
    v_fmac_f32 v178, v80, v177
    v_fma_f32 v162, -v81, v177, v162
    v_fmac_f32 v178, v81, v161
    v_fmac_f32 v163, v80, v162
    v_fmac_f32 v179, v80, v178
    v_fma_f32 v163, -v81, v178, v163
    v_mfma_f32_32x32x16_bf16 v[208:223], v[48:51], a[156:159], v[208:223]
    ds_read_b64_tr_b16 v[48:49], v22 offset:43008
    ds_read_b64_tr_b16 v[50:51], v22 offset:43264
    buffer_load_dwordx4 a[144:147], v30, s[32:35], s56 offen offset:1024 sc1
    v_fmac_f32 v179, v81, v162
    v_cvt_pk_bf16_f32 v65, v162, v163
    v_cvt_pk_bf16_f32 v73, -v178, -v179
    v_fmac_f32 v164, v80, v163
    s_waitcnt lgkmcnt(10)
    v_mfma_f32_32x32x16_bf16 v[224:239], v[52:55], a[152:155], v[224:239]
    v_fmac_f32 v180, v80, v179
    v_fma_f32 v164, -v81, v179, v164
    v_fmac_f32 v180, v81, v163
    v_fmac_f32 v165, v80, v164
    v_fmac_f32 v181, v80, v180
    v_fma_f32 v165, -v81, v180, v165
    v_mfma_f32_32x32x16_bf16 v[240:255], v[52:55], a[156:159], v[240:255]
    ds_read_b64_tr_b16 v[52:53], v22 offset:47104
    ds_read_b64_tr_b16 v[54:55], v22 offset:47360
    buffer_load_dwordx4 a[148:151], v30, s[32:35], s56 offen offset:2048 sc1
    v_fmac_f32 v181, v81, v164
    v_cvt_pk_bf16_f32 v66, v164, v165
    v_cvt_pk_bf16_f32 v74, -v180, -v181
    v_fmac_f32 v166, v80, v165
    s_waitcnt lgkmcnt(10)
    v_mfma_f32_32x32x16_bf16 v[192:207], v[56:59], a[160:163], v[192:207]
    v_fmac_f32 v182, v80, v181
    v_fma_f32 v166, -v81, v181, v166
    v_fmac_f32 v182, v81, v165
    v_fmac_f32 v167, v80, v166
    v_fmac_f32 v183, v80, v182
    v_fma_f32 v167, -v81, v182, v167
    v_mfma_f32_32x32x16_bf16 v[208:223], v[56:59], a[164:167], v[208:223]
    ds_read_b64_tr_b16 v[56:57], v22 offset:44032
    ds_read_b64_tr_b16 v[58:59], v22 offset:44288
    buffer_load_dwordx4 a[152:155], v30, s[32:35], s56 offen offset:3072 sc1
    v_fmac_f32 v183, v81, v166
    v_cvt_pk_bf16_f32 v67, v166, v167
    v_cvt_pk_bf16_f32 v75, -v182, -v183
    v_fmac_f32 v168, v80, v167
    s_waitcnt lgkmcnt(10)
    v_mfma_f32_32x32x16_bf16 v[224:239], v[60:63], a[160:163], v[224:239]
    v_fmac_f32 v184, v80, v183
    v_fma_f32 v168, -v81, v183, v168
    v_fmac_f32 v184, v81, v167
    v_fmac_f32 v169, v80, v168
    v_fmac_f32 v185, v80, v184
    v_fma_f32 v169, -v81, v184, v169
    v_mfma_f32_32x32x16_bf16 v[240:255], v[60:63], a[164:167], v[240:255]
    ds_read_b64_tr_b16 v[60:61], v22 offset:48128
    ds_read_b64_tr_b16 v[62:63], v22 offset:48384
    buffer_load_dwordx4 a[156:159], v31, s[32:35], s56 offen offset:0 sc1
    v_fmac_f32 v185, v81, v168
    v_cvt_pk_bf16_f32 v68, v168, v169
    v_cvt_pk_bf16_f32 v76, -v184, -v185
    v_fmac_f32 v170, v80, v169
    s_waitcnt lgkmcnt(10)
    v_mfma_f32_32x32x16_bf16 v[192:207], v[40:43], a[168:171], v[192:207]
    v_fmac_f32 v186, v80, v185
    v_fma_f32 v170, -v81, v185, v170
    v_fmac_f32 v186, v81, v169
    v_fmac_f32 v171, v80, v170
    v_fmac_f32 v187, v80, v186
    v_fma_f32 v171, -v81, v186, v171
    v_mfma_f32_32x32x16_bf16 v[208:223], v[40:43], a[172:175], v[208:223]
    s_add_u32 s56, s88, 655360
    buffer_load_dwordx4 a[160:163], v30, s[32:35], s56 offen offset:0 sc1
    v_fmac_f32 v187, v81, v170
    v_cvt_pk_bf16_f32 v69, v170, v171
    v_cvt_pk_bf16_f32 v77, -v186, -v187
    v_fmac_f32 v172, v80, v171
    v_fmac_f32 v188, v80, v187
    v_fma_f32 v172, -v81, v187, v172
    s_waitcnt lgkmcnt(8)
    v_mfma_f32_32x32x16_bf16 v[224:239], v[44:47], a[168:171], v[224:239]
    v_fmac_f32 v188, v81, v171
    v_fmac_f32 v173, v80, v172
    v_fmac_f32 v189, v80, v188
    v_fma_f32 v173, -v81, v188, v173
    v_fmac_f32 v189, v81, v172
    v_cvt_pk_bf16_f32 v70, v172, v173
    v_mfma_f32_32x32x16_bf16 v[240:255], v[44:47], a[172:175], v[240:255]
    buffer_load_dwordx4 a[164:167], v30, s[32:35], s56 offen offset:1024 sc1
    v_cvt_pk_bf16_f32 v78, -v188, -v189
    v_fmac_f32 v174, v80, v173
    v_fmac_f32 v190, v80, v189
    v_fma_f32 v174, -v81, v189, v174
    v_fmac_f32 v190, v81, v173
    v_fmac_f32 v175, v80, v174
    s_waitcnt lgkmcnt(6)
    v_mfma_f32_32x32x16_bf16 v[192:207], v[48:51], a[176:179], v[192:207]
    v_fmac_f32 v191, v80, v190
    v_fma_f32 v175, -v81, v190, v175
    v_fmac_f32 v191, v81, v174
    v_cvt_pk_bf16_f32 v71, v174, v175
    v_cvt_pk_bf16_f32 v79, -v190, -v191
    ds_write_b128 v94, v[64:67] offset:0
    v_mfma_f32_32x32x16_bf16 v[208:223], v[48:51], a[180:183], v[208:223]
    buffer_load_dwordx4 a[168:171], v30, s[32:35], s56 offen offset:2048 sc1
    ds_write_b128 v94, v[68:71] offset:16
    ds_write_b128 v94, v[72:75] offset:2304
    ds_write_b128 v94, v[76:79] offset:2320
    ds_read_b64_tr_b16 v[64:65], v95 offset:0
    ds_read_b64_tr_b16 v[66:67], v95 offset:576
    ds_read_b64_tr_b16 v[68:69], v95 offset:16
    s_waitcnt lgkmcnt(11)
    v_mfma_f32_32x32x16_bf16 v[224:239], v[52:55], a[176:179], v[224:239]
    ds_read_b64_tr_b16 v[70:71], v95 offset:592
    ds_read_b64_tr_b16 v[72:73], v95 offset:32
    ds_read_b64_tr_b16 v[74:75], v95 offset:608
    ds_read_b64_tr_b16 v[76:77], v95 offset:48
    ds_read_b64_tr_b16 v[78:79], v95 offset:624
    s_waitcnt lgkmcnt(0)
    buffer_store_dwordx4 v[64:67], v23, s[32:35], s90 offen offset:0 sc1
    v_mfma_f32_32x32x16_bf16 v[240:255], v[52:55], a[180:183], v[240:255]
    buffer_load_dwordx4 a[172:175], v30, s[32:35], s56 offen offset:3072 sc1
    buffer_store_dwordx4 v[68:71], v23, s[32:35], s90 offen offset:1024 sc1
    buffer_store_dwordx4 v[72:75], v23, s[32:35], s90 offen offset:2048 sc1
    buffer_store_dwordx4 v[76:79], v23, s[32:35], s90 offen offset:3072 sc1
    v_and_b32 v7, 3, v1
    v_lshl_add_u32 v7, v7, 2, s4
    v_min_u32 v7, 13, v7
    v_mfma_f32_32x32x16_bf16 v[192:207], v[56:59], a[184:187], v[192:207]
    v_lshlrev_b32 v7, 7, v7
    s_lshl_b32 s58, s82, 12
    s_add_u32 s58, s58, 22052864
    v_lshlrev_b32 v15, 4, v1
    v_lshl_add_u32 v2, s4, 12, v15
    s_nop 0
    v_add_u32 v3, s63, v2
    v_mfma_f32_32x32x16_bf16 v[208:223], v[56:59], a[188:191], v[208:223]
    buffer_load_dwordx4 a[176:179], v31, s[32:35], s56 offen offset:0 sc1
    s_mul_i32 s52, s82, 221184
    v_mfma_f32_32x32x16_bf16 v[224:239], v[60:63], a[184:187], v[224:239]
    v_mfma_f32_32x32x16_bf16 v[240:255], v[60:63], a[188:191], v[240:255]
    s_add_u32 s56, s88, 819200
    buffer_load_dwordx4 a[180:183], v30, s[32:35], s56 offen offset:0 sc1
    buffer_load_dwordx4 a[184:187], v30, s[32:35], s56 offen offset:1024 sc1
    buffer_load_dwordx4 a[188:191], v30, s[32:35], s56 offen offset:2048 sc1
    s_nop 6
    v_pk_mul_f32 v[224:225], v[224:225], v[192:193]
    v_pk_mul_f32 v[192:193], v[192:193], s[88:89] op_sel:[0,1] op_sel_hi:[1,1]
    v_pk_mul_f32 v[226:227], v[226:227], v[194:195]
    v_pk_mul_f32 v[194:195], v[194:195], s[88:89] op_sel:[0,1] op_sel_hi:[1,1]
    v_pk_mul_f32 v[228:229], v[228:229], v[196:197]
    v_pk_mul_f32 v[196:197], v[196:197], s[88:89] op_sel:[0,1] op_sel_hi:[1,1]
    v_pk_mul_f32 v[230:231], v[230:231], v[198:199]
    v_pk_mul_f32 v[198:199], v[198:199], s[88:89] op_sel:[0,1] op_sel_hi:[1,1]
    v_exp_f32 v192, v192
    v_exp_f32 v193, v193
    v_exp_f32 v194, v194
    v_exp_f32 v195, v195
    v_exp_f32 v196, v196
    v_exp_f32 v197, v197
    v_exp_f32 v198, v198
    v_exp_f32 v199, v199
    v_pk_add_f32 v[192:193], v[192:193], 1.0 op_sel_hi:[1,0]
    v_pk_add_f32 v[194:195], v[194:195], 1.0 op_sel_hi:[1,0]
    v_pk_add_f32 v[196:197], v[196:197], 1.0 op_sel_hi:[1,0]
    v_pk_add_f32 v[198:199], v[198:199], 1.0 op_sel_hi:[1,0]
    s_mov_b64 exec, 0xf
    buffer_load_dwordx2 v[8:9], v7, s[32:35], s58 offen sc1
    s_mov_b64 exec, -1
    v_rcp_f32 v192, v192
    v_rcp_f32 v193, v193
    v_rcp_f32 v194, v194
    v_rcp_f32 v195, v195
    v_rcp_f32 v196, v196
    v_rcp_f32 v197, v197
    v_rcp_f32 v198, v198
    v_rcp_f32 v199, v199
    v_pk_mul_f32 v[224:225], v[224:225], v[192:193]
    v_pk_mul_f32 v[226:227], v[226:227], v[194:195]
    v_pk_mul_f32 v[228:229], v[228:229], v[196:197]
    v_pk_mul_f32 v[230:231], v[230:231], v[198:199]
    v_cvt_pk_bf16_f32 v192, v224, v225
    v_cvt_pk_bf16_f32 v193, v226, v227
    v_cvt_pk_bf16_f32 v194, v228, v229
    v_cvt_pk_bf16_f32 v195, v230, v231
    buffer_store_dwordx4 v[192:195], v28, s[32:35], s92 offen offset:0 sc1
    v_pk_mul_f32 v[232:233], v[232:233], v[200:201]
    v_pk_mul_f32 v[200:201], v[200:201], s[88:89] op_sel:[0,1] op_sel_hi:[1,1]
    v_pk_mul_f32 v[234:235], v[234:235], v[202:203]
    v_pk_mul_f32 v[202:203], v[202:203], s[88:89] op_sel:[0,1] op_sel_hi:[1,1]
    v_pk_mul_f32 v[236:237], v[236:237], v[204:205]
    v_pk_mul_f32 v[204:205], v[204:205], s[88:89] op_sel:[0,1] op_sel_hi:[1,1]
    v_pk_mul_f32 v[238:239], v[238:239], v[206:207]
    v_pk_mul_f32 v[206:207], v[206:207], s[88:89] op_sel:[0,1] op_sel_hi:[1,1]
    v_exp_f32 v200, v200
    v_exp_f32 v201, v201
    v_exp_f32 v202, v202
    v_exp_f32 v203, v203
    v_exp_f32 v204, v204
    v_exp_f32 v205, v205
    v_exp_f32 v206, v206
    v_exp_f32 v207, v207
    v_pk_add_f32 v[200:201], v[200:201], 1.0 op_sel_hi:[1,0]
    v_pk_add_f32 v[202:203], v[202:203], 1.0 op_sel_hi:[1,0]
    v_pk_add_f32 v[204:205], v[204:205], 1.0 op_sel_hi:[1,0]
    v_pk_add_f32 v[206:207], v[206:207], 1.0 op_sel_hi:[1,0]
    v_rcp_f32 v200, v200
    v_rcp_f32 v201, v201
    v_rcp_f32 v202, v202
    v_rcp_f32 v203, v203
    v_rcp_f32 v204, v204
    v_rcp_f32 v205, v205
    v_rcp_f32 v206, v206
    v_rcp_f32 v207, v207
    v_pk_mul_f32 v[232:233], v[232:233], v[200:201]
    v_pk_mul_f32 v[234:235], v[234:235], v[202:203]
    v_pk_mul_f32 v[236:237], v[236:237], v[204:205]
    v_pk_mul_f32 v[238:239], v[238:239], v[206:207]
    v_cvt_pk_bf16_f32 v200, v232, v233
    v_cvt_pk_bf16_f32 v201, v234, v235
    v_cvt_pk_bf16_f32 v202, v236, v237
    v_cvt_pk_bf16_f32 v203, v238, v239
    buffer_store_dwordx4 v[200:203], v28, s[32:35], s92 offen offset:512 sc1
    v_pk_mul_f32 v[240:241], v[240:241], v[208:209]
    v_pk_mul_f32 v[208:209], v[208:209], s[88:89] op_sel:[0,1] op_sel_hi:[1,1]
    v_pk_mul_f32 v[242:243], v[242:243], v[210:211]
    v_pk_mul_f32 v[210:211], v[210:211], s[88:89] op_sel:[0,1] op_sel_hi:[1,1]
    v_pk_mul_f32 v[244:245], v[244:245], v[212:213]
    v_pk_mul_f32 v[212:213], v[212:213], s[88:89] op_sel:[0,1] op_sel_hi:[1,1]
    v_pk_mul_f32 v[246:247], v[246:247], v[214:215]
    v_pk_mul_f32 v[214:215], v[214:215], s[88:89] op_sel:[0,1] op_sel_hi:[1,1]
    v_exp_f32 v208, v208
    v_exp_f32 v209, v209
    v_exp_f32 v210, v210
    v_exp_f32 v211, v211
    v_exp_f32 v212, v212
    v_exp_f32 v213, v213
    v_exp_f32 v214, v214
    v_exp_f32 v215, v215
    v_pk_add_f32 v[208:209], v[208:209], 1.0 op_sel_hi:[1,0]
    v_pk_add_f32 v[210:211], v[210:211], 1.0 op_sel_hi:[1,0]
    v_pk_add_f32 v[212:213], v[212:213], 1.0 op_sel_hi:[1,0]
    v_pk_add_f32 v[214:215], v[214:215], 1.0 op_sel_hi:[1,0]
    v_rcp_f32 v208, v208
    v_rcp_f32 v209, v209
    v_rcp_f32 v210, v210
    v_rcp_f32 v211, v211
    v_rcp_f32 v212, v212
    v_rcp_f32 v213, v213
    v_rcp_f32 v214, v214
    v_rcp_f32 v215, v215
    v_pk_mul_f32 v[240:241], v[240:241], v[208:209]
    v_pk_mul_f32 v[242:243], v[242:243], v[210:211]
    v_pk_mul_f32 v[244:245], v[244:245], v[212:213]
    v_pk_mul_f32 v[246:247], v[246:247], v[214:215]
    v_cvt_pk_bf16_f32 v208, v240, v241
    v_cvt_pk_bf16_f32 v209, v242, v243
    v_cvt_pk_bf16_f32 v210, v244, v245
    v_cvt_pk_bf16_f32 v211, v246, v247
    buffer_store_dwordx4 v[208:211], v28, s[32:35], s92 offen offset:2048 sc1
    v_pk_mul_f32 v[248:249], v[248:249], v[216:217]
    s_waitcnt vmcnt(3)
    s_add_u32 s3, s91, 22183936
    buffer_store_dwordx2 v[36:37], v38, s[32:35], s3 offen sc1
    v_cmp_eq_u64 vcc, s[50:51], v[8:9]
    s_nop 0
    s_and_b32 s3, vcc_lo, 0xf
    s_cmp_eq_u32 s3, 0xf
    s_cselect_b32 s62, 0, 2130706432
    v_or_b32 v4, s62, v2
    v_or_b32 v5, s62, v3
    v_pk_mul_f32 v[216:217], v[216:217], s[88:89] op_sel:[0,1] op_sel_hi:[1,1]
    v_pk_mul_f32 v[250:251], v[250:251], v[218:219]
    v_pk_mul_f32 v[218:219], v[218:219], s[88:89] op_sel:[0,1] op_sel_hi:[1,1]
    v_pk_mul_f32 v[252:253], v[252:253], v[220:221]
    s_add_u32 s55, s66, 0
    buffer_load_dwordx4 v[96:99], v4, s[32:35], s55 offen sc1
    v_pk_mul_f32 v[220:221], v[220:221], s[88:89] op_sel:[0,1] op_sel_hi:[1,1]
    v_pk_mul_f32 v[254:255], v[254:255], v[222:223]
    v_pk_mul_f32 v[222:223], v[222:223], s[88:89] op_sel:[0,1] op_sel_hi:[1,1]
    v_exp_f32 v216, v216
    s_add_u32 s55, s67, 0
    buffer_load_dwordx4 v[100:103], v4, s[32:35], s55 offen sc1
    v_exp_f32 v217, v217
    v_exp_f32 v218, v218
    v_exp_f32 v219, v219
    v_exp_f32 v220, v220
    s_add_u32 s55, s68, 0
    buffer_load_dwordx4 v[104:107], v4, s[32:35], s55 offen sc1
    v_exp_f32 v221, v221
    v_exp_f32 v222, v222
    v_exp_f32 v223, v223
    v_pk_add_f32 v[216:217], v[216:217], 1.0 op_sel_hi:[1,0]
    s_add_u32 s55, s69, 0
    buffer_load_dwordx4 v[108:111], v4, s[32:35], s55 offen sc1
    v_pk_add_f32 v[218:219], v[218:219], 1.0 op_sel_hi:[1,0]
    v_pk_add_f32 v[220:221], v[220:221], 1.0 op_sel_hi:[1,0]
    v_pk_add_f32 v[222:223], v[222:223], 1.0 op_sel_hi:[1,0]
    v_rcp_f32 v216, v216
    s_add_u32 s55, s66, 16384
    buffer_load_dwordx4 v[112:115], v4, s[32:35], s55 offen sc1
    v_rcp_f32 v217, v217
    v_rcp_f32 v218, v218
    v_rcp_f32 v219, v219
    v_rcp_f32 v220, v220
    s_add_u32 s55, s67, 16384
    buffer_load_dwordx4 v[116:119], v4, s[32:35], s55 offen sc1
    v_rcp_f32 v221, v221
    v_rcp_f32 v222, v222
    v_rcp_f32 v223, v223
    v_pk_mul_f32 v[248:249], v[248:249], v[216:217]
    s_add_u32 s55, s68, 16384
    buffer_load_dwordx4 v[120:123], v4, s[32:35], s55 offen sc1
    v_pk_mul_f32 v[250:251], v[250:251], v[218:219]
    v_pk_mul_f32 v[252:253], v[252:253], v[220:221]
    v_pk_mul_f32 v[254:255], v[254:255], v[222:223]
    v_cvt_pk_bf16_f32 v216, v248, v249
    s_add_u32 s55, s69, 16384
    buffer_load_dwordx4 v[124:127], v4, s[32:35], s55 offen sc1
    v_cvt_pk_bf16_f32 v217, v250, v251
    v_cvt_pk_bf16_f32 v218, v252, v253
    v_cvt_pk_bf16_f32 v219, v254, v255
    buffer_store_dwordx4 v[216:219], v28, s[32:35], s92 offen offset:2560 sc1
    v_accvgpr_read_b32 v48, a240
    v_accvgpr_read_b32 v49, a241
    v_accvgpr_read_b32 v50, a242
    v_accvgpr_read_b32 v51, a243
    v_accvgpr_read_b32 v52, a244
    v_accvgpr_read_b32 v53, a245
    v_accvgpr_read_b32 v54, a246
    v_accvgpr_read_b32 v55, a247
    v_accvgpr_read_b32 v56, a248
    v_accvgpr_read_b32 v57, a249
L_p1done:
    v_mov_b32 v12, v36
    v_mov_b32 v13, v37
    v_mov_b32 v14, v38
    s_mov_b32 s36, s64
    s_mov_b32 s37, s65
    s_mov_b32 s38, 5242880
    s_mov_b32 s39, 0x20000
    s_cmp_eq_u32 s62, 0
    s_cbranch_scc0 L_gateslow_15
L_gateok_16:
    v_mov_b32 v89, v29
    s_mov_b32 s60, 22052864
    s_waitcnt vmcnt(7)
    v_mfma_f32_16x16x32_bf16 v[176:179], a[0:3], v[96:99], 0
    v_bfe_u32 v10, v1, 4, 1
    v_lshlrev_b32 v10, 5, v10
    v_mfma_f32_16x16x32_bf16 v[180:183], a[4:7], v[96:99], 0
    v_lshrrev_b32 v11, 5, v1
    v_lshl_add_u32 v10, v11, 2, v10
    v_mfma_f32_16x16x32_bf16 v[184:187], a[8:11], v[96:99], 0
    s_add_u32 s55, s66, 32768
    buffer_load_dwordx4 v[128:131], v2, s[32:35], s55 offen sc1
    v_bfe_u32 v11, v1, 2, 2
    v_mfma_f32_16x16x32_bf16 v[188:191], a[12:15], v[96:99], 0
    v_add_u32 v10, v10, v11
    s_lshl_b32 s3, s82, 6
    s_lshl_b32 s7, s4, 3
    s_add_u32 s3, s3, s7
    v_add_u32 v10, s3, v10
    v_mfma_f32_16x16x32_bf16 v[192:195], a[16:19], v[96:99], 0
    v_and_b32 v91, 3, v1
    v_lshlrev_b32 v91, 4, v91
    s_waitcnt vmcnt(7)
    v_mfma_f32_16x16x32_bf16 v[196:199], a[0:3], v[100:103], 0
    s_add_u32 s55, s67, 32768
    buffer_load_dwordx4 v[132:135], v2, s[32:35], s55 offen sc1
    v_mul_u32_u24 v6, 2560, v10
    v_mfma_f32_16x16x32_bf16 v[200:203], a[4:7], v[100:103], 0
    v_add_u32 v6, v6, v91
    v_lshlrev_b32 v10, 2, v10
    v_mfma_f32_16x16x32_bf16 v[204:207], a[8:11], v[100:103], 0
    s_mul_i32 s3, s49, 320
    v_add_u32 v6, s3, v6
    v_and_b32 v90, 3, v1
    v_mfma_f32_16x16x32_bf16 v[208:211], a[12:15], v[100:103], 0
    s_add_u32 s55, s68, 32768
    buffer_load_dwordx4 v[136:139], v2, s[32:35], s55 offen sc1
    v_and_b32 v4, 15, v1
    v_mfma_f32_16x16x32_bf16 v[212:215], a[16:19], v[100:103], 0
    v_lshrrev_b32 v5, 4, v1
    v_bfe_u32 v11, v1, 1, 2
    s_waitcnt vmcnt(8)
    v_mfma_f32_16x16x32_bf16 v[216:219], a[0:3], v[104:107], 0
    v_xor_b32 v5, v5, v11
    v_mul_u32_u24 v4, 320, v4
    v_mfma_f32_16x16x32_bf16 v[220:223], a[4:7], v[104:107], 0
    s_add_u32 s55, s69, 32768
    buffer_load_dwordx4 v[140:143], v2, s[32:35], s55 offen sc1
    v_lshl_add_u32 v4, v5, 4, v4
    v_mfma_f32_16x16x32_bf16 v[224:227], a[8:11], v[104:107], 0
    v_mov_b32 v7, v4
    v_lshrrev_b32 v5, 2, v1
    v_mfma_f32_16x16x32_bf16 v[228:231], a[12:15], v[104:107], 0
    v_mul_u32_u24 v5, 320, v5
    v_bfe_u32 v11, v1, 3, 2
    v_mfma_f32_16x16x32_bf16 v[232:235], a[16:19], v[104:107], 0
    s_add_u32 s55, s66, 49152
    buffer_load_dwordx4 v[144:147], v3, s[32:35], s55 offen sc1
    v_xor_b32 v11, v11, v90
    s_waitcnt vmcnt(9)
    v_mfma_f32_16x16x32_bf16 v[236:239], a[0:3], v[108:111], 0
    v_lshl_add_u32 v5, v11, 4, v5
    s_mul_i32 s90, s4, 20480
    v_mfma_f32_16x16x32_bf16 v[240:243], a[4:7], v[108:111], 0
    v_add_u32 v5, s90, v5
    s_mul_i32 s90, s4, 5120
    v_mfma_f32_16x16x32_bf16 v[244:247], a[8:11], v[108:111], 0
    s_add_u32 s55, s67, 49152
    buffer_load_dwordx4 v[148:151], v3, s[32:35], s55 offen sc1
    v_add_u32 v15, s90, v15
    v_mfma_f32_16x16x32_bf16 v[248:251], a[12:15], v[108:111], 0
    v_bfe_u32 v11, v1, 2, 1
    v_lshl_add_u32 v90, v11, 5, v90
    v_mfma_f32_16x16x32_bf16 v[252:255], a[16:19], v[108:111], 0
    v_bfe_u32 v11, v1, 3, 1
    v_lshl_add_u32 v11, v11, 2, v90
    s_waitcnt vmcnt(9)
    v_mfma_f32_16x16x32_bf16 v[176:179], a[20:23], v[112:115], v[176:179]
    s_add_u32 s55, s68, 49152
    buffer_load_dwordx4 v[152:155], v3, s[32:35], s55 offen sc1
    v_lshlrev_b32 v11, 2, v11
    v_mfma_f32_16x16x32_bf16 v[180:183], a[24:27], v[112:115], v[180:183]
    s_lshl_b32 s59, s82, 8
    s_add_u32 s59, s59, 16613376
    v_mfma_f32_16x16x32_bf16 v[184:187], a[28:31], v[112:115], v[184:187]
    v_lshlrev_b32 v88, 4, v1
    v_add_u32 v88, s57, v88
    v_mfma_f32_16x16x32_bf16 v[188:191], a[32:35], v[112:115], v[188:191]
    s_add_u32 s55, s69, 49152
    buffer_load_dwordx4 v[156:159], v3, s[32:35], s55 offen sc1
    v_mfma_f32_16x16x32_bf16 v[192:195], a[36:39], v[112:115], v[192:195]
    s_waitcnt vmcnt(10)
    v_mfma_f32_16x16x32_bf16 v[196:199], a[20:23], v[116:119], v[196:199]
    v_mfma_f32_16x16x32_bf16 v[200:203], a[24:27], v[116:119], v[200:203]
    v_mfma_f32_16x16x32_bf16 v[204:207], a[28:31], v[116:119], v[204:207]
    v_mfma_f32_16x16x32_bf16 v[208:211], a[32:35], v[116:119], v[208:211]
    v_mfma_f32_16x16x32_bf16 v[212:215], a[36:39], v[116:119], v[212:215]
    s_waitcnt vmcnt(9)
    v_mfma_f32_16x16x32_bf16 v[216:219], a[20:23], v[120:123], v[216:219]
    v_mfma_f32_16x16x32_bf16 v[220:223], a[24:27], v[120:123], v[220:223]
    v_mfma_f32_16x16x32_bf16 v[224:227], a[28:31], v[120:123], v[224:227]
    v_mfma_f32_16x16x32_bf16 v[228:231], a[32:35], v[120:123], v[228:231]
    v_mfma_f32_16x16x32_bf16 v[232:235], a[36:39], v[120:123], v[232:235]
    s_waitcnt vmcnt(8)
    v_mfma_f32_16x16x32_bf16 v[236:239], a[20:23], v[124:127], v[236:239]
    v_mfma_f32_16x16x32_bf16 v[240:243], a[24:27], v[124:127], v[240:243]
    v_mfma_f32_16x16x32_bf16 v[244:247], a[28:31], v[124:127], v[244:247]
    v_mfma_f32_16x16x32_bf16 v[248:251], a[32:35], v[124:127], v[248:251]
    v_mfma_f32_16x16x32_bf16 v[252:255], a[36:39], v[124:127], v[252:255]
    s_mov_b64 exec, 0x7
    buffer_load_dwordx2 v[8:9], v89, s[32:35], s60 offen sc1
    s_mov_b64 exec, -1
    s_waitcnt vmcnt(8)
    s_add_u32 s3, s91, 22315008
    buffer_store_dwordx2 v[12:13], v14, s[32:35], s3 offen sc1
    v_mfma_f32_16x16x32_bf16 v[176:179], a[40:43], v[128:131], v[176:179]
    v_mfma_f32_16x16x32_bf16 v[180:183], a[44:47], v[128:131], v[180:183]
    v_mfma_f32_16x16x32_bf16 v[184:187], a[48:51], v[128:131], v[184:187]
    v_mfma_f32_16x16x32_bf16 v[188:191], a[52:55], v[128:131], v[188:191]
    v_mfma_f32_16x16x32_bf16 v[192:195], a[56:59], v[128:131], v[192:195]
    s_waitcnt vmcnt(8)
    v_mfma_f32_16x16x32_bf16 v[196:199], a[40:43], v[132:135], v[196:199]
    v_mfma_f32_16x16x32_bf16 v[200:203], a[44:47], v[132:135], v[200:203]
    v_mfma_f32_16x16x32_bf16 v[204:207], a[48:51], v[132:135], v[204:207]
    v_mfma_f32_16x16x32_bf16 v[208:211], a[52:55], v[132:135], v[208:211]
    v_mfma_f32_16x16x32_bf16 v[212:215], a[56:59], v[132:135], v[212:215]
    s_waitcnt vmcnt(7)
    v_mfma_f32_16x16x32_bf16 v[216:219], a[40:43], v[136:139], v[216:219]
    v_mfma_f32_16x16x32_bf16 v[220:223], a[44:47], v[136:139], v[220:223]
    v_mfma_f32_16x16x32_bf16 v[224:227], a[48:51], v[136:139], v[224:227]
    v_mfma_f32_16x16x32_bf16 v[228:231], a[52:55], v[136:139], v[228:231]
    v_mfma_f32_16x16x32_bf16 v[232:235], a[56:59], v[136:139], v[232:235]
    s_waitcnt vmcnt(6)
    v_mfma_f32_16x16x32_bf16 v[236:239], a[40:43], v[140:143], v[236:239]
    v_mfma_f32_16x16x32_bf16 v[240:243], a[44:47], v[140:143], v[240:243]
    v_mfma_f32_16x16x32_bf16 v[244:247], a[48:51], v[140:143], v[244:247]
    v_mfma_f32_16x16x32_bf16 v[248:251], a[52:55], v[140:143], v[248:251]
    v_mfma_f32_16x16x32_bf16 v[252:255], a[56:59], v[140:143], v[252:255]
    s_waitcnt vmcnt(1)
    v_cmp_eq_u64 vcc, s[50:51], v[8:9]
    s_nop 0
    s_and_b32 s3, vcc_lo, 0x7
    s_cmp_eq_u32 s3, 0x7
    s_cselect_b32 s62, 0, 2130706432
    v_or_b32 v3, s62, v2
    v_mfma_f32_16x16x32_bf16 v[176:179], a[60:63], v[144:147], v[176:179]
    ds_read_b128 a[40:43], v88 offset:0
    ds_read_b128 a[44:47], v88 offset:1024
    v_mfma_f32_16x16x32_bf16 v[180:183], a[64:67], v[144:147], v[180:183]
    ds_read_b128 a[48:51], v88 offset:2048
    ds_read_b128 a[52:55], v88 offset:3072
    v_mfma_f32_16x16x32_bf16 v[184:187], a[68:71], v[144:147], v[184:187]
    s_add_u32 s55, s70, 0
    buffer_load_dwordx4 v[16:19], v3, s[32:35], s55 offen sc1
    ds_read_b128 a[56:59], v88 offset:4096
    v_mfma_f32_16x16x32_bf16 v[188:191], a[72:75], v[144:147], v[188:191]
    v_mfma_f32_16x16x32_bf16 v[192:195], a[76:79], v[144:147], v[192:195]
    v_mfma_f32_16x16x32_bf16 v[196:199], a[60:63], v[148:151], v[196:199]
    s_add_u32 s55, s71, 0
    buffer_load_dwordx4 v[20:23], v3, s[32:35], s55 offen sc1
    v_mfma_f32_16x16x32_bf16 v[200:203], a[64:67], v[148:151], v[200:203]
    v_mfma_f32_16x16x32_bf16 v[204:207], a[68:71], v[148:151], v[204:207]
    v_mfma_f32_16x16x32_bf16 v[208:211], a[72:75], v[148:151], v[208:211]
    s_add_u32 s55, s72, 0
    buffer_load_dwordx4 v[24:27], v3, s[32:35], s55 offen sc1
    v_mfma_f32_16x16x32_bf16 v[212:215], a[76:79], v[148:151], v[212:215]
    v_mfma_f32_16x16x32_bf16 v[216:219], a[60:63], v[152:155], v[216:219]
    v_mfma_f32_16x16x32_bf16 v[220:223], a[64:67], v[152:155], v[220:223]
    s_add_u32 s55, s73, 0
    buffer_load_dwordx4 v[28:31], v3, s[32:35], s55 offen sc1
    v_mfma_f32_16x16x32_bf16 v[224:227], a[68:71], v[152:155], v[224:227]
    v_mfma_f32_16x16x32_bf16 v[228:231], a[72:75], v[152:155], v[228:231]
    v_mfma_f32_16x16x32_bf16 v[232:235], a[76:79], v[152:155], v[232:235]
    s_add_u32 s55, s70, 16384
    buffer_load_dwordx4 v[32:35], v3, s[32:35], s55 offen sc1
    v_mfma_f32_16x16x32_bf16 v[236:239], a[60:63], v[156:159], v[236:239]
    v_mfma_f32_16x16x32_bf16 v[240:243], a[64:67], v[156:159], v[240:243]
    v_mfma_f32_16x16x32_bf16 v[244:247], a[68:71], v[156:159], v[244:247]
    s_add_u32 s55, s71, 16384
    buffer_load_dwordx4 v[36:39], v3, s[32:35], s55 offen sc1
    v_mfma_f32_16x16x32_bf16 v[248:251], a[72:75], v[156:159], v[248:251]
    v_mfma_f32_16x16x32_bf16 v[252:255], a[76:79], v[156:159], v[252:255]
    s_cmp_eq_u32 s62, 0
    s_cbranch_scc0 L_gateslow_19
L_gateok_20:
    s_waitcnt vmcnt(5)
    v_mfma_f32_16x16x32_bf16 v[96:99], a[80:83], v[16:19], 0
    s_add_u32 s55, s72, 16384
    buffer_load_dwordx4 v[40:43], v2, s[32:35], s55 offen sc1
    ds_read_b128 a[60:63], v88 offset:11264
    v_mfma_f32_16x16x32_bf16 v[100:103], a[84:87], v[16:19], 0
    ds_read_b128 a[64:67], v88 offset:12288
    ds_read_b128 a[68:71], v88 offset:13312
    v_mfma_f32_16x16x32_bf16 v[104:107], a[88:91], v[16:19], 0
    v_and_b32 v90, 3, v1
    v_lshlrev_b32 v90, 3, v90
    s_mul_i32 s3, s49, 160
    v_add_u32 v90, s3, v90
    ds_read_b128 a[72:75], v88 offset:14336
    v_mfma_f32_16x16x32_bf16 v[108:111], a[92:95], v[16:19], 0
    s_add_u32 s55, s73, 16384
    buffer_load_dwordx4 v[44:47], v2, s[32:35], s55 offen sc1
    ds_read_b128 a[76:79], v88 offset:15360
    v_mfma_f32_16x16x32_bf16 v[112:115], a[96:99], v[16:19], 0
    buffer_load_dwordx2 v[64:65], v90, s[44:47], 0 offen offset:0
    s_waitcnt vmcnt(7)
    v_mfma_f32_16x16x32_bf16 v[116:119], a[80:83], v[20:23], 0
    v_mfma_f32_16x16x32_bf16 v[120:123], a[84:87], v[20:23], 0
    s_add_u32 s55, s70, 32768
    buffer_load_dwordx4 a[240:243], v2, s[32:35], s55 offen sc1
    v_mfma_f32_16x16x32_bf16 v[124:127], a[88:91], v[20:23], 0
    v_mfma_f32_16x16x32_bf16 v[128:131], a[92:95], v[20:23], 0
    buffer_load_dwordx2 v[66:67], v90, s[44:47], 0 offen offset:32
    v_mfma_f32_16x16x32_bf16 v[132:135], a[96:99], v[20:23], 0
    s_add_u32 s55, s71, 32768
    buffer_load_dwordx4 a[244:247], v2, s[32:35], s55 offen sc1
    s_waitcnt vmcnt(9)
    v_mfma_f32_16x16x32_bf16 v[136:139], a[80:83], v[24:27], 0
    buffer_load_dwordx2 v[68:69], v90, s[44:47], 0 offen offset:64
    v_mfma_f32_16x16x32_bf16 v[140:143], a[84:87], v[24:27], 0
    v_mfma_f32_16x16x32_bf16 v[144:147], a[88:91], v[24:27], 0
    s_add_u32 s55, s72, 32768
    buffer_load_dwordx4 a[248:251], v2, s[32:35], s55 offen sc1
    v_mfma_f32_16x16x32_bf16 v[148:151], a[92:95], v[24:27], 0
    v_mfma_f32_16x16x32_bf16 v[152:155], a[96:99], v[24:27], 0
    buffer_load_dwordx2 v[70:71], v90, s[44:47], 0 offen offset:96
    s_waitcnt vmcnt(11)
    v_mfma_f32_16x16x32_bf16 v[156:159], a[80:83], v[28:31], 0
    s_add_u32 s55, s73, 32768
    buffer_load_dwordx4 a[252:255], v2, s[32:35], s55 offen sc1
    v_mfma_f32_16x16x32_bf16 v[160:163], a[84:87], v[28:31], 0
    buffer_load_dwordx2 v[72:73], v90, s[44:47], 0 offen offset:128
    v_mfma_f32_16x16x32_bf16 v[164:167], a[88:91], v[28:31], 0
    v_mfma_f32_16x16x32_bf16 v[168:171], a[92:95], v[28:31], 0
    v_mfma_f32_16x16x32_bf16 v[172:175], a[96:99], v[28:31], 0
    s_mov_b64 exec, 0x38
    buffer_load_dwordx2 v[62:63], v89, s[32:35], s60 offen sc1
    s_mov_b64 exec, -1
    s_waitcnt lgkmcnt(0)
    s_barrier
    s_waitcnt vmcnt(13)
    v_mfma_f32_16x16x32_bf16 v[96:99], a[100:103], v[32:35], v[96:99]
    v_mfma_f32_16x16x32_bf16 v[100:103], a[104:107], v[32:35], v[100:103]
    v_mfma_f32_16x16x32_bf16 v[104:107], a[108:111], v[32:35], v[104:107]
    v_mfma_f32_16x16x32_bf16 v[108:111], a[112:115], v[32:35], v[108:111]
    v_mfma_f32_16x16x32_bf16 v[112:115], a[116:119], v[32:35], v[112:115]
    s_waitcnt vmcnt(12)
    v_mfma_f32_16x16x32_bf16 v[116:119], a[100:103], v[36:39], v[116:119]
    v_mfma_f32_16x16x32_bf16 v[120:123], a[104:107], v[36:39], v[120:123]
    v_mfma_f32_16x16x32_bf16 v[124:127], a[108:111], v[36:39], v[124:127]
    v_mfma_f32_16x16x32_bf16 v[128:131], a[112:115], v[36:39], v[128:131]
    v_mfma_f32_16x16x32_bf16 v[132:135], a[116:119], v[36:39], v[132:135]
    s_waitcnt vmcnt(11)
    v_mfma_f32_16x16x32_bf16 v[136:139], a[100:103], v[40:43], v[136:139]
    v_mfma_f32_16x16x32_bf16 v[140:143], a[104:107], v[40:43], v[140:143]
    v_mfma_f32_16x16x32_bf16 v[144:147], a[108:111], v[40:43], v[144:147]
    v_mfma_f32_16x16x32_bf16 v[148:151], a[112:115], v[40:43], v[148:151]
    v_mfma_f32_16x16x32_bf16 v[152:155], a[116:119], v[40:43], v[152:155]
    s_waitcnt vmcnt(10)
    v_mfma_f32_16x16x32_bf16 v[156:159], a[100:103], v[44:47], v[156:159]
    v_mfma_f32_16x16x32_bf16 v[160:163], a[104:107], v[44:47], v[160:163]
    v_mfma_f32_16x16x32_bf16 v[164:167], a[108:111], v[44:47], v[164:167]
    v_mfma_f32_16x16x32_bf16 v[168:171], a[112:115], v[44:47], v[168:171]
    v_mfma_f32_16x16x32_bf16 v[172:175], a[116:119], v[44:47], v[172:175]
    s_waitcnt vmcnt(0)
    v_cmp_eq_u64 vcc, s[50:51], v[62:63]
    s_nop 0
    s_and_b32 s3, vcc_lo, 0x38
    s_cmp_eq_u32 s3, 0x38
    s_cselect_b32 s62, 0, 2130706432
    v_or_b32 v3, s62, v2
    v_mfma_f32_16x16x32_bf16 v[96:99], a[120:123], a[240:243], v[96:99]
    v_mfma_f32_16x16x32_bf16 v[100:103], a[124:127], a[240:243], v[100:103]
    v_mfma_f32_16x16x32_bf16 v[104:107], a[128:131], a[240:243], v[104:107]
    s_add_u32 s55, s70, 49152
    buffer_load_dwordx4 a[0:3], v3, s[32:35], s55 offen sc1
    v_mfma_f32_16x16x32_bf16 v[108:111], a[132:135], a[240:243], v[108:111]
    v_mfma_f32_16x16x32_bf16 v[112:115], a[136:139], a[240:243], v[112:115]
    v_mfma_f32_16x16x32_bf16 v[116:119], a[120:123], a[244:247], v[116:119]
    s_add_u32 s55, s71, 49152
    buffer_load_dwordx4 a[4:7], v3, s[32:35], s55 offen sc1
    v_mfma_f32_16x16x32_bf16 v[120:123], a[124:127], a[244:247], v[120:123]
    v_mfma_f32_16x16x32_bf16 v[124:127], a[128:131], a[244:247], v[124:127]
    v_mfma_f32_16x16x32_bf16 v[128:131], a[132:135], a[244:247], v[128:131]
    s_add_u32 s55, s72, 49152
    buffer_load_dwordx4 a[8:11], v3, s[32:35], s55 offen sc1
    v_mfma_f32_16x16x32_bf16 v[132:135], a[136:139], a[244:247], v[132:135]
    v_mfma_f32_16x16x32_bf16 v[136:139], a[120:123], a[248:251], v[136:139]
    v_mfma_f32_16x16x32_bf16 v[140:143], a[124:127], a[248:251], v[140:143]
    s_add_u32 s55, s73, 49152
    buffer_load_dwordx4 a[12:15], v3, s[32:35], s55 offen sc1
    v_mfma_f32_16x16x32_bf16 v[144:147], a[128:131], a[248:251], v[144:147]
    v_mfma_f32_16x16x32_bf16 v[148:151], a[132:135], a[248:251], v[148:151]
    v_mfma_f32_16x16x32_bf16 v[152:155], a[136:139], a[248:251], v[152:155]
    s_add_u32 s55, s70, 65536
    buffer_load_dwordx4 a[16:19], v3, s[32:35], s55 offen sc1
    v_mfma_f32_16x16x32_bf16 v[156:159], a[120:123], a[252:255], v[156:159]
    v_mfma_f32_16x16x32_bf16 v[160:163], a[124:127], a[252:255], v[160:163]
    v_mfma_f32_16x16x32_bf16 v[164:167], a[128:131], a[252:255], v[164:167]
    s_add_u32 s55, s71, 65536
    buffer_load_dwordx4 a[20:23], v3, s[32:35], s55 offen sc1
    v_mfma_f32_16x16x32_bf16 v[168:171], a[132:135], a[252:255], v[168:171]
    v_mfma_f32_16x16x32_bf16 v[172:175], a[136:139], a[252:255], v[172:175]
    s_cmp_eq_u32 s62, 0
    s_cbranch_scc0 L_gateslow_23
L_gateok_24:
    s_mov_b64 exec, 0x1fffc0
    buffer_load_dwordx2 v[8:9], v89, s[32:35], s60 offen sc1
    s_mov_b64 exec, -1
    s_waitcnt vmcnt(6)
    v_mfma_f32_16x16x32_bf16 v[96:99], a[140:143], a[0:3], v[96:99]
    s_add_u32 s55, s72, 65536
    buffer_load_dwordx4 a[24:27], v2, s[32:35], s55 offen sc1
    v_mfma_f32_16x16x32_bf16 v[100:103], a[144:147], a[0:3], v[100:103]
    v_lshlrev_b32 v74, 16, v48
    v_and_b32 v48, 0xffff0000, v48
    v_mfma_f32_16x16x32_bf16 v[104:107], a[148:151], a[0:3], v[104:107]
    v_lshlrev_b32 v75, 16, v64
    v_and_b32 v64, 0xffff0000, v64
    v_mfma_f32_16x16x32_bf16 v[108:111], a[152:155], a[0:3], v[108:111]
    s_add_u32 s55, s73, 65536
    buffer_load_dwordx4 a[28:31], v2, s[32:35], s55 offen sc1
    v_mul_f32 v74, v74, v75
    v_mfma_f32_16x16x32_bf16 v[112:115], a[156:159], a[0:3], v[112:115]
    v_mul_f32 v48, v48, v64
    v_cvt_pk_bf16_f32 v48, v74, v48
    s_waitcnt vmcnt(7)
    v_mfma_f32_16x16x32_bf16 v[116:119], a[140:143], a[4:7], v[116:119]
    v_lshlrev_b32 v76, 16, v49
    v_and_b32 v49, 0xffff0000, v49
    v_mfma_f32_16x16x32_bf16 v[120:123], a[144:147], a[4:7], v[120:123]
    s_add_u32 s55, s70, 81920
    buffer_load_dwordx4 a[32:35], v2, s[32:35], s55 offen sc1
    v_lshlrev_b32 v77, 16, v65
    v_mfma_f32_16x16x32_bf16 v[124:127], a[148:151], a[4:7], v[124:127]
    v_and_b32 v65, 0xffff0000, v65
    v_mul_f32 v76, v76, v77
    v_mfma_f32_16x16x32_bf16 v[128:131], a[152:155], a[4:7], v[128:131]
    v_mul_f32 v49, v49, v65
    v_cvt_pk_bf16_f32 v49, v76, v49
    v_mfma_f32_16x16x32_bf16 v[132:135], a[156:159], a[4:7], v[132:135]
    s_add_u32 s55, s71, 81920
    buffer_load_dwordx4 a[36:39], v2, s[32:35], s55 offen sc1
    v_lshlrev_b32 v74, 16, v50
    s_waitcnt vmcnt(8)
    v_mfma_f32_16x16x32_bf16 v[136:139], a[140:143], a[8:11], v[136:139]
    v_and_b32 v50, 0xffff0000, v50
    v_lshlrev_b32 v75, 16, v66
    v_mfma_f32_16x16x32_bf16 v[140:143], a[144:147], a[8:11], v[140:143]
    v_and_b32 v66, 0xffff0000, v66
    v_mul_f32 v74, v74, v75
    v_mfma_f32_16x16x32_bf16 v[144:147], a[148:151], a[8:11], v[144:147]
    s_add_u32 s55, s72, 81920
    buffer_load_dwordx4 v[16:19], v2, s[32:35], s55 offen sc1
    v_mul_f32 v50, v50, v66
    v_mfma_f32_16x16x32_bf16 v[148:151], a[152:155], a[8:11], v[148:151]
    v_cvt_pk_bf16_f32 v50, v74, v50
    v_lshlrev_b32 v76, 16, v51
    v_mfma_f32_16x16x32_bf16 v[152:155], a[156:159], a[8:11], v[152:155]
    v_and_b32 v51, 0xffff0000, v51
    v_lshlrev_b32 v77, 16, v67
    s_waitcnt vmcnt(8)
    v_mfma_f32_16x16x32_bf16 v[156:159], a[140:143], a[12:15], v[156:159]
    s_add_u32 s55, s73, 81920
    buffer_load_dwordx4 v[20:23], v2, s[32:35], s55 offen sc1
    v_and_b32 v67, 0xffff0000, v67
    v_mfma_f32_16x16x32_bf16 v[160:163], a[144:147], a[12:15], v[160:163]
    v_mul_f32 v76, v76, v77
    v_mul_f32 v51, v51, v67
    v_mfma_f32_16x16x32_bf16 v[164:167], a[148:151], a[12:15], v[164:167]
    v_cvt_pk_bf16_f32 v51, v76, v51
    v_lshlrev_b32 v74, 16, v52
    v_mfma_f32_16x16x32_bf16 v[168:171], a[152:155], a[12:15], v[168:171]
    v_and_b32 v52, 0xffff0000, v52
    v_lshlrev_b32 v75, 16, v68
    v_mfma_f32_16x16x32_bf16 v[172:175], a[156:159], a[12:15], v[172:175]
    v_and_b32 v68, 0xffff0000, v68
    v_mul_f32 v74, v74, v75
    s_waitcnt vmcnt(6)
    v_cmp_eq_u64 vcc, s[50:51], v[8:9]
    s_nop 0
    s_and_b32 s3, vcc_lo, 0x1fffc0
    s_cmp_eq_u32 s3, 0x1fffc0
    s_cselect_b32 s62, 0, 2130706432
    v_or_b32 v3, s62, v2
    v_mfma_f32_16x16x32_bf16 v[96:99], a[160:163], a[16:19], v[96:99]
    v_mul_f32 v52, v52, v68
    v_cvt_pk_bf16_f32 v52, v74, v52
    v_mfma_f32_16x16x32_bf16 v[100:103], a[164:167], a[16:19], v[100:103]
    s_add_u32 s55, s70, 98304
    buffer_load_dwordx4 v[24:27], v3, s[32:35], s55 offen sc1
    v_lshlrev_b32 v76, 16, v53
    v_mfma_f32_16x16x32_bf16 v[104:107], a[168:171], a[16:19], v[104:107]
    v_and_b32 v53, 0xffff0000, v53
    v_lshlrev_b32 v77, 16, v69
    v_mfma_f32_16x16x32_bf16 v[108:111], a[172:175], a[16:19], v[108:111]
    v_and_b32 v69, 0xffff0000, v69
    v_mul_f32 v76, v76, v77
    v_mfma_f32_16x16x32_bf16 v[112:115], a[176:179], a[16:19], v[112:115]
    s_add_u32 s55, s70, 114688
    buffer_load_dwordx4 v[28:31], v3, s[32:35], s55 offen sc1
    v_mul_f32 v53, v53, v69
    v_mfma_f32_16x16x32_bf16 v[116:119], a[160:163], a[20:23], v[116:119]
    v_cvt_pk_bf16_f32 v53, v76, v53
    v_lshlrev_b32 v74, 16, v54
    v_mfma_f32_16x16x32_bf16 v[120:123], a[164:167], a[20:23], v[120:123]
    v_and_b32 v54, 0xffff0000, v54
    v_lshlrev_b32 v75, 16, v70
    v_mfma_f32_16x16x32_bf16 v[124:127], a[168:171], a[20:23], v[124:127]
    s_add_u32 s55, s70, 131072
    buffer_load_dwordx4 v[32:35], v3, s[32:35], s55 offen sc1
    v_and_b32 v70, 0xffff0000, v70
    v_mfma_f32_16x16x32_bf16 v[128:131], a[172:175], a[20:23], v[128:131]
    v_mul_f32 v74, v74, v75
    v_mul_f32 v54, v54, v70
    v_mfma_f32_16x16x32_bf16 v[132:135], a[176:179], a[20:23], v[132:135]
    v_cvt_pk_bf16_f32 v54, v74, v54
    v_lshlrev_b32 v76, 16, v55
    s_waitcnt vmcnt(8)
    v_mfma_f32_16x16x32_bf16 v[136:139], a[160:163], a[24:27], v[136:139]
    s_add_u32 s55, s70, 147456
    buffer_load_dwordx4 v[36:39], v3, s[32:35], s55 offen sc1
    v_and_b32 v55, 0xffff0000, v55
    v_mfma_f32_16x16x32_bf16 v[140:143], a[164:167], a[24:27], v[140:143]
    v_lshlrev_b32 v77, 16, v71
    v_and_b32 v71, 0xffff0000, v71
    v_mfma_f32_16x16x32_bf16 v[144:147], a[168:171], a[24:27], v[144:147]
    v_mul_f32 v76, v76, v77
    v_mul_f32 v55, v55, v71
    v_mfma_f32_16x16x32_bf16 v[148:151], a[172:175], a[24:27], v[148:151]
    s_add_u32 s55, s71, 98304
    buffer_load_dwordx4 v[40:43], v3, s[32:35], s55 offen sc1
    v_cvt_pk_bf16_f32 v55, v76, v55
    v_mfma_f32_16x16x32_bf16 v[152:155], a[176:179], a[24:27], v[152:155]
    v_lshlrev_b32 v74, 16, v56
    v_and_b32 v56, 0xffff0000, v56
    s_waitcnt vmcnt(9)
    v_mfma_f32_16x16x32_bf16 v[156:159], a[160:163], a[28:31], v[156:159]
    v_lshlrev_b32 v75, 16, v72
    v_and_b32 v72, 0xffff0000, v72
    v_mfma_f32_16x16x32_bf16 v[160:163], a[164:167], a[28:31], v[160:163]
    s_add_u32 s55, s71, 114688
    buffer_load_dwordx4 v[44:47], v3, s[32:35], s55 offen sc1
    v_mul_f32 v74, v74, v75
    v_mfma_f32_16x16x32_bf16 v[164:167], a[168:171], a[28:31], v[164:167]
    v_mul_f32 v56, v56, v72
    v_cvt_pk_bf16_f32 v56, v74, v56
    v_mfma_f32_16x16x32_bf16 v[168:171], a[172:175], a[28:31], v[168:171]
    v_lshlrev_b32 v76, 16, v57
    v_and_b32 v57, 0xffff0000, v57
    v_mfma_f32_16x16x32_bf16 v[172:175], a[176:179], a[28:31], v[172:175]
    s_add_u32 s55, s71, 131072
    buffer_load_dwordx4 a[240:243], v3, s[32:35], s55 offen sc1
    v_lshlrev_b32 v77, 16, v73
    s_waitcnt vmcnt(10)
    v_mfma_f32_16x16x32_bf16 v[96:99], a[180:183], a[32:35], v[96:99]
    v_and_b32 v73, 0xffff0000, v73
    v_mul_f32 v76, v76, v77
    v_mfma_f32_16x16x32_bf16 v[100:103], a[184:187], a[32:35], v[100:103]
    v_mul_f32 v57, v57, v73
    v_cvt_pk_bf16_f32 v57, v76, v57
    v_mfma_f32_16x16x32_bf16 v[104:107], a[188:191], a[32:35], v[104:107]
    s_add_u32 s55, s71, 147456
    buffer_load_dwordx4 a[244:247], v3, s[32:35], s55 offen sc1
    v_mfma_f32_16x16x32_bf16 v[108:111], a[192:195], a[32:35], v[108:111]
    v_mfma_f32_16x16x32_bf16 v[112:115], a[196:199], a[32:35], v[112:115]
    s_waitcnt vmcnt(10)
    v_mfma_f32_16x16x32_bf16 v[116:119], a[180:183], a[36:39], v[116:119]
    s_add_u32 s55, s72, 98304
    buffer_load_dwordx4 a[248:251], v3, s[32:35], s55 offen sc1
    v_mfma_f32_16x16x32_bf16 v[120:123], a[184:187], a[36:39], v[120:123]
    v_mfma_f32_16x16x32_bf16 v[124:127], a[188:191], a[36:39], v[124:127]
    v_mfma_f32_16x16x32_bf16 v[128:131], a[192:195], a[36:39], v[128:131]
    s_add_u32 s55, s72, 114688
    buffer_load_dwordx4 a[252:255], v3, s[32:35], s55 offen sc1
    v_mfma_f32_16x16x32_bf16 v[132:135], a[196:199], a[36:39], v[132:135]
    s_waitcnt vmcnt(11)
    v_mfma_f32_16x16x32_bf16 v[136:139], a[180:183], v[16:19], v[136:139]
    v_mfma_f32_16x16x32_bf16 v[140:143], a[184:187], v[16:19], v[140:143]
    s_add_u32 s55, s72, 131072
    buffer_load_dwordx4 a[0:3], v3, s[32:35], s55 offen sc1
    v_mfma_f32_16x16x32_bf16 v[144:147], a[188:191], v[16:19], v[144:147]
    v_mfma_f32_16x16x32_bf16 v[148:151], a[192:195], v[16:19], v[148:151]
    v_mfma_f32_16x16x32_bf16 v[152:155], a[196:199], v[16:19], v[152:155]
    s_add_u32 s55, s72, 147456
    buffer_load_dwordx4 a[4:7], v3, s[32:35], s55 offen sc1
    s_waitcnt vmcnt(12)
    v_mfma_f32_16x16x32_bf16 v[156:159], a[180:183], v[20:23], v[156:159]
    v_mfma_f32_16x16x32_bf16 v[160:163], a[184:187], v[20:23], v[160:163]
    v_mfma_f32_16x16x32_bf16 v[164:167], a[188:191], v[20:23], v[164:167]
    s_add_u32 s55, s73, 98304
    buffer_load_dwordx4 a[8:11], v3, s[32:35], s55 offen sc1
    v_mfma_f32_16x16x32_bf16 v[168:171], a[192:195], v[20:23], v[168:171]
    v_mfma_f32_16x16x32_bf16 v[172:175], a[196:199], v[20:23], v[172:175]
    s_cmp_eq_u32 s62, 0
    s_cbranch_scc0 L_gateslow_27
L_gateok_28:
    s_waitcnt vmcnt(12)
    v_mfma_f32_16x16x32_bf16 v[96:99], a[200:203], v[24:27], v[96:99]
    s_add_u32 s55, s73, 114688
    buffer_load_dwordx4 a[12:15], v2, s[32:35], s55 offen sc1
    s_lshl_b32 s3, s24, 5
    s_add_u32 s3, s3, s59
    buffer_load_dword v58, v11, s[32:35], s3 offen sc1
    v_mfma_f32_16x16x32_bf16 v[100:103], a[204:207], v[24:27], v[100:103]
    s_lshl_b32 s3, s25, 5
    s_add_u32 s3, s3, s59
    buffer_load_dword v59, v11, s[32:35], s3 offen sc1
    s_lshl_b32 s3, s26, 5
    s_add_u32 s3, s3, s59
    buffer_load_dword v60, v11, s[32:35], s3 offen sc1
    v_mfma_f32_16x16x32_bf16 v[104:107], a[208:211], v[24:27], v[104:107]
    s_lshl_b32 s3, s27, 5
    s_add_u32 s3, s3, s59
    buffer_load_dword v61, v11, s[32:35], s3 offen sc1
    s_mov_b32 s3, 16613376
    buffer_load_dword v10, v10, s[32:35], s3 offen sc1
    v_mfma_f32_16x16x32_bf16 v[108:111], a[212:215], v[24:27], v[108:111]
    s_add_u32 s55, s73, 131072
    buffer_load_dwordx4 a[16:19], v2, s[32:35], s55 offen sc1
    v_mfma_f32_16x16x32_bf16 v[112:115], a[216:219], v[24:27], v[112:115]
    s_waitcnt vmcnt(18)
    v_mfma_f32_16x16x32_bf16 v[96:99], a[220:223], v[28:31], v[96:99]
    v_mfma_f32_16x16x32_bf16 v[100:103], a[224:227], v[28:31], v[100:103]
    s_add_u32 s55, s73, 147456
    buffer_load_dwordx4 a[20:23], v2, s[32:35], s55 offen sc1
    v_mfma_f32_16x16x32_bf16 v[104:107], a[228:231], v[28:31], v[104:107]
    v_mfma_f32_16x16x32_bf16 v[108:111], a[232:235], v[28:31], v[108:111]
    v_mfma_f32_16x16x32_bf16 v[112:115], a[236:239], v[28:31], v[112:115]
    s_add_u32 s55, s74, 0
    buffer_load_dwordx4 a[24:27], v2, s[32:35], s55 offen sc1
    s_waitcnt vmcnt(19)
    v_mfma_f32_16x16x32_bf16 v[96:99], a[40:43], v[32:35], v[96:99]
    v_mfma_f32_16x16x32_bf16 v[100:103], a[44:47], v[32:35], v[100:103]
    v_mfma_f32_16x16x32_bf16 v[104:107], a[48:51], v[32:35], v[104:107]
    s_add_u32 s55, s75, 0
    buffer_load_dwordx4 a[28:31], v2, s[32:35], s55 offen sc1
    v_mfma_f32_16x16x32_bf16 v[108:111], a[52:55], v[32:35], v[108:111]
    v_mfma_f32_16x16x32_bf16 v[112:115], a[56:59], v[32:35], v[112:115]
    s_waitcnt vmcnt(19)
    v_mfma_f32_16x16x32_bf16 v[96:99], a[60:63], v[36:39], v[96:99]
    s_add_u32 s55, s76, 0
    buffer_load_dwordx4 a[32:35], v2, s[32:35], s55 offen sc1
    v_mfma_f32_16x16x32_bf16 v[100:103], a[64:67], v[36:39], v[100:103]
    v_mfma_f32_16x16x32_bf16 v[104:107], a[68:71], v[36:39], v[104:107]
    v_mfma_f32_16x16x32_bf16 v[108:111], a[72:75], v[36:39], v[108:111]
    s_add_u32 s55, s77, 0
    buffer_load_dwordx4 a[36:39], v2, s[32:35], s55 offen sc1
    v_mfma_f32_16x16x32_bf16 v[112:115], a[76:79], v[36:39], v[112:115]
    s_waitcnt vmcnt(20)
    v_mfma_f32_16x16x32_bf16 v[116:119], a[200:203], v[40:43], v[116:119]
    s_mul_i32 s3, s24, 20480
    s_add_u32 s3, s3, 0
    v_add_u32 v4, s3, v7
    ds_write_b128 v4, v[96:99] offset:0
    v_mfma_f32_16x16x32_bf16 v[120:123], a[204:207], v[40:43], v[120:123]
    s_add_u32 s55, s74, 16384
    buffer_load_dwordx4 v[16:19], v2, s[32:35], s55 offen sc1
    v_mfma_f32_16x16x32_bf16 v[124:127], a[208:211], v[40:43], v[124:127]
    ds_write_b128 v4, v[100:103] offset:64
    v_mfma_f32_16x16x32_bf16 v[128:131], a[212:215], v[40:43], v[128:131]
    v_mfma_f32_16x16x32_bf16 v[132:135], a[216:219], v[40:43], v[132:135]
    s_add_u32 s55, s75, 16384
    buffer_load_dwordx4 v[20:23], v2, s[32:35], s55 offen sc1
    s_waitcnt vmcnt(21)
    v_mfma_f32_16x16x32_bf16 v[116:119], a[220:223], v[44:47], v[116:119]
    v_mfma_f32_16x16x32_bf16 v[120:123], a[224:227], v[44:47], v[120:123]
    ds_write_b128 v4, v[104:107] offset:128
    v_mfma_f32_16x16x32_bf16 v[124:127], a[228:231], v[44:47], v[124:127]
    s_add_u32 s55, s76, 16384
    buffer_load_dwordx4 v[24:27], v2, s[32:35], s55 offen sc1
    v_mfma_f32_16x16x32_bf16 v[128:131], a[232:235], v[44:47], v[128:131]
    ds_write_b128 v4, v[108:111] offset:192
    v_mfma_f32_16x16x32_bf16 v[132:135], a[236:239], v[44:47], v[132:135]
    s_waitcnt vmcnt(21)
    v_mfma_f32_16x16x32_bf16 v[116:119], a[40:43], a[240:243], v[116:119]
    s_add_u32 s55, s77, 16384
    buffer_load_dwordx4 v[28:31], v2, s[32:35], s55 offen sc1
    v_mfma_f32_16x16x32_bf16 v[120:123], a[44:47], a[240:243], v[120:123]
    v_mfma_f32_16x16x32_bf16 v[124:127], a[48:51], a[240:243], v[124:127]
    ds_write_b128 v4, v[112:115] offset:256
    v_mfma_f32_16x16x32_bf16 v[128:131], a[52:55], a[240:243], v[128:131]
    s_add_u32 s55, s74, 32768
    buffer_load_dwordx4 v[32:35], v2, s[32:35], s55 offen sc1
    v_mfma_f32_16x16x32_bf16 v[132:135], a[56:59], a[240:243], v[132:135]
    s_waitcnt vmcnt(22)
    v_mfma_f32_16x16x32_bf16 v[116:119], a[60:63], a[244:247], v[116:119]
    v_mfma_f32_16x16x32_bf16 v[120:123], a[64:67], a[244:247], v[120:123]
    s_add_u32 s55, s75, 32768
    buffer_load_dwordx4 v[36:39], v2, s[32:35], s55 offen sc1
    v_mfma_f32_16x16x32_bf16 v[124:127], a[68:71], a[244:247], v[124:127]
    v_mfma_f32_16x16x32_bf16 v[128:131], a[72:75], a[244:247], v[128:131]
    v_mfma_f32_16x16x32_bf16 v[132:135], a[76:79], a[244:247], v[132:135]
    s_add_u32 s55, s76, 32768
    buffer_load_dwordx4 v[40:43], v2, s[32:35], s55 offen sc1
    s_waitcnt vmcnt(23)
    v_mfma_f32_16x16x32_bf16 v[136:139], a[200:203], a[248:251], v[136:139]
    s_mul_i32 s3, s25, 20480
    s_add_u32 s3, s3, 0
    v_add_u32 v4, s3, v7
    ds_write_b128 v4, v[116:119] offset:5120
    v_mfma_f32_16x16x32_bf16 v[140:143], a[204:207], a[248:251], v[140:143]
    v_mfma_f32_16x16x32_bf16 v[144:147], a[208:211], a[248:251], v[144:147]
    s_add_u32 s55, s77, 32768
    buffer_load_dwordx4 v[44:47], v2, s[32:35], s55 offen sc1
    v_mfma_f32_16x16x32_bf16 v[148:151], a[212:215], a[248:251], v[148:151]
    v_mfma_f32_16x16x32_bf16 v[152:155], a[216:219], a[248:251], v[152:155]
    ds_write_b128 v4, v[120:123] offset:5184
    s_waitcnt vmcnt(23)
    v_mfma_f32_16x16x32_bf16 v[136:139], a[220:223], a[252:255], v[136:139]
    s_add_u32 s55, s74, 49152
    buffer_load_dwordx4 a[240:243], v2, s[32:35], s55 offen sc1
    v_mfma_f32_16x16x32_bf16 v[140:143], a[224:227], a[252:255], v[140:143]
    ds_write_b128 v4, v[124:127] offset:5248
    v_mfma_f32_16x16x32_bf16 v[144:147], a[228:231], a[252:255], v[144:147]
    v_mfma_f32_16x16x32_bf16 v[148:151], a[232:235], a[252:255], v[148:151]
    s_add_u32 s55, s75, 49152
    buffer_load_dwordx4 a[244:247], v2, s[32:35], s55 offen sc1
    v_mfma_f32_16x16x32_bf16 v[152:155], a[236:239], a[252:255], v[152:155]
    s_waitcnt vmcnt(24)
    v_mfma_f32_16x16x32_bf16 v[136:139], a[40:43], a[0:3], v[136:139]
    ds_write_b128 v4, v[128:131] offset:5312
    v_mfma_f32_16x16x32_bf16 v[140:143], a[44:47], a[0:3], v[140:143]
    s_add_u32 s55, s76, 49152
    buffer_load_dwordx4 a[248:251], v2, s[32:35], s55 offen sc1
    v_mfma_f32_16x16x32_bf16 v[144:147], a[48:51], a[0:3], v[144:147]
    ds_write_b128 v4, v[132:135] offset:5376
    v_mfma_f32_16x16x32_bf16 v[148:151], a[52:55], a[0:3], v[148:151]
    v_mfma_f32_16x16x32_bf16 v[152:155], a[56:59], a[0:3], v[152:155]
    s_add_u32 s55, s77, 49152
    buffer_load_dwordx4 a[252:255], v2, s[32:35], s55 offen sc1
    s_waitcnt vmcnt(25)
    v_mfma_f32_16x16x32_bf16 v[136:139], a[60:63], a[4:7], v[136:139]
    v_mfma_f32_16x16x32_bf16 v[140:143], a[64:67], a[4:7], v[140:143]
    v_mfma_f32_16x16x32_bf16 v[144:147], a[68:71], a[4:7], v[144:147]
    s_add_u32 s55, s74, 65536
    buffer_load_dwordx4 a[0:3], v2, s[32:35], s55 offen sc1
    v_mfma_f32_16x16x32_bf16 v[148:151], a[72:75], a[4:7], v[148:151]
    v_mfma_f32_16x16x32_bf16 v[152:155], a[76:79], a[4:7], v[152:155]
    s_waitcnt vmcnt(25)
    v_mfma_f32_16x16x32_bf16 v[156:159], a[200:203], a[8:11], v[156:159]
    s_add_u32 s55, s75, 65536
    buffer_load_dwordx4 a[4:7], v2, s[32:35], s55 offen sc1
    v_mfma_f32_16x16x32_bf16 v[160:163], a[204:207], a[8:11], v[160:163]
    v_mfma_f32_16x16x32_bf16 v[164:167], a[208:211], a[8:11], v[164:167]
    s_mul_i32 s3, s26, 20480
    s_add_u32 s3, s3, 0
    v_add_u32 v4, s3, v7
    ds_write_b128 v4, v[136:139] offset:10240
    v_mfma_f32_16x16x32_bf16 v[168:171], a[212:215], a[8:11], v[168:171]
    v_mfma_f32_16x16x32_bf16 v[172:175], a[216:219], a[8:11], v[172:175]
    ds_write_b128 v4, v[140:143] offset:10304
    s_waitcnt vmcnt(25)
    v_mfma_f32_16x16x32_bf16 v[156:159], a[220:223], a[12:15], v[156:159]
    v_mfma_f32_16x16x32_bf16 v[160:163], a[224:227], a[12:15], v[160:163]
    s_add_u32 s55, s76, 65536
    buffer_load_dwordx4 a[8:11], v2, s[32:35], s55 offen sc1
    v_mfma_f32_16x16x32_bf16 v[164:167], a[228:231], a[12:15], v[164:167]
    v_mfma_f32_16x16x32_bf16 v[168:171], a[232:235], a[12:15], v[168:171]
    ds_write_b128 v4, v[144:147] offset:10368
    v_mfma_f32_16x16x32_bf16 v[172:175], a[236:239], a[12:15], v[172:175]
    s_add_u32 s55, s77, 65536
    buffer_load_dwordx4 a[12:15], v2, s[32:35], s55 offen sc1
    s_waitcnt vmcnt(21)
    v_mfma_f32_16x16x32_bf16 v[156:159], a[40:43], a[16:19], v[156:159]
    ds_write_b128 v4, v[148:151] offset:10432
    v_mfma_f32_16x16x32_bf16 v[160:163], a[44:47], a[16:19], v[160:163]
    v_mfma_f32_16x16x32_bf16 v[164:167], a[48:51], a[16:19], v[164:167]
    ds_write_b128 v4, v[152:155] offset:10496
    v_mfma_f32_16x16x32_bf16 v[168:171], a[52:55], a[16:19], v[168:171]
    v_mfma_f32_16x16x32_bf16 v[172:175], a[56:59], a[16:19], v[172:175]
    s_waitcnt vmcnt(20)
    v_mfma_f32_16x16x32_bf16 v[156:159], a[60:63], a[20:23], v[156:159]
    s_add_u32 s55, s74, 81920
    buffer_load_dwordx4 a[16:19], v2, s[32:35], s55 offen sc1
    v_mfma_f32_16x16x32_bf16 v[160:163], a[64:67], a[20:23], v[160:163]
    v_mfma_f32_16x16x32_bf16 v[164:167], a[68:71], a[20:23], v[164:167]
    v_mfma_f32_16x16x32_bf16 v[168:171], a[72:75], a[20:23], v[168:171]
    v_mfma_f32_16x16x32_bf16 v[172:175], a[76:79], a[20:23], v[172:175]
    s_waitcnt lgkmcnt(0)
    s_barrier
    s_waitcnt vmcnt(20)
    v_mfma_f32_16x16x32_bf16 v[96:99], a[80:83], a[24:27], 0
    s_mul_i32 s3, s27, 20480
    s_add_u32 s3, s3, 0
    v_add_u32 v4, s3, v7
    ds_write_b128 v4, v[156:159] offset:15360
    ds_write_b128 v4, v[160:163] offset:15424
    ds_write_b128 v4, v[164:167] offset:15488
    ds_write_b128 v4, v[168:171] offset:15552
    v_mfma_f32_16x16x32_bf16 v[100:103], a[84:87], a[24:27], 0
    ds_write_b128 v4, v[172:175] offset:15616
    s_xor_b32 s56, s2, 4
    s_mul_i32 s56, s56, 20480
    s_add_u32 s56, s56, 16777216
    v_add_u32 v62, 4096, v15
    ds_read_b128 v[64:67], v5 offset:0
    ds_read_b128 v[68:71], v5 offset:5120
    v_mfma_f32_16x16x32_bf16 v[104:107], a[88:91], a[24:27], 0
    s_add_u32 s55, s75, 81920
    buffer_load_dwordx4 a[20:23], v2, s[32:35], s55 offen sc1
    ds_read_b128 v[72:75], v5 offset:10240
    ds_read_b128 v[76:79], v5 offset:15360
    ds_read_b128 v[80:83], v5 offset:64
    v_mfma_f32_16x16x32_bf16 v[108:111], a[92:95], a[24:27], 0
    ds_read_b128 v[84:87], v5 offset:5184
    ds_read_b128 v[88:91], v5 offset:10304
    ds_read_b128 v[92:95], v5 offset:15424
    s_waitcnt lgkmcnt(4)
    v_mfma_f32_16x16x32_bf16 v[112:115], a[96:99], a[24:27], 0
    v_add_f32 v64, v64, v68
    v_add_f32 v72, v72, v76
    v_add_f32 v65, v65, v69
    v_add_f32 v73, v73, v77
    s_waitcnt vmcnt(20)
    v_mfma_f32_16x16x32_bf16 v[116:119], a[80:83], a[28:31], 0
    s_add_u32 s55, s76, 81920
    buffer_load_dwordx4 a[24:27], v2, s[32:35], s55 offen sc1
    v_add_f32 v66, v66, v70
    v_add_f32 v74, v74, v78
    v_add_f32 v67, v67, v71
    v_mfma_f32_16x16x32_bf16 v[120:123], a[84:87], a[28:31], 0
    v_add_f32 v75, v75, v79
    v_add_f32 v64, v64, v72
    v_add_f32 v65, v65, v73
    v_add_f32 v66, v66, v74
    v_mfma_f32_16x16x32_bf16 v[124:127], a[88:91], a[28:31], 0
    v_add_f32 v67, v67, v75
    buffer_store_dwordx4 v[64:67], v15, s[32:35], s56 offen offset:0 sc1
    s_nop 0
    ds_read_b128 v[64:67], v5 offset:128
    ds_read_b128 v[68:71], v5 offset:5248
    v_mfma_f32_16x16x32_bf16 v[128:131], a[92:95], a[28:31], 0
    ds_read_b128 v[72:75], v5 offset:10368
    ds_read_b128 v[76:79], v5 offset:15488
    s_waitcnt lgkmcnt(4)
    v_add_f32 v80, v80, v84
    v_mfma_f32_16x16x32_bf16 v[132:135], a[96:99], a[28:31], 0
    v_add_f32 v88, v88, v92
    v_add_f32 v81, v81, v85
    v_add_f32 v89, v89, v93
    v_add_f32 v82, v82, v86
    s_waitcnt vmcnt(21)
    v_mfma_f32_16x16x32_bf16 v[136:139], a[80:83], a[32:35], 0
    v_add_f32 v90, v90, v94
    v_add_f32 v83, v83, v87
    v_add_f32 v91, v91, v95
    v_add_f32 v80, v80, v88
    v_mfma_f32_16x16x32_bf16 v[140:143], a[84:87], a[32:35], 0
    s_add_u32 s55, s77, 81920
    buffer_load_dwordx4 a[28:31], v2, s[32:35], s55 offen sc1
    v_add_f32 v81, v81, v89
    v_add_f32 v82, v82, v90
    v_add_f32 v83, v83, v91
    v_mfma_f32_16x16x32_bf16 v[144:147], a[88:91], a[32:35], 0
    buffer_store_dwordx4 v[80:83], v15, s[32:35], s56 offen offset:1024 sc1
    s_nop 0
    ds_read_b128 v[80:83], v5 offset:192
    ds_read_b128 v[84:87], v5 offset:5312
    ds_read_b128 v[88:91], v5 offset:10432
    v_mfma_f32_16x16x32_bf16 v[148:151], a[92:95], a[32:35], 0
    ds_read_b128 v[92:95], v5 offset:15552
    s_waitcnt lgkmcnt(4)
    v_add_f32 v64, v64, v68
    v_add_f32 v72, v72, v76
    v_mfma_f32_16x16x32_bf16 v[152:155], a[96:99], a[32:35], 0
    s_add_u32 s55, s74, 98304
    buffer_load_dwordx4 a[32:35], v2, s[32:35], s55 offen sc1
    v_add_f32 v65, v65, v69
    v_add_f32 v73, v73, v77
    v_add_f32 v66, v66, v70
    s_waitcnt vmcnt(23)
    v_mfma_f32_16x16x32_bf16 v[156:159], a[80:83], a[36:39], 0
    v_add_f32 v74, v74, v78
    v_add_f32 v67, v67, v71
    v_add_f32 v75, v75, v79
    v_add_f32 v64, v64, v72
    v_mfma_f32_16x16x32_bf16 v[160:163], a[84:87], a[36:39], 0
    v_add_f32 v65, v65, v73
    v_add_f32 v66, v66, v74
    v_add_f32 v67, v67, v75
    buffer_store_dwordx4 v[64:67], v15, s[32:35], s56 offen offset:2048 sc1
    v_mfma_f32_16x16x32_bf16 v[164:167], a[88:91], a[36:39], 0
    ds_read_b128 v[64:67], v5 offset:256
    ds_read_b128 v[68:71], v5 offset:5376
    ds_read_b128 v[72:75], v5 offset:10496
    ds_read_b128 v[76:79], v5 offset:15616
    v_mfma_f32_16x16x32_bf16 v[168:171], a[92:95], a[36:39], 0
    s_waitcnt lgkmcnt(4)
    v_add_f32 v80, v80, v84
    v_add_f32 v88, v88, v92
    v_add_f32 v81, v81, v85
    v_mfma_f32_16x16x32_bf16 v[172:175], a[96:99], a[36:39], 0
    v_add_f32 v89, v89, v93
    v_add_f32 v82, v82, v86
    v_add_f32 v90, v90, v94
    v_add_f32 v83, v83, v87
    s_waitcnt vmcnt(23)
    v_mfma_f32_16x16x32_bf16 v[96:99], a[100:103], v[16:19], v[96:99]
    s_add_u32 s55, s74, 114688
    buffer_load_dwordx4 a[36:39], v2, s[32:35], s55 offen sc1
    v_add_f32 v91, v91, v95
    v_add_f32 v80, v80, v88
    v_add_f32 v81, v81, v89
    v_mfma_f32_16x16x32_bf16 v[100:103], a[104:107], v[16:19], v[100:103]
    v_add_f32 v82, v82, v90
    v_add_f32 v83, v83, v91
    buffer_store_dwordx4 v[80:83], v15, s[32:35], s56 offen offset:3072 sc1
    s_waitcnt lgkmcnt(0)
    v_mfma_f32_16x16x32_bf16 v[104:107], a[108:111], v[16:19], v[104:107]
    v_add_f32 v64, v64, v68
    v_add_f32 v72, v72, v76
    v_add_f32 v65, v65, v69
    v_add_f32 v73, v73, v77
    v_mfma_f32_16x16x32_bf16 v[108:111], a[112:115], v[16:19], v[108:111]
    v_add_f32 v66, v66, v70
    v_add_f32 v74, v74, v78
    v_add_f32 v67, v67, v71
    v_add_f32 v75, v75, v79
    v_mfma_f32_16x16x32_bf16 v[112:115], a[116:119], v[16:19], v[112:115]
    v_add_f32 v64, v64, v72
    v_add_f32 v65, v65, v73
    v_add_f32 v66, v66, v74
    v_add_f32 v67, v67, v75
    s_waitcnt vmcnt(24)
    v_mfma_f32_16x16x32_bf16 v[116:119], a[100:103], v[20:23], v[116:119]
    buffer_store_dwordx4 v[64:67], v62, s[32:35], s56 offen offset:0 sc1
    s_lshl_b32 s58, s2, 9
    s_lshl_b32 s7, s4, 7
    s_add_u32 s58, s58, s7
    s_add_u32 s58, s58, 22446080
    s_cmp_eq_u32 s83, 0
    s_cselect_b64 s[84:85], -1, 0
    v_mfma_f32_16x16x32_bf16 v[120:123], a[104:107], v[20:23], v[120:123]
    v_cvt_pk_bf16_f32 v58, v58, v58
    v_cvt_pk_bf16_f32 v59, v59, v59
    v_mfma_f32_16x16x32_bf16 v[124:127], a[108:111], v[20:23], v[124:127]
    v_cvt_pk_bf16_f32 v60, v60, v60
    v_cvt_pk_bf16_f32 v61, v61, v61
    v_mfma_f32_16x16x32_bf16 v[128:131], a[112:115], v[20:23], v[128:131]
    v_cvt_pk_bf16_f32 v10, v10, v10
    v_lshlrev_b32 v58, 16, v58
    v_mfma_f32_16x16x32_bf16 v[132:135], a[116:119], v[20:23], v[132:135]
    v_lshlrev_b32 v59, 16, v59
    v_lshlrev_b32 v60, 16, v60
    s_waitcnt vmcnt(24)
    v_mfma_f32_16x16x32_bf16 v[136:139], a[100:103], v[24:27], v[136:139]
    v_lshlrev_b32 v61, 16, v61
    v_lshlrev_b32 v10, 16, v10
    v_mfma_f32_16x16x32_bf16 v[140:143], a[104:107], v[24:27], v[140:143]
    v_mul_f32 v58, 0xbfb8aa3b, v58
    v_mul_f32 v59, 0xbfb8aa3b, v59
    v_mfma_f32_16x16x32_bf16 v[144:147], a[108:111], v[24:27], v[144:147]
    v_mul_f32 v60, 0xbfb8aa3b, v60
    v_mul_f32 v61, 0xbfb8aa3b, v61
    v_mfma_f32_16x16x32_bf16 v[148:151], a[112:115], v[24:27], v[148:151]
    v_mul_f32 v10, 0xbfb8aa3b, v10
    v_exp_f32 v58, v58
    v_mfma_f32_16x16x32_bf16 v[152:155], a[116:119], v[24:27], v[152:155]
    v_exp_f32 v59, v59
    v_exp_f32 v60, v60
    s_waitcnt vmcnt(23)
    v_mfma_f32_16x16x32_bf16 v[156:159], a[100:103], v[28:31], v[156:159]
    v_exp_f32 v61, v61
    v_exp_f32 v10, v10
    v_mfma_f32_16x16x32_bf16 v[160:163], a[104:107], v[28:31], v[160:163]
    v_add_f32 v58, 1.0, v58
    v_add_f32 v59, 1.0, v59
    v_mfma_f32_16x16x32_bf16 v[164:167], a[108:111], v[28:31], v[164:167]
    v_add_f32 v60, 1.0, v60
    v_add_f32 v61, 1.0, v61
    v_mfma_f32_16x16x32_bf16 v[168:171], a[112:115], v[28:31], v[168:171]
    v_add_f32 v10, 1.0, v10
    v_rcp_f32 v58, v58
    v_mfma_f32_16x16x32_bf16 v[172:175], a[116:119], v[28:31], v[172:175]
    v_rcp_f32 v59, v59
    v_rcp_f32 v60, v60
    s_waitcnt vmcnt(22)
    v_mfma_f32_16x16x32_bf16 v[96:99], a[120:123], v[32:35], v[96:99]
    v_rcp_f32 v61, v61
    v_rcp_f32 v10, v10
    v_mfma_f32_16x16x32_bf16 v[100:103], a[124:127], v[32:35], v[100:103]
    v_cvt_pk_bf16_f32 v58, v58, v58
    v_cvt_pk_bf16_f32 v59, v59, v59
    v_mfma_f32_16x16x32_bf16 v[104:107], a[128:131], v[32:35], v[104:107]
    v_cvt_pk_bf16_f32 v60, v60, v60
    v_cvt_pk_bf16_f32 v61, v61, v61
    v_mfma_f32_16x16x32_bf16 v[108:111], a[132:135], v[32:35], v[108:111]
    v_cvt_pk_bf16_f32 v10, v10, v10
    v_lshlrev_b32 v58, 16, v58
    v_mfma_f32_16x16x32_bf16 v[112:115], a[136:139], v[32:35], v[112:115]
    s_add_u32 s55, s74, 131072
    buffer_load_dwordx4 v[32:35], v2, s[32:35], s55 offen sc1
    v_lshlrev_b32 v59, 16, v59
    s_waitcnt vmcnt(22)
    v_mfma_f32_16x16x32_bf16 v[116:119], a[120:123], v[36:39], v[116:119]
    v_lshlrev_b32 v60, 16, v60
    v_lshlrev_b32 v61, 16, v61
    v_mfma_f32_16x16x32_bf16 v[120:123], a[124:127], v[36:39], v[120:123]
    v_lshlrev_b32 v10, 16, v10
    v_sub_f32 v3, 1.0, v58
    v_mfma_f32_16x16x32_bf16 v[124:127], a[128:131], v[36:39], v[124:127]
    v_sub_f32 v63, 1.0, v59
    v_sub_f32 v8, 1.0, v60
    v_mfma_f32_16x16x32_bf16 v[128:131], a[132:135], v[36:39], v[128:131]
    v_sub_f32 v9, 1.0, v61
    v_sub_f32 v11, 1.0, v10
    v_mfma_f32_16x16x32_bf16 v[132:135], a[136:139], v[36:39], v[132:135]
    v_cvt_pk_bf16_f32 v3, v3, v3
    v_cvt_pk_bf16_f32 v63, v63, v63
    s_waitcnt vmcnt(21)
    v_mfma_f32_16x16x32_bf16 v[136:139], a[120:123], v[40:43], v[136:139]
    s_add_u32 s55, s74, 147456
    buffer_load_dwordx4 v[36:39], v2, s[32:35], s55 offen sc1
    v_cvt_pk_bf16_f32 v8, v8, v8
    v_mfma_f32_16x16x32_bf16 v[140:143], a[124:127], v[40:43], v[140:143]
    v_cvt_pk_bf16_f32 v9, v9, v9
    v_cvt_pk_bf16_f32 v11, v11, v11
    v_mfma_f32_16x16x32_bf16 v[144:147], a[128:131], v[40:43], v[144:147]
    v_lshlrev_b32 v3, 16, v3
    v_lshlrev_b32 v63, 16, v63
    v_mfma_f32_16x16x32_bf16 v[148:151], a[132:135], v[40:43], v[148:151]
    v_lshlrev_b32 v8, 16, v8
    v_lshlrev_b32 v9, 16, v9
    v_mfma_f32_16x16x32_bf16 v[152:155], a[136:139], v[40:43], v[152:155]
    v_lshlrev_b32 v11, 16, v11
    v_cndmask_b32 v58, v58, v3, s[84:85]
    s_waitcnt vmcnt(21)
    v_mfma_f32_16x16x32_bf16 v[156:159], a[120:123], v[44:47], v[156:159]
    v_cndmask_b32 v59, v59, v63, s[84:85]
    v_cndmask_b32 v60, v60, v8, s[84:85]
    v_mfma_f32_16x16x32_bf16 v[160:163], a[124:127], v[44:47], v[160:163]
    s_add_u32 s55, s75, 98304
    buffer_load_dwordx4 v[40:43], v2, s[32:35], s55 offen sc1
    v_cndmask_b32 v61, v61, v9, s[84:85]
    v_mfma_f32_16x16x32_bf16 v[164:167], a[128:131], v[44:47], v[164:167]
    v_cndmask_b32 v11, v11, v10, s[84:85]
    v_mul_f32 v176, v3, v176
    v_mfma_f32_16x16x32_bf16 v[168:171], a[132:135], v[44:47], v[168:171]
    v_mul_f32 v177, v3, v177
    v_mul_f32 v178, v3, v178
    v_mfma_f32_16x16x32_bf16 v[172:175], a[136:139], v[44:47], v[172:175]
    s_add_u32 s55, s75, 114688
    buffer_load_dwordx4 v[44:47], v2, s[32:35], s55 offen sc1
    v_mul_f32 v179, v3, v179
    s_waitcnt vmcnt(22)
    v_mfma_f32_16x16x32_bf16 v[96:99], a[140:143], a[240:243], v[96:99]
    v_mul_f32 v180, v3, v180
    v_mul_f32 v181, v3, v181
    v_mfma_f32_16x16x32_bf16 v[100:103], a[144:147], a[240:243], v[100:103]
    v_mul_f32 v182, v3, v182
    v_mul_f32 v183, v3, v183
    v_mfma_f32_16x16x32_bf16 v[104:107], a[148:151], a[240:243], v[104:107]
    v_mul_f32 v184, v3, v184
    v_mul_f32 v185, v3, v185
    v_mfma_f32_16x16x32_bf16 v[108:111], a[152:155], a[240:243], v[108:111]
    v_mul_f32 v186, v3, v186
    v_mul_f32 v187, v3, v187
    v_mfma_f32_16x16x32_bf16 v[112:115], a[156:159], a[240:243], v[112:115]
    v_mul_f32 v188, v3, v188
    v_mul_f32 v189, v3, v189
    s_waitcnt vmcnt(21)
    v_mfma_f32_16x16x32_bf16 v[116:119], a[140:143], a[244:247], v[116:119]
    s_add_u32 s55, s75, 131072
    buffer_load_dwordx4 a[240:243], v2, s[32:35], s55 offen sc1
    v_mul_f32 v190, v3, v190
    v_mfma_f32_16x16x32_bf16 v[120:123], a[144:147], a[244:247], v[120:123]
    v_mul_f32 v191, v3, v191
    v_mul_f32 v192, v3, v192
    v_mfma_f32_16x16x32_bf16 v[124:127], a[148:151], a[244:247], v[124:127]
    v_mul_f32 v193, v3, v193
    v_mul_f32 v194, v3, v194
    v_mfma_f32_16x16x32_bf16 v[128:131], a[152:155], a[244:247], v[128:131]
    v_mul_f32 v195, v3, v195
    v_mul_f32 v196, v63, v196
    v_mfma_f32_16x16x32_bf16 v[132:135], a[156:159], a[244:247], v[132:135]
    v_mul_f32 v197, v63, v197
    v_mul_f32 v198, v63, v198
    s_waitcnt vmcnt(21)
    v_mfma_f32_16x16x32_bf16 v[136:139], a[140:143], a[248:251], v[136:139]
    v_mul_f32 v199, v63, v199
    v_mul_f32 v200, v63, v200
    v_mfma_f32_16x16x32_bf16 v[140:143], a[144:147], a[248:251], v[140:143]
    s_add_u32 s55, s75, 147456
    buffer_load_dwordx4 a[244:247], v2, s[32:35], s55 offen sc1
    v_mul_f32 v201, v63, v201
    v_mfma_f32_16x16x32_bf16 v[144:147], a[148:151], a[248:251], v[144:147]
    v_mul_f32 v202, v63, v202
    v_mul_f32 v203, v63, v203
    v_mfma_f32_16x16x32_bf16 v[148:151], a[152:155], a[248:251], v[148:151]
    v_mul_f32 v204, v63, v204
    v_mul_f32 v205, v63, v205
    v_mfma_f32_16x16x32_bf16 v[152:155], a[156:159], a[248:251], v[152:155]
    s_add_u32 s55, s76, 98304
    buffer_load_dwordx4 a[248:251], v2, s[32:35], s55 offen sc1
    v_mul_f32 v206, v63, v206
    s_waitcnt vmcnt(22)
    v_mfma_f32_16x16x32_bf16 v[156:159], a[140:143], a[252:255], v[156:159]
    v_mul_f32 v207, v63, v207
    v_mul_f32 v208, v63, v208
    v_mfma_f32_16x16x32_bf16 v[160:163], a[144:147], a[252:255], v[160:163]
    v_mul_f32 v209, v63, v209
    v_mul_f32 v210, v63, v210
    v_mfma_f32_16x16x32_bf16 v[164:167], a[148:151], a[252:255], v[164:167]
    v_mul_f32 v211, v63, v211
    v_mul_f32 v212, v63, v212
    v_mfma_f32_16x16x32_bf16 v[168:171], a[152:155], a[252:255], v[168:171]
    v_mul_f32 v213, v63, v213
    v_mul_f32 v214, v63, v214
    v_mfma_f32_16x16x32_bf16 v[172:175], a[156:159], a[252:255], v[172:175]
    v_mul_f32 v215, v63, v215
    v_mul_f32 v216, v8, v216
    s_waitcnt vmcnt(7)
    s_xor_b32 s3, s58, 2048
    buffer_store_dwordx2 v[12:13], v14, s[32:35], s3 offen sc1
    v_mfma_f32_16x16x32_bf16 v[96:99], a[160:163], a[0:3], v[96:99]
    s_add_u32 s55, s76, 114688
    buffer_load_dwordx4 a[252:255], v2, s[32:35], s55 offen sc1
    v_mul_f32 v217, v8, v217
    v_mfma_f32_16x16x32_bf16 v[100:103], a[164:167], a[0:3], v[100:103]
    v_mul_f32 v218, v8, v218
    v_mul_f32 v219, v8, v219
    v_mfma_f32_16x16x32_bf16 v[104:107], a[168:171], a[0:3], v[104:107]
    v_mul_f32 v220, v8, v220
    v_mul_f32 v221, v8, v221
    v_mfma_f32_16x16x32_bf16 v[108:111], a[172:175], a[0:3], v[108:111]
    v_mul_f32 v222, v8, v222
    v_mul_f32 v223, v8, v223
    v_mfma_f32_16x16x32_bf16 v[112:115], a[176:179], a[0:3], v[112:115]
    v_mul_f32 v224, v8, v224
    v_mul_f32 v225, v8, v225
    v_mfma_f32_16x16x32_bf16 v[116:119], a[160:163], a[4:7], v[116:119]
    v_mul_f32 v226, v8, v226
    v_mul_f32 v227, v8, v227
    v_mfma_f32_16x16x32_bf16 v[120:123], a[164:167], a[4:7], v[120:123]
    s_add_u32 s55, s76, 131072
    buffer_load_dwordx4 a[0:3], v2, s[32:35], s55 offen sc1
    v_mul_f32 v228, v8, v228
    v_mfma_f32_16x16x32_bf16 v[124:127], a[168:171], a[4:7], v[124:127]
    v_mul_f32 v229, v8, v229
    v_mul_f32 v230, v8, v230
    v_mfma_f32_16x16x32_bf16 v[128:131], a[172:175], a[4:7], v[128:131]
    v_mul_f32 v231, v8, v231
    v_mul_f32 v232, v8, v232
    v_mfma_f32_16x16x32_bf16 v[132:135], a[176:179], a[4:7], v[132:135]
    s_add_u32 s55, s76, 147456
    buffer_load_dwordx4 a[4:7], v2, s[32:35], s55 offen sc1
    v_mul_f32 v233, v8, v233
    v_mfma_f32_16x16x32_bf16 v[136:139], a[160:163], a[8:11], v[136:139]
    v_mul_f32 v234, v8, v234
    v_mul_f32 v235, v8, v235
    v_mfma_f32_16x16x32_bf16 v[140:143], a[164:167], a[8:11], v[140:143]
    v_mul_f32 v236, v9, v236
    v_mul_f32 v237, v9, v237
    v_mfma_f32_16x16x32_bf16 v[144:147], a[168:171], a[8:11], v[144:147]
    v_mul_f32 v238, v9, v238
    v_mul_f32 v239, v9, v239
    v_mfma_f32_16x16x32_bf16 v[148:151], a[172:175], a[8:11], v[148:151]
    v_mul_f32 v240, v9, v240
    v_mul_f32 v241, v9, v241
    v_mfma_f32_16x16x32_bf16 v[152:155], a[176:179], a[8:11], v[152:155]
    v_mul_f32 v242, v9, v242
    v_mul_f32 v243, v9, v243
    v_mfma_f32_16x16x32_bf16 v[156:159], a[160:163], a[12:15], v[156:159]
    s_add_u32 s55, s77, 98304
    buffer_load_dwordx4 a[8:11], v2, s[32:35], s55 offen sc1
    v_mul_f32 v244, v9, v244
    v_mfma_f32_16x16x32_bf16 v[160:163], a[164:167], a[12:15], v[160:163]
    v_mul_f32 v245, v9, v245
    v_mul_f32 v246, v9, v246
    v_mfma_f32_16x16x32_bf16 v[164:167], a[168:171], a[12:15], v[164:167]
    v_mul_f32 v247, v9, v247
    v_mul_f32 v248, v9, v248
    v_mfma_f32_16x16x32_bf16 v[168:171], a[172:175], a[12:15], v[168:171]
    v_mul_f32 v249, v9, v249
    v_mul_f32 v250, v9, v250
    v_mfma_f32_16x16x32_bf16 v[172:175], a[176:179], a[12:15], v[172:175]
    v_mul_f32 v251, v9, v251
    v_mul_f32 v252, v9, v252
    v_mfma_f32_16x16x32_bf16 v[96:99], a[180:183], a[16:19], v[96:99]
    v_mul_f32 v253, v9, v253
    v_mul_f32 v254, v9, v254
    v_mfma_f32_16x16x32_bf16 v[100:103], a[184:187], a[16:19], v[100:103]
    s_add_u32 s55, s77, 114688
    buffer_load_dwordx4 a[12:15], v2, s[32:35], s55 offen sc1
    v_mul_f32 v255, v9, v255
    v_mfma_f32_16x16x32_bf16 v[104:107], a[188:191], a[16:19], v[104:107]
    s_mul_i32 s56, s2, 20480
    s_add_u32 s56, s56, 16777216
    v_add_u32 v5, 81920, v5
    v_mfma_f32_16x16x32_bf16 v[108:111], a[192:195], a[16:19], v[108:111]
    v_mfma_f32_16x16x32_bf16 v[112:115], a[196:199], a[16:19], v[112:115]
    s_add_u32 s55, s77, 131072
    buffer_load_dwordx4 a[16:19], v2, s[32:35], s55 offen sc1
    v_mfma_f32_16x16x32_bf16 v[116:119], a[180:183], a[20:23], v[116:119]
    v_mfma_f32_16x16x32_bf16 v[120:123], a[184:187], a[20:23], v[120:123]
    v_mfma_f32_16x16x32_bf16 v[124:127], a[188:191], a[20:23], v[124:127]
    v_mfma_f32_16x16x32_bf16 v[128:131], a[192:195], a[20:23], v[128:131]
    v_mfma_f32_16x16x32_bf16 v[132:135], a[196:199], a[20:23], v[132:135]
    v_mfma_f32_16x16x32_bf16 v[136:139], a[180:183], a[24:27], v[136:139]
    s_add_u32 s55, s77, 147456
    buffer_load_dwordx4 a[20:23], v2, s[32:35], s55 offen sc1
    v_mfma_f32_16x16x32_bf16 v[140:143], a[184:187], a[24:27], v[140:143]
    v_mfma_f32_16x16x32_bf16 v[144:147], a[188:191], a[24:27], v[144:147]
    v_mfma_f32_16x16x32_bf16 v[148:151], a[192:195], a[24:27], v[148:151]
    v_mfma_f32_16x16x32_bf16 v[152:155], a[196:199], a[24:27], v[152:155]
    v_mfma_f32_16x16x32_bf16 v[156:159], a[180:183], a[28:31], v[156:159]
    v_mfma_f32_16x16x32_bf16 v[160:163], a[184:187], a[28:31], v[160:163]
    v_mfma_f32_16x16x32_bf16 v[164:167], a[188:191], a[28:31], v[164:167]
    v_mfma_f32_16x16x32_bf16 v[168:171], a[192:195], a[28:31], v[168:171]
    v_mfma_f32_16x16x32_bf16 v[172:175], a[196:199], a[28:31], v[172:175]
    v_mfma_f32_16x16x32_bf16 v[96:99], a[200:203], a[32:35], v[96:99]
    v_lshlrev_b32 v16, 16, v48
    v_and_b32 v17, 0xffff0000, v48
    v_mfma_f32_16x16x32_bf16 v[100:103], a[204:207], a[32:35], v[100:103]
    v_mul_f32 v16, v10, v16
    v_mul_f32 v17, v10, v17
    v_mfma_f32_16x16x32_bf16 v[104:107], a[208:211], a[32:35], v[104:107]
    v_lshlrev_b32 v18, 16, v49
    v_and_b32 v19, 0xffff0000, v49
    v_mfma_f32_16x16x32_bf16 v[108:111], a[212:215], a[32:35], v[108:111]
    v_mul_f32 v18, v10, v18
    v_mul_f32 v19, v10, v19
    v_mfma_f32_16x16x32_bf16 v[112:115], a[216:219], a[32:35], v[112:115]
    v_lshlrev_b32 v20, 16, v50
    v_and_b32 v21, 0xffff0000, v50
    v_mfma_f32_16x16x32_bf16 v[96:99], a[220:223], a[36:39], v[96:99]
    v_mul_f32 v20, v10, v20
    v_mul_f32 v21, v10, v21
    v_mfma_f32_16x16x32_bf16 v[100:103], a[224:227], a[36:39], v[100:103]
    v_lshlrev_b32 v22, 16, v51
    v_and_b32 v23, 0xffff0000, v51
    v_mfma_f32_16x16x32_bf16 v[104:107], a[228:231], a[36:39], v[104:107]
    v_mul_f32 v22, v10, v22
    v_mul_f32 v23, v10, v23
    v_mfma_f32_16x16x32_bf16 v[108:111], a[232:235], a[36:39], v[108:111]
    v_lshlrev_b32 v24, 16, v52
    v_and_b32 v25, 0xffff0000, v52
    v_mfma_f32_16x16x32_bf16 v[112:115], a[236:239], a[36:39], v[112:115]
    v_mul_f32 v24, v10, v24
    v_mul_f32 v25, v10, v25
    s_waitcnt vmcnt(14)
    v_mfma_f32_16x16x32_bf16 v[96:99], a[40:43], v[32:35], v[96:99]
    v_lshlrev_b32 v26, 16, v53
    v_and_b32 v27, 0xffff0000, v53
    v_mfma_f32_16x16x32_bf16 v[100:103], a[44:47], v[32:35], v[100:103]
    v_mul_f32 v26, v10, v26
    v_mul_f32 v27, v10, v27
    v_mfma_f32_16x16x32_bf16 v[104:107], a[48:51], v[32:35], v[104:107]
    v_lshlrev_b32 v28, 16, v54
    v_and_b32 v29, 0xffff0000, v54
    v_mfma_f32_16x16x32_bf16 v[108:111], a[52:55], v[32:35], v[108:111]
    v_mul_f32 v28, v10, v28
    v_mul_f32 v29, v10, v29
    v_mfma_f32_16x16x32_bf16 v[112:115], a[56:59], v[32:35], v[112:115]
    v_lshlrev_b32 v30, 16, v55
    v_and_b32 v31, 0xffff0000, v55
    s_waitcnt vmcnt(13)
    v_mfma_f32_16x16x32_bf16 v[96:99], a[60:63], v[36:39], v[96:99]
    v_mul_f32 v30, v10, v30
    v_mul_f32 v31, v10, v31
    v_mfma_f32_16x16x32_bf16 v[100:103], a[64:67], v[36:39], v[100:103]
    v_lshlrev_b32 v84, 16, v56
    v_and_b32 v85, 0xffff0000, v56
    v_mfma_f32_16x16x32_bf16 v[104:107], a[68:71], v[36:39], v[104:107]
    v_mul_f32 v84, v10, v84
    v_mul_f32 v85, v10, v85
    v_mfma_f32_16x16x32_bf16 v[108:111], a[72:75], v[36:39], v[108:111]
    v_lshlrev_b32 v86, 16, v57
    v_and_b32 v87, 0xffff0000, v57
    v_mfma_f32_16x16x32_bf16 v[112:115], a[76:79], v[36:39], v[112:115]
    v_mul_f32 v86, v10, v86
    v_mul_f32 v87, v10, v87
    s_mov_b64 exec, 0x1
    buffer_load_dwordx2 v[8:9], v14, s[32:35], s58 offen sc1
    s_mov_b64 exec, -1
    s_waitcnt vmcnt(13)
    v_mfma_f32_16x16x32_bf16 v[116:119], a[200:203], v[40:43], v[116:119]
    v_fma_f32 v96, v96, v58, v176
    v_fma_f32 v97, v97, v58, v177
    v_mfma_f32_16x16x32_bf16 v[120:123], a[204:207], v[40:43], v[120:123]
    v_fma_f32 v98, v98, v58, v178
    v_fma_f32 v99, v99, v58, v179
    v_mfma_f32_16x16x32_bf16 v[124:127], a[208:211], v[40:43], v[124:127]
    s_mul_i32 s3, s24, 20480
    s_add_u32 s3, s3, 81920
    v_add_u32 v4, s3, v7
    ds_write_b128 v4, v[96:99] offset:0
    v_fma_f32 v100, v100, v58, v180
    v_mfma_f32_16x16x32_bf16 v[128:131], a[212:215], v[40:43], v[128:131]
    v_fma_f32 v101, v101, v58, v181
    v_fma_f32 v102, v102, v58, v182
    v_mfma_f32_16x16x32_bf16 v[132:135], a[216:219], v[40:43], v[132:135]
    v_fma_f32 v103, v103, v58, v183
    ds_write_b128 v4, v[100:103] offset:64
    s_waitcnt vmcnt(12)
    v_mfma_f32_16x16x32_bf16 v[116:119], a[220:223], v[44:47], v[116:119]
    v_fma_f32 v104, v104, v58, v184
    v_fma_f32 v105, v105, v58, v185
    v_mfma_f32_16x16x32_bf16 v[120:123], a[224:227], v[44:47], v[120:123]
    v_fma_f32 v106, v106, v58, v186
    v_fma_f32 v107, v107, v58, v187
    v_mfma_f32_16x16x32_bf16 v[124:127], a[228:231], v[44:47], v[124:127]
    ds_write_b128 v4, v[104:107] offset:128
    v_fma_f32 v108, v108, v58, v188
    v_mfma_f32_16x16x32_bf16 v[128:131], a[232:235], v[44:47], v[128:131]
    v_fma_f32 v109, v109, v58, v189
    v_fma_f32 v110, v110, v58, v190
    v_mfma_f32_16x16x32_bf16 v[132:135], a[236:239], v[44:47], v[132:135]
    v_fma_f32 v111, v111, v58, v191
    ds_write_b128 v4, v[108:111] offset:192
    s_waitcnt vmcnt(11)
    v_mfma_f32_16x16x32_bf16 v[116:119], a[40:43], a[240:243], v[116:119]
    v_fma_f32 v112, v112, v58, v192
    v_fma_f32 v113, v113, v58, v193
    v_mfma_f32_16x16x32_bf16 v[120:123], a[44:47], a[240:243], v[120:123]
    v_fma_f32 v114, v114, v58, v194
    v_fma_f32 v115, v115, v58, v195
    v_mfma_f32_16x16x32_bf16 v[124:127], a[48:51], a[240:243], v[124:127]
    ds_write_b128 v4, v[112:115] offset:256
    v_mfma_f32_16x16x32_bf16 v[128:131], a[52:55], a[240:243], v[128:131]
    v_mfma_f32_16x16x32_bf16 v[132:135], a[56:59], a[240:243], v[132:135]
    s_waitcnt vmcnt(10)
    v_mfma_f32_16x16x32_bf16 v[116:119], a[60:63], a[244:247], v[116:119]
    v_mfma_f32_16x16x32_bf16 v[120:123], a[64:67], a[244:247], v[120:123]
    v_mfma_f32_16x16x32_bf16 v[124:127], a[68:71], a[244:247], v[124:127]
    v_mfma_f32_16x16x32_bf16 v[128:131], a[72:75], a[244:247], v[128:131]
    v_mfma_f32_16x16x32_bf16 v[132:135], a[76:79], a[244:247], v[132:135]
    s_waitcnt vmcnt(9)
    v_mfma_f32_16x16x32_bf16 v[136:139], a[200:203], a[248:251], v[136:139]
    s_nop 1
    v_fma_f32 v116, v116, v59, v196
    v_fma_f32 v117, v117, v59, v197
    v_mfma_f32_16x16x32_bf16 v[140:143], a[204:207], a[248:251], v[140:143]
    v_fma_f32 v118, v118, v59, v198
    v_fma_f32 v119, v119, v59, v199
    v_mfma_f32_16x16x32_bf16 v[144:147], a[208:211], a[248:251], v[144:147]
    s_mul_i32 s3, s25, 20480
    s_add_u32 s3, s3, 81920
    v_add_u32 v4, s3, v7
    ds_write_b128 v4, v[116:119] offset:5120
    v_fma_f32 v120, v120, v59, v200
    v_mfma_f32_16x16x32_bf16 v[148:151], a[212:215], a[248:251], v[148:151]
    v_fma_f32 v121, v121, v59, v201
    v_fma_f32 v122, v122, v59, v202
    v_mfma_f32_16x16x32_bf16 v[152:155], a[216:219], a[248:251], v[152:155]
    v_fma_f32 v123, v123, v59, v203
    ds_write_b128 v4, v[120:123] offset:5184
    s_waitcnt vmcnt(7)
    v_mfma_f32_16x16x32_bf16 v[136:139], a[220:223], a[252:255], v[136:139]
    v_fma_f32 v124, v124, v59, v204
    v_fma_f32 v125, v125, v59, v205
    v_mfma_f32_16x16x32_bf16 v[140:143], a[224:227], a[252:255], v[140:143]
    v_fma_f32 v126, v126, v59, v206
    v_fma_f32 v127, v127, v59, v207
    v_mfma_f32_16x16x32_bf16 v[144:147], a[228:231], a[252:255], v[144:147]
    ds_write_b128 v4, v[124:127] offset:5248
    v_fma_f32 v128, v128, v59, v208
    v_mfma_f32_16x16x32_bf16 v[148:151], a[232:235], a[252:255], v[148:151]
    v_fma_f32 v129, v129, v59, v209
    v_fma_f32 v130, v130, v59, v210
    v_mfma_f32_16x16x32_bf16 v[152:155], a[236:239], a[252:255], v[152:155]
    v_fma_f32 v131, v131, v59, v211
    ds_write_b128 v4, v[128:131] offset:5312
    s_waitcnt vmcnt(6)
    v_mfma_f32_16x16x32_bf16 v[136:139], a[40:43], a[0:3], v[136:139]
    v_fma_f32 v132, v132, v59, v212
    v_fma_f32 v133, v133, v59, v213
    v_mfma_f32_16x16x32_bf16 v[140:143], a[44:47], a[0:3], v[140:143]
    v_fma_f32 v134, v134, v59, v214
    v_fma_f32 v135, v135, v59, v215
    v_mfma_f32_16x16x32_bf16 v[144:147], a[48:51], a[0:3], v[144:147]
    ds_write_b128 v4, v[132:135] offset:5376
    v_mfma_f32_16x16x32_bf16 v[148:151], a[52:55], a[0:3], v[148:151]
    v_mfma_f32_16x16x32_bf16 v[152:155], a[56:59], a[0:3], v[152:155]
    s_waitcnt vmcnt(5)
    v_mfma_f32_16x16x32_bf16 v[136:139], a[60:63], a[4:7], v[136:139]
    v_mfma_f32_16x16x32_bf16 v[140:143], a[64:67], a[4:7], v[140:143]
    v_mfma_f32_16x16x32_bf16 v[144:147], a[68:71], a[4:7], v[144:147]
    v_mfma_f32_16x16x32_bf16 v[148:151], a[72:75], a[4:7], v[148:151]
    v_mfma_f32_16x16x32_bf16 v[152:155], a[76:79], a[4:7], v[152:155]
    s_waitcnt vmcnt(0)
    v_cmp_eq_u64 vcc, s[50:51], v[8:9]
    s_nop 0
    s_and_b32 s3, vcc_lo, 0x1
    s_cmp_eq_u32 s3, 0x1
    s_cselect_b32 s62, 0, 2130706432
    v_or_b32 v2, s62, v15
    v_or_b32 v3, s62, v62
    v_mfma_f32_16x16x32_bf16 v[156:159], a[200:203], a[8:11], v[156:159]
    buffer_load_dwordx4 v[64:67], v2, s[32:35], s56 offen offset:0 sc1
    v_fma_f32 v136, v136, v60, v216
    v_fma_f32 v137, v137, v60, v217
    v_mfma_f32_16x16x32_bf16 v[160:163], a[204:207], a[8:11], v[160:163]
    v_fma_f32 v138, v138, v60, v218
    v_fma_f32 v139, v139, v60, v219
    s_mul_i32 s3, s26, 20480
    s_add_u32 s3, s3, 81920
    v_add_u32 v4, s3, v7
    ds_write_b128 v4, v[136:139] offset:10240
    v_mfma_f32_16x16x32_bf16 v[164:167], a[208:211], a[8:11], v[164:167]
    buffer_load_dwordx4 v[68:71], v2, s[32:35], s56 offen offset:1024 sc1
    v_fma_f32 v140, v140, v60, v220
    v_fma_f32 v141, v141, v60, v221
    v_mfma_f32_16x16x32_bf16 v[168:171], a[212:215], a[8:11], v[168:171]
    v_fma_f32 v142, v142, v60, v222
    v_fma_f32 v143, v143, v60, v223
    ds_write_b128 v4, v[140:143] offset:10304
    v_mfma_f32_16x16x32_bf16 v[172:175], a[216:219], a[8:11], v[172:175]
    buffer_load_dwordx4 v[72:75], v2, s[32:35], s56 offen offset:2048 sc1
    v_fma_f32 v144, v144, v60, v224
    v_fma_f32 v145, v145, v60, v225
    v_mfma_f32_16x16x32_bf16 v[156:159], a[220:223], a[12:15], v[156:159]
    v_fma_f32 v146, v146, v60, v226
    v_fma_f32 v147, v147, v60, v227
    ds_write_b128 v4, v[144:147] offset:10368
    v_mfma_f32_16x16x32_bf16 v[160:163], a[224:227], a[12:15], v[160:163]
    buffer_load_dwordx4 v[76:79], v2, s[32:35], s56 offen offset:3072 sc1
    v_fma_f32 v148, v148, v60, v228
    v_fma_f32 v149, v149, v60, v229
    v_mfma_f32_16x16x32_bf16 v[164:167], a[228:231], a[12:15], v[164:167]
    v_fma_f32 v150, v150, v60, v230
    v_fma_f32 v151, v151, v60, v231
    ds_write_b128 v4, v[148:151] offset:10432
    v_mfma_f32_16x16x32_bf16 v[168:171], a[232:235], a[12:15], v[168:171]
    buffer_load_dwordx4 v[80:83], v3, s[32:35], s56 offen offset:0 sc1
    v_fma_f32 v152, v152, v60, v232
    v_fma_f32 v153, v153, v60, v233
    v_mfma_f32_16x16x32_bf16 v[172:175], a[236:239], a[12:15], v[172:175]
    v_fma_f32 v154, v154, v60, v234
    v_fma_f32 v155, v155, v60, v235
    ds_write_b128 v4, v[152:155] offset:10496
    v_mfma_f32_16x16x32_bf16 v[156:159], a[40:43], a[16:19], v[156:159]
    v_mfma_f32_16x16x32_bf16 v[160:163], a[44:47], a[16:19], v[160:163]
    v_mfma_f32_16x16x32_bf16 v[164:167], a[48:51], a[16:19], v[164:167]
    v_mfma_f32_16x16x32_bf16 v[168:171], a[52:55], a[16:19], v[168:171]
    s_waitcnt lgkmcnt(0)
    s_barrier
    ds_read_b128 v[96:99], v5 offset:0
    ds_read_b128 v[100:103], v5 offset:5120
    v_mfma_f32_16x16x32_bf16 v[172:175], a[56:59], a[16:19], v[172:175]
    ds_read_b128 v[104:107], v5 offset:10240
    ds_read_b128 v[108:111], v5 offset:64
    ds_read_b128 v[112:115], v5 offset:5184
    v_mfma_f32_16x16x32_bf16 v[156:159], a[60:63], a[20:23], v[156:159]
    ds_read_b128 v[116:119], v5 offset:10304
    ds_read_b128 v[120:123], v5 offset:128
    ds_read_b128 v[124:127], v5 offset:5248
    v_mfma_f32_16x16x32_bf16 v[160:163], a[64:67], a[20:23], v[160:163]
    ds_read_b128 v[128:131], v5 offset:10368
    ds_read_b128 v[132:135], v5 offset:192
    ds_read_b128 v[136:139], v5 offset:5312
    v_mfma_f32_16x16x32_bf16 v[164:167], a[68:71], a[20:23], v[164:167]
    ds_read_b128 v[140:143], v5 offset:10432
    ds_read_b128 v[144:147], v5 offset:256
    ds_read_b128 v[148:151], v5 offset:5376
    v_mfma_f32_16x16x32_bf16 v[168:171], a[72:75], a[20:23], v[168:171]
    ds_read_b128 v[152:155], v5 offset:10496
    v_mfma_f32_16x16x32_bf16 v[172:175], a[76:79], a[20:23], v[172:175]
    v_pk_fma_f32 v[156:157], v[156:157], v[60:61], v[236:237] op_sel:[0,1,0] op_sel_hi:[1,1,1]
    v_pk_fma_f32 v[158:159], v[158:159], v[60:61], v[238:239] op_sel:[0,1,0] op_sel_hi:[1,1,1]
    s_mul_i32 s3, s27, 20480
    s_add_u32 s3, s3, 81920
    v_add_u32 v4, s3, v7
    ds_write_b128 v4, v[156:159] offset:15360
    v_pk_fma_f32 v[160:161], v[160:161], v[60:61], v[240:241] op_sel:[0,1,0] op_sel_hi:[1,1,1]
    v_pk_fma_f32 v[162:163], v[162:163], v[60:61], v[242:243] op_sel:[0,1,0] op_sel_hi:[1,1,1]
    ds_write_b128 v4, v[160:163] offset:15424
    v_pk_fma_f32 v[164:165], v[164:165], v[60:61], v[244:245] op_sel:[0,1,0] op_sel_hi:[1,1,1]
    v_pk_fma_f32 v[166:167], v[166:167], v[60:61], v[246:247] op_sel:[0,1,0] op_sel_hi:[1,1,1]
    ds_write_b128 v4, v[164:167] offset:15488
    v_pk_fma_f32 v[168:169], v[168:169], v[60:61], v[248:249] op_sel:[0,1,0] op_sel_hi:[1,1,1]
    v_pk_fma_f32 v[170:171], v[170:171], v[60:61], v[250:251] op_sel:[0,1,0] op_sel_hi:[1,1,1]
    ds_write_b128 v4, v[168:171] offset:15552
    v_pk_fma_f32 v[172:173], v[172:173], v[60:61], v[252:253] op_sel:[0,1,0] op_sel_hi:[1,1,1]
    v_pk_fma_f32 v[174:175], v[174:175], v[60:61], v[254:255] op_sel:[0,1,0] op_sel_hi:[1,1,1]
    ds_write_b128 v4, v[172:175] offset:15616
    ds_read_b128 v[176:179], v5 offset:15360
    ds_read_b128 v[180:183], v5 offset:15424
    ds_read_b128 v[184:187], v5 offset:15488
    ds_read_b128 v[188:191], v5 offset:15552
    ds_read_b128 v[192:195], v5 offset:15616
    s_waitcnt lgkmcnt(15)
    v_pk_add_f32 v[96:97], v[96:97], v[100:101]
    v_pk_add_f32 v[104:105], v[104:105], v[16:17]
    v_pk_add_f32 v[98:99], v[98:99], v[102:103]
    v_pk_add_f32 v[106:107], v[106:107], v[18:19]
    v_pk_add_f32 v[96:97], v[96:97], v[104:105]
    v_pk_add_f32 v[98:99], v[98:99], v[106:107]
    v_pk_add_f32 v[108:109], v[108:109], v[112:113]
    v_pk_add_f32 v[116:117], v[116:117], v[20:21]
    v_pk_add_f32 v[110:111], v[110:111], v[114:115]
    v_pk_add_f32 v[118:119], v[118:119], v[22:23]
    v_pk_add_f32 v[108:109], v[108:109], v[116:117]
    v_pk_add_f32 v[110:111], v[110:111], v[118:119]
    v_pk_add_f32 v[120:121], v[120:121], v[124:125]
    v_pk_add_f32 v[128:129], v[128:129], v[24:25]
    v_pk_add_f32 v[122:123], v[122:123], v[126:127]
    v_pk_add_f32 v[130:131], v[130:131], v[26:27]
    v_pk_add_f32 v[120:121], v[120:121], v[128:129]
    v_pk_add_f32 v[122:123], v[122:123], v[130:131]
    s_waitcnt lgkmcnt(13)
    v_pk_add_f32 v[132:133], v[132:133], v[136:137]
    v_pk_add_f32 v[140:141], v[140:141], v[28:29]
    v_pk_add_f32 v[134:135], v[134:135], v[138:139]
    v_pk_add_f32 v[142:143], v[142:143], v[30:31]
    v_pk_add_f32 v[132:133], v[132:133], v[140:141]
    v_pk_add_f32 v[134:135], v[134:135], v[142:143]
    s_waitcnt lgkmcnt(10)
    v_pk_add_f32 v[144:145], v[144:145], v[148:149]
    v_pk_add_f32 v[152:153], v[152:153], v[84:85]
    v_pk_add_f32 v[146:147], v[146:147], v[150:151]
    v_pk_add_f32 v[154:155], v[154:155], v[86:87]
    v_pk_add_f32 v[144:145], v[144:145], v[152:153]
    v_pk_add_f32 v[146:147], v[146:147], v[154:155]
    s_waitcnt lgkmcnt(4)
    v_pk_add_f32 v[96:97], v[96:97], v[176:177]
    v_pk_add_f32 v[98:99], v[98:99], v[178:179]
    s_waitcnt lgkmcnt(3)
    v_pk_add_f32 v[108:109], v[108:109], v[180:181]
    v_pk_add_f32 v[110:111], v[110:111], v[182:183]
    s_waitcnt lgkmcnt(2)
    v_pk_add_f32 v[120:121], v[120:121], v[184:185]
    v_pk_add_f32 v[122:123], v[122:123], v[186:187]
    s_waitcnt lgkmcnt(1)
    v_pk_add_f32 v[132:133], v[132:133], v[188:189]
    v_pk_add_f32 v[134:135], v[134:135], v[190:191]
    s_waitcnt lgkmcnt(0)
    v_pk_add_f32 v[144:145], v[144:145], v[192:193]
    v_pk_add_f32 v[146:147], v[146:147], v[194:195]
    s_cmp_eq_u32 s62, 0
    s_cbranch_scc0 L_gateslow_31
L_gateok_32:
    s_waitcnt vmcnt(0)
    v_pk_fma_f32 v[96:97], v[64:65], v[10:11], v[96:97] op_sel:[0,1,0] op_sel_hi:[1,1,1]
    v_pk_fma_f32 v[98:99], v[66:67], v[10:11], v[98:99] op_sel:[0,1,0] op_sel_hi:[1,1,1]
    buffer_store_dwordx4 v[96:99], v6, s[36:39], 0 offen offset:0
    v_pk_fma_f32 v[108:109], v[68:69], v[10:11], v[108:109] op_sel:[0,1,0] op_sel_hi:[1,1,1]
    v_pk_fma_f32 v[110:111], v[70:71], v[10:11], v[110:111] op_sel:[0,1,0] op_sel_hi:[1,1,1]
    buffer_store_dwordx4 v[108:111], v6, s[36:39], 0 offen offset:64
    v_pk_fma_f32 v[120:121], v[72:73], v[10:11], v[120:121] op_sel:[0,1,0] op_sel_hi:[1,1,1]
    v_pk_fma_f32 v[122:123], v[74:75], v[10:11], v[122:123] op_sel:[0,1,0] op_sel_hi:[1,1,1]
    buffer_store_dwordx4 v[120:123], v6, s[36:39], 0 offen offset:128
    v_pk_fma_f32 v[132:133], v[76:77], v[10:11], v[132:133] op_sel:[0,1,0] op_sel_hi:[1,1,1]
    v_pk_fma_f32 v[134:135], v[78:79], v[10:11], v[134:135] op_sel:[0,1,0] op_sel_hi:[1,1,1]
    buffer_store_dwordx4 v[132:135], v6, s[36:39], 0 offen offset:192
    v_pk_fma_f32 v[144:145], v[80:81], v[10:11], v[144:145] op_sel:[0,1,0] op_sel_hi:[1,1,1]
    v_pk_fma_f32 v[146:147], v[82:83], v[10:11], v[146:147] op_sel:[0,1,0] op_sel_hi:[1,1,1]
    buffer_store_dwordx4 v[144:147], v6, s[36:39], 0 offen offset:256
L_end:
    s_endpgm
L_classB:
    s_nop 4
    v_add_u32 v10, 20480, v12
    v_add_u32 v11, 40960, v12
    s_cmp_eq_u32 s6, 31
    s_cselect_b32 s3, 819200, 0
    s_cmp_eq_u32 s4, 0
    s_cselect_b32 s3, s3, 0
    v_subrev_u32 v10, s3, v10
    s_lshl_b32 s59, s4, 10
    s_add_u32 s59, s59, 65536
    s_lshl_b32 s58, s4, 12
    s_add_u32 s58, s58, 118784
    s_waitcnt lgkmcnt(0)
    s_cmp_lt_u32 s4, 2
    s_cselect_b32 s20, s70, s72
    s_cselect_b32 s21, s71, s73
    s_mov_b32 s22, 819200
    s_mov_b32 s23, 0x20000
    s_cmp_eq_u32 s6, 31
    s_cselect_b32 s12, s90, s20
    s_cselect_b32 s13, s91, s21
    s_cselect_b32 s14, 1280, s22
    s_mov_b32 s15, 0x20000
    s_add_u32 m0, s59, 0
    s_nop 0
    buffer_load_dwordx4 v12, s[20:23], s60 offen lds
    s_add_u32 m0, s59, 4096
    s_nop 0
    buffer_load_dwordx4 v10, s[12:15], s60 offen lds
    s_add_u32 m0, s59, 8192
    s_nop 0
    buffer_load_dwordx4 v11, s[20:23], s60 offen lds
    s_add_u32 s60, s60, 128
    s_mov_b32 s32, s96
    s_mov_b32 s33, s97
    s_mov_b32 s34, 268435456
    s_mov_b32 s35, 0x20000
    s_mov_b32 s40, s94
    s_mov_b32 s41, s95
    s_mov_b32 s42, 256
    s_mov_b32 s43, 0x20000
    s_mov_b32 s64, s92
    s_mov_b32 s65, s93
    v_and_b32 v24, 31, v1
    v_lshrrev_b32 v25, 5, v1
    v_bfe_u32 v26, v1, 1, 3
    v_xor_b32 v25, v25, v26
    v_lshlrev_b32 v24, 7, v24
    v_xor_b32 v26, 0, v25
    v_lshl_add_u32 v26, v26, 4, v24
    v_add_u32 v13, s57, v26
    v_add_u32 v17, 65536, v26
    v_xor_b32 v26, 2, v25
    v_lshl_add_u32 v26, v26, 4, v24
    v_add_u32 v14, s57, v26
    v_add_u32 v18, 65536, v26
    v_xor_b32 v26, 4, v25
    v_lshl_add_u32 v26, v26, 4, v24
    v_add_u32 v15, s57, v26
    v_add_u32 v19, 65536, v26
    v_xor_b32 v26, 6, v25
    v_lshl_add_u32 v26, v26, 4, v24
    v_add_u32 v16, s57, v26
    v_add_u32 v20, 65536, v26
    s_mov_b32 s48, s2
    s_mul_i32 s95, s48, 293
    s_lshr_b32 s95, s95, 12
    s_mul_i32 s3, s95, 14
    s_sub_u32 s3, s48, s3
    s_lshl_b32 s56, s3, 2
    s_add_u32 s56, s56, s4
    s_cmp_lt_u32 s48, 252
    s_cselect_b32 s55, 0, 2130706432
    s_cselect_b32 s95, s95, 0
    s_cmp_lt_u32 s95, 10
    s_cselect_b32 s62, 1, 0
    s_cselect_b32 s24, s88, s74
    s_cselect_b32 s25, s89, s75
    s_cselect_b32 s28, s88, s76
    s_cselect_b32 s29, s89, s77
    s_mov_b32 s26, 819200
    s_cmov_b32 s26, 2211840
    s_mov_b32 s53, 0
    s_cmov_b32 s53, 20480
    s_mov_b32 s85, 40960
    s_cmov_b32 s85, 1024
    s_mov_b32 s30, s26
    s_mov_b32 s27, 0x20000
    s_mov_b32 s31, 0x20000
    v_lshrrev_b32 v31, 3, v1
    v_mul_u32_u24 v31, 1280, v31
    v_and_b32 v29, 7, v1
    v_lshl_add_u32 v31, v29, 4, v31
    v_lshlrev_b32 v33, 4, v1
    s_add_u32 s3, s56, 0
    s_mul_i32 s7, s3, 26
    s_lshr_b32 s7, s7, 8
    s_mul_i32 s92, s7, 10
    s_sub_u32 s92, s3, s92
    s_sub_u32 s93, s95, 10
    s_mul_i32 s93, s93, 5
    s_add_u32 s7, s7, s93
    s_mul_i32 s84, s92, 163840
    s_lshl_b32 s93, s7, 10
    s_add_u32 s84, s84, s93
    s_add_u32 s84, s84, 14794752
    s_mul_i32 s52, s7, 20480
    s_lshl_b32 s92, s92, 7
    s_add_u32 s52, s52, s92
    s_mul_i32 s7, s3, 40960
    s_lshl_b32 s92, s95, 7
    s_add_u32 s7, s7, s92
    s_lshr_b32 s92, s3, 1
    s_and_b32 s93, s3, 1
    s_mul_i32 s93, s93, 27
    s_add_u32 s92, s92, s93
    s_mul_i32 s92, s92, 40960
    s_lshl_b32 s93, s95, 12
    s_add_u32 s92, s92, s93
    s_add_u32 s92, s92, 12582912
    s_cmp_eq_u32 s62, 1
    s_cmov_b32 s52, s7
    s_cmov_b32 s84, s92
    s_cselect_b32 s7, 54, 50
    s_cmp_lt_u32 s3, s7
    s_cselect_b32 s3, s55, 2130706432
    s_cselect_b32 s52, s52, 0
    v_or_b32 v28, s3, v31
    v_or_b32 v38, s3, v33
    v_lshrrev_b32 v33, 5, v1
    v_lshlrev_b32 v33, 4, v33
    v_bfe_u32 v30, v1, 2, 3
    v_add_u32 v30, v33, v30
    v_and_b32 v32, 3, v1
    v_lshlrev_b32 v32, 3, v32
    v_add_u32 v32, s58, v32
    v_lshl_add_u32 v30, v30, 7, v32
    v_and_b32 v32, 15, v1
    v_add_u32 v32, v33, v32
    v_lshlrev_b32 v32, 7, v32
    v_bfe_u32 v33, v1, 4, 1
    v_lshl_add_u32 v32, v33, 4, v32
    v_add_u32 v32, s58, v32
    s_bfe_u32 s83, s2, 0x10002
    s_and_b32 s82, s2, 1
    s_lshl_b32 s82, s82, 1
    s_bfe_u32 s3, s2, 0x10001
    s_add_u32 s82, s82, s3
    s_lshl_b32 s82, s82, 2
    s_bfe_u32 s3, s2, 0x20003
    s_add_u32 s82, s82, s3
    s_lshl_b32 s82, s82, 1
    s_add_u32 s82, s82, s83
    s_mul_i32 s88, s83, 1638400
    s_add_u32 s88, s88, 13156352
    s_cmp_lt_u32 s4, 2
    s_cselect_b32 s63, 0, 2130706432
    s_cmp_ge_u32 s2, 8
    s_cbranch_scc1 L_noelect_35
    s_cmp_lg_u32 s4, 0
    s_cbranch_scc1 L_noelect_35
    s_or_b32 s98, s98, 1
    v_mov_b32 v24, s98
    v_mov_b32 v25, s99
    v_mov_b32 v26, 0
    v_mov_b32 v27, 0
    s_mov_b64 exec, 1
    buffer_atomic_cmpswap_x2 v[24:27], v26, s[40:43], 0 offen sc1
    s_mov_b64 exec, -1
    s_nop 1
L_noelect_35:
    s_add_u32 m0, s59, 12288
    s_nop 0
    buffer_load_dwordx4 v12, s[20:23], s60 offen lds
    s_add_u32 m0, s59, 16384
    s_nop 0
    buffer_load_dwordx4 v10, s[12:15], s60 offen lds
    s_add_u32 m0, s59, 20480
    s_nop 0
    buffer_load_dwordx4 v11, s[20:23], s60 offen lds
    s_add_u32 m0, s57, 8192
    s_nop 0
    buffer_load_dwordx4 v2, s[8:11], s60 offen lds
    buffer_load_dwordx4 v3, s[8:11], s60 offen offset:1024 lds
    buffer_load_dwordx4 v4, s[8:11], s60 offen offset:2048 lds
    buffer_load_dwordx4 v5, s[8:11], s60 offen offset:3072 lds
    s_add_u32 m0, s57, 12288
    s_nop 0
    buffer_load_dwordx4 v6, s[8:11], s60 offen lds
    buffer_load_dwordx4 v7, s[8:11], s60 offen offset:1024 lds
    buffer_load_dwordx4 v8, s[8:11], s60 offen offset:2048 lds
    buffer_load_dwordx4 v9, s[8:11], s60 offen offset:3072 lds
    s_add_u32 s60, s60, 128
    s_waitcnt vmcnt(11)
    s_barrier
    ds_read_b128 a[192:195], v13 offset:0
    ds_read_b128 a[196:199], v13 offset:4096
    ds_read_b128 v[40:43], v17 offset:0
    ds_read_b128 v[44:47], v17 offset:4096
    ds_read_b128 v[48:51], v17 offset:8192
    ds_read_b128 a[200:203], v14 offset:0
    ds_read_b128 a[204:207], v14 offset:4096
    s_waitcnt lgkmcnt(5)
    s_waitcnt lgkmcnt(4)
    v_mfma_f32_32x32x16_bf16 v[96:111], a[192:195], v[40:43], 0
    ds_read_b128 v[60:63], v18 offset:0
    ds_read_b128 v[64:67], v18 offset:4096
    v_mfma_f32_32x32x16_bf16 v[112:127], a[196:199], v[40:43], 0
    ds_read_b128 v[68:71], v18 offset:8192
    ds_read_b128 a[208:211], v15 offset:0
    s_add_u32 m0, s59, 24576
    s_nop 0
    buffer_load_dwordx4 v12, s[20:23], s60 offen lds
    s_waitcnt lgkmcnt(7)
    v_mfma_f32_32x32x16_bf16 v[128:143], a[192:195], v[44:47], 0
    ds_read_b128 a[212:215], v15 offset:4096
    ds_read_b128 a[216:219], v16 offset:0
    v_mfma_f32_32x32x16_bf16 v[144:159], a[196:199], v[44:47], 0
    ds_read_b128 a[220:223], v16 offset:4096
    s_add_u32 m0, s59, 28672
    s_nop 0
    buffer_load_dwordx4 v10, s[12:15], s60 offen lds
    s_waitcnt lgkmcnt(9)
    v_mfma_f32_32x32x16_bf16 v[160:175], a[192:195], v[48:51], 0
    v_mfma_f32_32x32x16_bf16 v[176:191], a[196:199], v[48:51], 0
    s_add_u32 m0, s59, 32768
    s_nop 0
    buffer_load_dwordx4 v11, s[20:23], s60 offen lds
    s_waitcnt lgkmcnt(7)
    s_waitcnt lgkmcnt(6)
    v_mfma_f32_32x32x16_bf16 v[96:111], a[200:203], v[60:63], v[96:111]
    ds_read_b128 v[40:43], v19 offset:0
    ds_read_b128 v[44:47], v19 offset:4096
    s_waitcnt lgkmcnt(2)
    s_add_u32 m0, s57, 0
    s_nop 0
    buffer_load_dwordx4 v2, s[8:11], s60 offen lds
    v_mfma_f32_32x32x16_bf16 v[112:127], a[204:207], v[60:63], v[112:127]
    ds_read_b128 v[48:51], v19 offset:8192
    buffer_load_dwordx4 v3, s[8:11], s60 offen offset:1024 lds
    v_mfma_f32_32x32x16_bf16 v[128:143], a[200:203], v[64:67], v[128:143]
    buffer_load_dwordx4 v4, s[8:11], s60 offen offset:2048 lds
    v_mfma_f32_32x32x16_bf16 v[144:159], a[204:207], v[64:67], v[144:159]
    buffer_load_dwordx4 v5, s[8:11], s60 offen offset:3072 lds
    v_mfma_f32_32x32x16_bf16 v[160:175], a[200:203], v[68:71], v[160:175]
    s_add_u32 m0, s57, 4096
    s_nop 0
    buffer_load_dwordx4 v6, s[8:11], s60 offen lds
    v_mfma_f32_32x32x16_bf16 v[176:191], a[204:207], v[68:71], v[176:191]
    buffer_load_dwordx4 v7, s[8:11], s60 offen offset:1024 lds
    s_waitcnt lgkmcnt(2)
    v_mfma_f32_32x32x16_bf16 v[96:111], a[208:211], v[40:43], v[96:111]
    ds_read_b128 v[60:63], v20 offset:0
    ds_read_b128 v[64:67], v20 offset:4096
    buffer_load_dwordx4 v8, s[8:11], s60 offen offset:2048 lds
    v_mfma_f32_32x32x16_bf16 v[112:127], a[212:215], v[40:43], v[112:127]
    ds_read_b128 v[68:71], v20 offset:8192
    buffer_load_dwordx4 v9, s[8:11], s60 offen offset:3072 lds
    s_add_u32 s60, s60, 128
    s_waitcnt lgkmcnt(4)
    v_mfma_f32_32x32x16_bf16 v[128:143], a[208:211], v[44:47], v[128:143]
    v_and_b32 v23, 15, v1
    s_lshl_b32 s3, s54, 4
    v_add_u32 v23, s3, v23
    v_lshlrev_b32 v23, 1, v23
    v_mfma_f32_32x32x16_bf16 v[144:159], a[212:215], v[44:47], v[144:159]
    s_mov_b32 s44, s66
    s_mov_b32 s45, s67
    s_mov_b32 s46, 1280
    s_mov_b32 s47, 0x20000
    buffer_load_ushort v228, v23, s[44:47], 0 offen offset:0
    s_waitcnt lgkmcnt(3)
    v_mfma_f32_32x32x16_bf16 v[160:175], a[208:211], v[48:51], v[160:175]
    buffer_load_ushort v236, v23, s[44:47], 0 offen offset:32
    v_mfma_f32_32x32x16_bf16 v[176:191], a[212:215], v[48:51], v[176:191]
    buffer_load_ushort v244, v23, s[44:47], 0 offen offset:64
    s_waitcnt lgkmcnt(2)
    v_mfma_f32_32x32x16_bf16 v[96:111], a[216:219], v[60:63], v[96:111]
    s_waitcnt lgkmcnt(0)
    s_mov_b32 s44, s68
    s_mov_b32 s45, s69
    s_mov_b32 s46, 1280
    s_mov_b32 s47, 0x20000
    buffer_load_ushort v229, v23, s[44:47], 0 offen offset:0
    buffer_load_ushort v237, v23, s[44:47], 0 offen offset:32
    buffer_load_ushort v245, v23, s[44:47], 0 offen offset:64
    s_mov_b32 s44, s78
    s_mov_b32 s45, s79
    s_mov_b32 s46, 1280
    s_mov_b32 s47, 0x20000
    buffer_load_ushort v230, v23, s[44:47], 0 offen offset:0
    buffer_load_ushort v238, v23, s[44:47], 0 offen offset:32
    buffer_load_ushort v246, v23, s[44:47], 0 offen offset:64
    s_mov_b32 s44, s80
    s_mov_b32 s45, s81
    s_mov_b32 s46, 1280
    s_mov_b32 s47, 0x20000
    v_lshlrev_b32 v94, 7, v1
    buffer_load_dword v95, v94, s[44:47], 0 offen
    s_add_u32 m0, s58, 0
    s_mov_b32 s3, s52
    buffer_load_dwordx4 v28, s[24:27], s3 offen nt lds
    s_add_u32 m0, s58, 1024
    s_add_u32 s3, s52, 10240
    buffer_load_dwordx4 v28, s[24:27], s3 offen nt lds
    s_add_u32 m0, s58, 2048
    s_add_u32 s3, s52, s53
    buffer_load_dwordx4 v28, s[28:31], s3 offen nt lds
    s_add_u32 m0, s58, 3072
    s_add_u32 s3, s52, s53
    s_add_u32 s3, s3, 10240
    buffer_load_dwordx4 v28, s[28:31], s3 offen nt lds
    s_waitcnt vmcnt(25)
    s_barrier
    ds_read_b128 a[224:227], v13 offset:8192
    ds_read_b128 a[228:231], v13 offset:12288
    v_mfma_f32_32x32x16_bf16 v[112:127], a[220:223], v[60:63], v[112:127]
    ds_read_b128 v[40:43], v17 offset:12288
    ds_read_b128 v[44:47], v17 offset:16384
    s_add_u32 m0, s59, 0
    s_nop 0
    buffer_load_dwordx4 v12, s[20:23], s60 offen lds
    v_mfma_f32_32x32x16_bf16 v[128:143], a[216:219], v[64:67], v[128:143]
    ds_read_b128 v[48:51], v17 offset:20480
    ds_read_b128 a[232:235], v14 offset:8192
    v_mfma_f32_32x32x16_bf16 v[144:159], a[220:223], v[64:67], v[144:159]
    ds_read_b128 a[236:239], v14 offset:12288
    s_add_u32 m0, s59, 4096
    s_nop 0
    buffer_load_dwordx4 v10, s[12:15], s60 offen lds
    v_mfma_f32_32x32x16_bf16 v[160:175], a[216:219], v[68:71], v[160:175]
    v_mfma_f32_32x32x16_bf16 v[176:191], a[220:223], v[68:71], v[176:191]
    s_add_u32 m0, s59, 8192
    s_nop 0
    buffer_load_dwordx4 v11, s[20:23], s60 offen lds
    s_waitcnt lgkmcnt(5)
    s_waitcnt lgkmcnt(4)
    v_mfma_f32_32x32x16_bf16 v[96:111], a[224:227], v[40:43], v[96:111]
    ds_read_b128 v[60:63], v18 offset:12288
    ds_read_b128 v[64:67], v18 offset:16384
    v_mfma_f32_32x32x16_bf16 v[112:127], a[228:231], v[40:43], v[112:127]
    ds_read_b128 v[68:71], v18 offset:20480
    ds_read_b128 a[240:243], v15 offset:8192
    s_waitcnt lgkmcnt(7)
    v_mfma_f32_32x32x16_bf16 v[128:143], a[224:227], v[44:47], v[128:143]
    ds_read_b128 a[244:247], v15 offset:12288
    ds_read_b128 a[248:251], v16 offset:8192
    v_mfma_f32_32x32x16_bf16 v[144:159], a[228:231], v[44:47], v[144:159]
    ds_read_b128 a[252:255], v16 offset:12288
    s_waitcnt lgkmcnt(9)
    v_mfma_f32_32x32x16_bf16 v[160:175], a[224:227], v[48:51], v[160:175]
    v_mfma_f32_32x32x16_bf16 v[176:191], a[228:231], v[48:51], v[176:191]
    s_waitcnt lgkmcnt(7)
    s_waitcnt lgkmcnt(6)
    v_mfma_f32_32x32x16_bf16 v[96:111], a[232:235], v[60:63], v[96:111]
    ds_read_b128 v[40:43], v19 offset:12288
    ds_read_b128 v[44:47], v19 offset:16384
    s_waitcnt lgkmcnt(2)
    s_add_u32 m0, s57, 8192
    s_nop 0
    buffer_load_dwordx4 v2, s[8:11], s60 offen lds
    v_mfma_f32_32x32x16_bf16 v[112:127], a[236:239], v[60:63], v[112:127]
    ds_read_b128 v[48:51], v19 offset:20480
    buffer_load_dwordx4 v3, s[8:11], s60 offen offset:1024 lds
    v_mfma_f32_32x32x16_bf16 v[128:143], a[232:235], v[64:67], v[128:143]
    buffer_load_dwordx4 v4, s[8:11], s60 offen offset:2048 lds
    v_mfma_f32_32x32x16_bf16 v[144:159], a[236:239], v[64:67], v[144:159]
    buffer_load_dwordx4 v5, s[8:11], s60 offen offset:3072 lds
    v_mfma_f32_32x32x16_bf16 v[160:175], a[232:235], v[68:71], v[160:175]
    s_add_u32 m0, s57, 12288
    s_nop 0
    buffer_load_dwordx4 v6, s[8:11], s60 offen lds
    v_mfma_f32_32x32x16_bf16 v[176:191], a[236:239], v[68:71], v[176:191]
    buffer_load_dwordx4 v7, s[8:11], s60 offen offset:1024 lds
    s_waitcnt lgkmcnt(2)
    v_mfma_f32_32x32x16_bf16 v[96:111], a[240:243], v[40:43], v[96:111]
    ds_read_b128 v[60:63], v20 offset:12288
    ds_read_b128 v[64:67], v20 offset:16384
    buffer_load_dwordx4 v8, s[8:11], s60 offen offset:2048 lds
    v_mfma_f32_32x32x16_bf16 v[112:127], a[244:247], v[40:43], v[112:127]
    ds_read_b128 v[68:71], v20 offset:20480
    buffer_load_dwordx4 v9, s[8:11], s60 offen offset:3072 lds
    s_add_u32 s60, s60, 128
    s_waitcnt vmcnt(11)
    s_cmp_eq_u32 s62, 1
    s_cbranch_scc0 L_rpc_36
    ds_read_b64_tr_b16 a[0:1], v30 offset:0
    ds_read_b64_tr_b16 a[2:3], v30 offset:1024
    ds_read_b64_tr_b16 a[4:5], v30 offset:32
    ds_read_b64_tr_b16 a[6:7], v30 offset:1056
    s_branch L_rpd_37
L_rpc_36:
    ds_read_b128 a[0:3], v32 offset:0
    ds_read_b128 a[4:7], v32 offset:32
L_rpd_37:
    s_waitcnt lgkmcnt(4)
    v_mfma_f32_32x32x16_bf16 v[128:143], a[240:243], v[44:47], v[128:143]
    s_cmp_eq_u32 s62, 1
    s_cbranch_scc0 L_rpc_38
    ds_read_b64_tr_b16 a[8:9], v30 offset:64
    ds_read_b64_tr_b16 a[10:11], v30 offset:1088
    ds_read_b64_tr_b16 a[12:13], v30 offset:96
    ds_read_b64_tr_b16 a[14:15], v30 offset:1120
    s_branch L_rpd_39
L_rpc_38:
    ds_read_b128 a[8:11], v32 offset:64
    ds_read_b128 a[12:15], v32 offset:96
L_rpd_39:
    v_mfma_f32_32x32x16_bf16 v[144:159], a[244:247], v[44:47], v[144:159]
    s_waitcnt lgkmcnt(3)
    v_mfma_f32_32x32x16_bf16 v[160:175], a[240:243], v[48:51], v[160:175]
    v_mfma_f32_32x32x16_bf16 v[176:191], a[244:247], v[48:51], v[176:191]
    s_waitcnt lgkmcnt(2)
    v_mfma_f32_32x32x16_bf16 v[96:111], a[248:251], v[60:63], v[96:111]
    s_waitcnt lgkmcnt(0)
    s_barrier
    ds_read_b128 a[192:195], v13 offset:0
    ds_read_b128 a[196:199], v13 offset:4096
    v_lshrrev_b32 v254, 4, v1
    v_lshl_add_u32 v252, s4, 2, v254
    v_lshlrev_b32 v252, 4, v252
    v_mfma_f32_32x32x16_bf16 v[112:127], a[252:255], v[60:63], v[112:127]
    ds_read_b128 v[40:43], v17 offset:24576
    ds_read_b128 v[44:47], v17 offset:28672
    s_add_u32 m0, s59, 12288
    s_nop 0
    buffer_load_dwordx4 v12, s[20:23], s60 offen lds
    v_cvt_f32_u32 v252, v252
    v_sub_u32 v254, s5, v254
    v_add_u32 v254, -1, v254
    v_mfma_f32_32x32x16_bf16 v[128:143], a[248:251], v[64:67], v[128:143]
    ds_read_b128 v[48:51], v17 offset:32768
    ds_read_b128 a[200:203], v14 offset:0
    v_lshlrev_b32 v254, 8, v254
    v_cvt_f32_i32 v253, v254
    v_add_f32 v254, 0xc4800000, v253
    v_lshlrev_b32 v228, 16, v228
    v_mfma_f32_32x32x16_bf16 v[144:159], a[252:255], v[64:67], v[144:159]
    ds_read_b128 a[204:207], v14 offset:4096
    s_add_u32 m0, s59, 16384
    s_nop 0
    buffer_load_dwordx4 v10, s[12:15], s60 offen lds
    v_lshlrev_b32 v229, 16, v229
    v_lshlrev_b32 v230, 16, v230
    v_mul_f32 v230, 0x3fb8aa3b, v230
    v_exp_f32 v230, v230
    v_mfma_f32_32x32x16_bf16 v[160:175], a[248:251], v[68:71], v[160:175]
    v_mul_f32 v234, v228, v228
    v_cvt_pk_bf16_f32 v230, v230, v230
    v_fmac_f32 v234, v229, v229
    v_lshlrev_b32 v230, 16, v230
    v_rcp_f32 v234, v234
    v_mul_f32 v231, v230, v228
    v_mfma_f32_32x32x16_bf16 v[176:191], a[252:255], v[68:71], v[176:191]
    s_add_u32 m0, s59, 20480
    s_nop 0
    buffer_load_dwordx4 v11, s[20:23], s60 offen lds
    v_mul_f32 v232, v230, v229
    v_mul_f32 v231, 0x3fb8aa3b, v231
    v_mul_f32 v232, 0x3e22f983, v232
    v_exp_f32 v230, v231
    v_mov_b32 v233, v232
    s_waitcnt lgkmcnt(5)
    s_waitcnt lgkmcnt(4)
    v_mfma_f32_32x32x16_bf16 v[96:111], a[192:195], v[40:43], v[96:111]
    ds_read_b128 v[60:63], v18 offset:24576
    ds_read_b128 v[64:67], v18 offset:28672
    v_rndne_f32 v235, v233
    v_sub_f32 v233, v233, v235
    v_cos_f32 v192, v233
    v_mfma_f32_32x32x16_bf16 v[112:127], a[196:199], v[40:43], v[112:127]
    ds_read_b128 v[68:71], v18 offset:32768
    ds_read_b128 a[208:211], v15 offset:0
    v_sin_f32 v193, v233
    s_nop 0
    v_mul_f32 v192, v230, v192
    v_mul_f32 v193, v230, v193
    s_waitcnt lgkmcnt(7)
    v_mfma_f32_32x32x16_bf16 v[128:143], a[192:195], v[44:47], v[128:143]
    ds_read_b128 a[212:215], v15 offset:4096
    ds_read_b128 a[216:219], v16 offset:0
    v_add_f32 v233, -1.0, v192
    v_add_f32 v234, v234, v234
    v_mul_f32 v194, v233, v228
    v_mfma_f32_32x32x16_bf16 v[144:159], a[196:199], v[44:47], v[144:159]
    ds_read_b128 a[220:223], v16 offset:4096
    v_mul_f32 v195, v193, v228
    v_fmac_f32 v194, v193, v229
    v_fma_f32 v195, -v233, v229, v195
    v_mul_f32 v194, v194, v234
    v_mul_f32 v195, v195, v234
    s_waitcnt lgkmcnt(9)
    v_mfma_f32_32x32x16_bf16 v[160:175], a[192:195], v[48:51], v[160:175]
    v_mul_f32 v230, 0x41800000, v231
    v_mul_f32 v233, 0x41800000, v232
    v_exp_f32 v230, v230
    v_rndne_f32 v235, v233
    v_sub_f32 v233, v233, v235
    v_mfma_f32_32x32x16_bf16 v[176:191], a[196:199], v[48:51], v[176:191]
    v_cos_f32 v196, v233
    v_sin_f32 v197, v233
    s_nop 0
    v_mul_f32 v196, v230, v196
    v_mul_f32 v197, v230, v197
    v_mul_f32 v230, v252, v231
    s_waitcnt lgkmcnt(7)
    s_waitcnt lgkmcnt(6)
    v_mfma_f32_32x32x16_bf16 v[96:111], a[200:203], v[60:63], v[96:111]
    ds_read_b128 v[40:43], v19 offset:24576
    ds_read_b128 v[44:47], v19 offset:28672
    s_waitcnt lgkmcnt(2)
    s_add_u32 m0, s57, 0
    s_nop 0
    buffer_load_dwordx4 v2, s[8:11], s60 offen lds
    v_mul_f32 v233, v252, v232
    v_exp_f32 v230, v230
    v_mfma_f32_32x32x16_bf16 v[112:127], a[204:207], v[60:63], v[112:127]
    ds_read_b128 v[48:51], v19 offset:32768
    buffer_load_dwordx4 v3, s[8:11], s60 offen offset:1024 lds
    v_rndne_f32 v235, v233
    v_sub_f32 v233, v233, v235
    v_cos_f32 v198, v233
    v_sin_f32 v199, v233
    v_mfma_f32_32x32x16_bf16 v[128:143], a[200:203], v[64:67], v[128:143]
    buffer_load_dwordx4 v4, s[8:11], s60 offen offset:2048 lds
    s_nop 0
    v_mul_f32 v198, v230, v198
    v_mul_f32 v199, v230, v199
    v_mul_f32 v230, v253, v231
    v_mul_f32 v233, v253, v232
    v_mfma_f32_32x32x16_bf16 v[144:159], a[204:207], v[64:67], v[144:159]
    buffer_load_dwordx4 v5, s[8:11], s60 offen offset:3072 lds
    v_exp_f32 v230, v230
    v_rndne_f32 v235, v233
    v_cmp_le_f32 vcc, 0, v253
    v_sub_f32 v233, v233, v235
    v_cos_f32 v200, v233
    v_mfma_f32_32x32x16_bf16 v[160:175], a[200:203], v[68:71], v[160:175]
    s_add_u32 m0, s57, 4096
    s_nop 0
    buffer_load_dwordx4 v6, s[8:11], s60 offen lds
    v_sin_f32 v201, v233
    v_cndmask_b32 v230, 0, v230, vcc
    v_mul_f32 v200, v230, v200
    v_mul_f32 v201, v230, v201
    v_mul_f32 v230, v254, v231
    v_mfma_f32_32x32x16_bf16 v[176:191], a[204:207], v[68:71], v[176:191]
    buffer_load_dwordx4 v7, s[8:11], s60 offen offset:1024 lds
    v_mul_f32 v233, v254, v232
    v_exp_f32 v230, v230
    v_rndne_f32 v235, v233
    v_cmp_le_f32 vcc, 0, v254
    v_sub_f32 v233, v233, v235
    s_waitcnt lgkmcnt(2)
    v_mfma_f32_32x32x16_bf16 v[96:111], a[208:211], v[40:43], v[96:111]
    ds_read_b128 v[60:63], v20 offset:24576
    ds_read_b128 v[64:67], v20 offset:28672
    buffer_load_dwordx4 v8, s[8:11], s60 offen offset:2048 lds
    v_cos_f32 v202, v233
    v_sin_f32 v203, v233
    v_mfma_f32_32x32x16_bf16 v[112:127], a[212:215], v[40:43], v[112:127]
    ds_read_b128 v[68:71], v20 offset:32768
    buffer_load_dwordx4 v9, s[8:11], s60 offen offset:3072 lds
    s_add_u32 s60, s60, 128
    s_cmp_ge_u32 s60, 1280
    s_cmov_b32 s60, 0
    s_cmov_b32 s61, 0
    v_cndmask_b32 v230, 0, v230, vcc
    v_mul_f32 v202, v230, v202
    v_mul_f32 v203, v230, v203
    v_lshlrev_b32 v236, 16, v236
    s_waitcnt lgkmcnt(4)
    v_mfma_f32_32x32x16_bf16 v[128:143], a[208:211], v[44:47], v[128:143]
    buffer_store_dwordx4 a[0:3], v38, s[32:35], s84 offen sc1
    s_add_u32 s84, s84, s85
    v_lshlrev_b32 v237, 16, v237
    v_lshlrev_b32 v238, 16, v238
    v_mul_f32 v238, 0x3fb8aa3b, v238
    v_exp_f32 v238, v238
    v_mfma_f32_32x32x16_bf16 v[144:159], a[212:215], v[44:47], v[144:159]
    buffer_store_dwordx4 a[4:7], v38, s[32:35], s84 offen sc1
    s_add_u32 s84, s84, s85
    v_mul_f32 v242, v236, v236
    v_cvt_pk_bf16_f32 v238, v238, v238
    v_fmac_f32 v242, v237, v237
    v_lshlrev_b32 v238, 16, v238
    v_rcp_f32 v242, v242
    s_waitcnt lgkmcnt(3)
    v_mfma_f32_32x32x16_bf16 v[160:175], a[208:211], v[48:51], v[160:175]
    buffer_store_dwordx4 a[8:11], v38, s[32:35], s84 offen sc1
    s_add_u32 s84, s84, s85
    v_mul_f32 v239, v238, v236
    v_mul_f32 v240, v238, v237
    v_mul_f32 v239, 0x3fb8aa3b, v239
    v_mul_f32 v240, 0x3e22f983, v240
    v_mfma_f32_32x32x16_bf16 v[176:191], a[212:215], v[48:51], v[176:191]
    buffer_store_dwordx4 a[12:15], v38, s[32:35], s84 offen sc1
    v_exp_f32 v238, v239
    v_mov_b32 v241, v240
    v_rndne_f32 v243, v241
    v_sub_f32 v241, v241, v243
    v_cos_f32 v204, v241
    s_waitcnt lgkmcnt(2)
    v_mfma_f32_32x32x16_bf16 v[96:111], a[216:219], v[60:63], v[96:111]
    s_waitcnt lgkmcnt(0)
    s_waitcnt vmcnt(15)
    s_barrier
    ds_read_b128 a[224:227], v13 offset:8192
    ds_read_b128 a[228:231], v13 offset:12288
    v_sin_f32 v205, v241
    s_nop 0
    v_mul_f32 v204, v238, v204
    v_mfma_f32_32x32x16_bf16 v[112:127], a[220:223], v[60:63], v[112:127]
    ds_read_b128 v[40:43], v17 offset:0
    ds_read_b128 v[44:47], v17 offset:4096
    v_mov_b32 v93, 0
    s_mov_b64 exec, 0x1
    buffer_load_dwordx2 v[92:93], v93, s[40:43], 0 offen sc1
    s_mov_b64 exec, -1
    v_mul_f32 v205, v238, v205
    v_add_f32 v241, -1.0, v204
    v_add_f32 v242, v242, v242
    v_mfma_f32_32x32x16_bf16 v[128:143], a[216:219], v[64:67], v[128:143]
    ds_read_b128 v[48:51], v17 offset:8192
    ds_read_b128 a[232:235], v14 offset:8192
    v_mul_f32 v206, v241, v236
    v_mul_f32 v207, v205, v236
    v_fmac_f32 v206, v205, v237
    v_fma_f32 v207, -v241, v237, v207
    v_mfma_f32_32x32x16_bf16 v[144:159], a[220:223], v[64:67], v[144:159]
    ds_read_b128 a[236:239], v14 offset:12288
    s_add_u32 m0, s59, 24576
    s_nop 0
    buffer_load_dwordx4 v12, s[20:23], s60 offen lds
    v_mul_f32 v206, v206, v242
    v_mul_f32 v207, v207, v242
    v_mul_f32 v238, 0x41800000, v239
    v_mul_f32 v241, 0x41800000, v240
    v_mfma_f32_32x32x16_bf16 v[160:175], a[216:219], v[68:71], v[160:175]
    v_exp_f32 v238, v238
    v_rndne_f32 v243, v241
    v_sub_f32 v241, v241, v243
    v_cos_f32 v208, v241
    v_sin_f32 v209, v241
    s_nop 0
    v_mfma_f32_32x32x16_bf16 v[176:191], a[220:223], v[68:71], v[176:191]
    s_add_u32 m0, s59, 28672
    s_nop 0
    buffer_load_dwordx4 v10, s[12:15], s60 offen lds
    v_mul_f32 v208, v238, v208
    v_mul_f32 v209, v238, v209
    v_mul_f32 v238, v252, v239
    v_mul_f32 v241, v252, v240
    v_exp_f32 v238, v238
    s_waitcnt lgkmcnt(5)
    s_waitcnt lgkmcnt(4)
    v_mfma_f32_32x32x16_bf16 v[96:111], a[224:227], v[40:43], v[96:111]
    ds_read_b128 v[60:63], v18 offset:0
    ds_read_b128 v[64:67], v18 offset:4096
    v_rndne_f32 v243, v241
    v_sub_f32 v241, v241, v243
    v_cos_f32 v210, v241
    v_mfma_f32_32x32x16_bf16 v[112:127], a[228:231], v[40:43], v[112:127]
    ds_read_b128 v[68:71], v18 offset:8192
    ds_read_b128 a[240:243], v15 offset:8192
    s_add_u32 m0, s59, 32768
    s_nop 0
    buffer_load_dwordx4 v11, s[20:23], s60 offen lds
    v_sin_f32 v211, v241
    s_nop 0
    v_mul_f32 v210, v238, v210
    s_waitcnt lgkmcnt(7)
    v_mfma_f32_32x32x16_bf16 v[128:143], a[224:227], v[44:47], v[128:143]
    ds_read_b128 a[244:247], v15 offset:12288
    ds_read_b128 a[248:251], v16 offset:8192
    v_mul_f32 v211, v238, v211
    v_mul_f32 v238, v253, v239
    v_mul_f32 v241, v253, v240
    v_mfma_f32_32x32x16_bf16 v[144:159], a[228:231], v[44:47], v[144:159]
    ds_read_b128 a[252:255], v16 offset:12288
    v_exp_f32 v238, v238
    v_rndne_f32 v243, v241
    v_cmp_le_f32 vcc, 0, v253
    v_sub_f32 v241, v241, v243
    v_cos_f32 v212, v241
    s_waitcnt lgkmcnt(9)
    v_mfma_f32_32x32x16_bf16 v[160:175], a[224:227], v[48:51], v[160:175]
    v_sin_f32 v213, v241
    v_cndmask_b32 v238, 0, v238, vcc
    v_mul_f32 v212, v238, v212
    v_mul_f32 v213, v238, v213
    v_mul_f32 v238, v254, v239
    v_mfma_f32_32x32x16_bf16 v[176:191], a[228:231], v[48:51], v[176:191]
    v_mul_f32 v241, v254, v240
    v_exp_f32 v238, v238
    v_rndne_f32 v243, v241
    v_cmp_le_f32 vcc, 0, v254
    v_sub_f32 v241, v241, v243
    v_cos_f32 v214, v241
    s_waitcnt lgkmcnt(7)
    s_waitcnt lgkmcnt(6)
    v_mfma_f32_32x32x16_bf16 v[96:111], a[232:235], v[60:63], v[96:111]
    ds_read_b128 v[40:43], v19 offset:0
    ds_read_b128 v[44:47], v19 offset:4096
    s_waitcnt lgkmcnt(2)
    s_add_u32 m0, s57, 8192
    s_nop 0
    buffer_load_dwordx4 v2, s[8:11], s60 offen lds
    v_sin_f32 v215, v241
    v_cndmask_b32 v238, 0, v238, vcc
    v_mfma_f32_32x32x16_bf16 v[112:127], a[236:239], v[60:63], v[112:127]
    ds_read_b128 v[48:51], v19 offset:8192
    buffer_load_dwordx4 v3, s[8:11], s60 offen offset:1024 lds
    v_mul_f32 v214, v238, v214
    v_mul_f32 v215, v238, v215
    v_lshlrev_b32 v244, 16, v244
    v_lshlrev_b32 v245, 16, v245
    v_mfma_f32_32x32x16_bf16 v[128:143], a[232:235], v[64:67], v[128:143]
    buffer_load_dwordx4 v4, s[8:11], s60 offen offset:2048 lds
    v_lshlrev_b32 v246, 16, v246
    v_mul_f32 v246, 0x3fb8aa3b, v246
    v_exp_f32 v246, v246
    v_mul_f32 v250, v244, v244
    v_cvt_pk_bf16_f32 v246, v246, v246
    v_mfma_f32_32x32x16_bf16 v[144:159], a[236:239], v[64:67], v[144:159]
    buffer_load_dwordx4 v5, s[8:11], s60 offen offset:3072 lds
    v_fmac_f32 v250, v245, v245
    v_lshlrev_b32 v246, 16, v246
    v_rcp_f32 v250, v250
    v_mul_f32 v247, v246, v244
    v_mul_f32 v248, v246, v245
    v_mfma_f32_32x32x16_bf16 v[160:175], a[232:235], v[68:71], v[160:175]
    s_add_u32 m0, s57, 12288
    s_nop 0
    buffer_load_dwordx4 v6, s[8:11], s60 offen lds
    v_mul_f32 v247, 0x3fb8aa3b, v247
    v_mul_f32 v248, 0x3e22f983, v248
    v_exp_f32 v246, v247
    v_mov_b32 v249, v248
    v_rndne_f32 v251, v249
    v_mfma_f32_32x32x16_bf16 v[176:191], a[236:239], v[68:71], v[176:191]
    buffer_load_dwordx4 v7, s[8:11], s60 offen offset:1024 lds
    v_sub_f32 v249, v249, v251
    v_cos_f32 v216, v249
    v_sin_f32 v217, v249
    s_nop 0
    v_mul_f32 v216, v246, v216
    s_waitcnt lgkmcnt(2)
    v_mfma_f32_32x32x16_bf16 v[96:111], a[240:243], v[40:43], v[96:111]
    ds_read_b128 v[60:63], v20 offset:0
    ds_read_b128 v[64:67], v20 offset:4096
    buffer_load_dwordx4 v8, s[8:11], s60 offen offset:2048 lds
    v_mul_f32 v217, v246, v217
    v_add_f32 v249, -1.0, v216
    v_mfma_f32_32x32x16_bf16 v[112:127], a[244:247], v[40:43], v[112:127]
    ds_read_b128 v[68:71], v20 offset:8192
    buffer_load_dwordx4 v9, s[8:11], s60 offen offset:3072 lds
    s_add_u32 s60, s60, 128
    v_add_f32 v250, v250, v250
    v_mul_f32 v218, v249, v244
    v_mul_f32 v219, v217, v244
    v_fmac_f32 v218, v217, v245
    s_waitcnt lgkmcnt(4)
    v_mfma_f32_32x32x16_bf16 v[128:143], a[240:243], v[44:47], v[128:143]
    v_fma_f32 v219, -v249, v245, v219
    v_mul_f32 v218, v218, v250
    v_mul_f32 v219, v219, v250
    v_mul_f32 v246, 0x41800000, v247
    v_mul_f32 v249, 0x41800000, v248
    v_mfma_f32_32x32x16_bf16 v[144:159], a[244:247], v[44:47], v[144:159]
    v_exp_f32 v246, v246
    v_rndne_f32 v251, v249
    v_sub_f32 v249, v249, v251
    v_cos_f32 v220, v249
    v_sin_f32 v221, v249
    s_nop 0
    s_waitcnt lgkmcnt(3)
    v_mfma_f32_32x32x16_bf16 v[160:175], a[240:243], v[48:51], v[160:175]
    v_mul_f32 v220, v246, v220
    v_mul_f32 v221, v246, v221
    v_mul_f32 v246, v252, v247
    v_mul_f32 v249, v252, v248
    v_exp_f32 v246, v246
    v_mfma_f32_32x32x16_bf16 v[176:191], a[244:247], v[48:51], v[176:191]
    v_rndne_f32 v251, v249
    v_sub_f32 v249, v249, v251
    v_cos_f32 v222, v249
    v_sin_f32 v223, v249
    s_nop 0
    v_mul_f32 v222, v246, v222
    s_waitcnt lgkmcnt(2)
    v_mfma_f32_32x32x16_bf16 v[96:111], a[248:251], v[60:63], v[96:111]
    s_waitcnt lgkmcnt(0)
    s_waitcnt vmcnt(16)
    s_waitcnt vmcnt(11)
    s_barrier
    v_readfirstlane_b32 s50, v92
    v_readfirstlane_b32 s51, v93
    s_nop 0
    s_cmp_lg_u64 s[50:51], 0
    s_cbranch_scc0 L_tagslow_40
L_tagok_41:
    ds_read_b128 a[192:195], v13 offset:0
    ds_read_b128 a[196:199], v13 offset:4096
    v_mov_b32 v36, s50
    v_mov_b32 v37, s51
    v_lshrrev_b32 v38, 4, v1
    v_mfma_f32_32x32x16_bf16 v[112:127], a[252:255], v[60:63], v[112:127]
    ds_read_b128 v[40:43], v17 offset:12288
    ds_read_b128 v[44:47], v17 offset:16384
    s_add_u32 m0, s59, 0
    s_nop 0
    buffer_load_dwordx4 v12, s[20:23], s60 offen lds
    v_lshlrev_b32 v38, 29, v38
    v_lshl_add_u32 v38, v1, 3, v38
    s_cmp_eq_u32 s4, 0
    s_cselect_b32 s3, s55, 2130706432
    v_or_b32 v38, s3, v38
    s_lshl_b32 s3, s48, 7
    s_add_u32 s3, s3, 22020096
    buffer_store_dwordx2 v[36:37], v38, s[32:35], s3 offen sc1
    v_mfma_f32_32x32x16_bf16 v[128:143], a[248:251], v[64:67], v[128:143]
    ds_read_b128 v[48:51], v17 offset:20480
    ds_read_b128 a[200:203], v14 offset:0
    v_lshrrev_b32 v38, 4, v1
    v_lshlrev_b32 v38, 29, v38
    v_lshl_add_u32 v38, v1, 3, v38
    s_mul_i32 s85, s4, 40960
    v_mfma_f32_32x32x16_bf16 v[144:159], a[252:255], v[64:67], v[144:159]
    ds_read_b128 a[204:207], v14 offset:4096
    s_add_u32 m0, s59, 4096
    s_nop 0
    buffer_load_dwordx4 v10, s[12:15], s60 offen lds
    s_mul_i32 s52, s49, 5120
    s_add_u32 s85, s85, s52
    v_lshlrev_b32 v23, 4, v1
    v_add_u32 v30, s85, v23
    v_mfma_f32_32x32x16_bf16 v[160:175], a[248:251], v[68:71], v[160:175]
    v_add_u32 v31, 4096, v30
    v_add_u32 v32, s63, v30
    v_add_u32 v33, s63, v31
    v_lshlrev_b32 v35, 3, v1
    v_lshl_add_u32 v35, s4, 9, v35
    v_add_u32 v35, 135168, v35
    v_mfma_f32_32x32x16_bf16 v[176:191], a[252:255], v[68:71], v[176:191]
    s_add_u32 m0, s59, 8192
    s_nop 0
    buffer_load_dwordx4 v11, s[20:23], s60 offen lds
    v_mov_b32 v28, 0
    v_mov_b32 v29, 0
    s_mov_b32 s53, 22020096
    ds_write_b64 v35, v[28:29] offset:0
    ds_write_b64 v35, v[28:29] offset:4096
    s_waitcnt lgkmcnt(7)
    s_waitcnt lgkmcnt(6)
    v_mfma_f32_32x32x16_bf16 v[96:111], a[192:195], v[40:43], v[96:111]
    ds_read_b128 v[60:63], v18 offset:12288
    ds_read_b128 v[64:67], v18 offset:16384
    ds_write_b64 v35, v[28:29] offset:8192
    s_lshl_b32 s3, s5, 2
    s_add_u32 s3, s3, s4
    s_lshl_b32 s3, s3, 5
    s_add_u32 s3, s3, s6
    v_mov_b32 v94, s3
    s_xor_b32 s3, s2, 4
    s_lshl_b32 s3, s3, 2
    s_add_u32 s3, s3, s4
    v_mov_b32 v95, s3
    v_cmp_gt_u32 s[98:99], 48, v1
    s_nop 1
    v_cndmask_b32 v94, v95, v94, s[98:99]
    v_lshrrev_b32 v95, 4, v1
    v_mfma_f32_32x32x16_bf16 v[112:127], a[196:199], v[40:43], v[112:127]
    ds_read_b128 v[68:71], v18 offset:20480
    ds_read_b128 a[208:211], v15 offset:0
    v_lshl_add_u32 v94, v95, 10, v94
    v_lshlrev_b32 v94, 7, v94
    v_and_b32 v95, 15, v1
    v_lshl_add_u32 v94, v95, 3, v94
    s_waitcnt lgkmcnt(10)
    v_mfma_f32_32x32x16_bf16 v[128:143], a[192:195], v[44:47], v[128:143]
    ds_read_b128 a[212:215], v15 offset:4096
    ds_read_b128 a[216:219], v16 offset:0
    s_mov_b32 s3, 22052864
    buffer_store_dwordx2 v[28:29], v94, s[32:35], s3 offen sc1
    s_cmp_eq_u32 s4, 3
    s_cselect_b32 s3, 0, 2130706432
    v_lshrrev_b32 v94, 5, v1
    v_lshlrev_b32 v94, 29, v94
    v_lshl_add_u32 v94, v1, 3, v94
    v_or_b32 v94, s3, v94
    s_lshl_b32 s3, s54, 3
    s_add_u32 s3, s3, s5
    s_lshl_b32 s3, s3, 8
    s_add_u32 s3, s3, 16515072
    buffer_store_dwordx2 v[28:29], v94, s[32:35], s3 offen sc1
    v_mfma_f32_32x32x16_bf16 v[144:159], a[196:199], v[44:47], v[144:159]
    ds_read_b128 a[220:223], v16 offset:4096
    s_lshl_b32 s3, s54, 3
    s_add_u32 s3, s3, s5
    s_lshl_b32 s3, s3, 8
    s_add_u32 s3, s3, 16517120
    buffer_store_dwordx2 v[28:29], v94, s[32:35], s3 offen sc1
    s_lshl_b32 s3, s54, 3
    s_add_u32 s3, s3, s5
    s_lshl_b32 s3, s3, 8
    s_add_u32 s3, s3, 16519168
    buffer_store_dwordx2 v[28:29], v94, s[32:35], s3 offen sc1
    s_cmp_eq_u32 s6, 31
    s_cselect_b32 s3, 0, 2130706432
    v_lshlrev_b32 v94, 2, v1
    v_or_b32 v94, s3, v94
    s_lshl_b32 s3, s5, 2
    s_add_u32 s3, s3, s4
    s_lshl_b32 s3, s3, 8
    s_add_u32 s3, s3, 16613376
    buffer_store_dword v28, v94, s[32:35], s3 offen sc1
    v_mul_f32 v223, v246, v223
    v_mul_f32 v246, v253, v247
    s_waitcnt lgkmcnt(12)
    v_mfma_f32_32x32x16_bf16 v[160:175], a[192:195], v[48:51], v[160:175]
    v_mul_f32 v249, v253, v248
    v_exp_f32 v246, v246
    v_rndne_f32 v251, v249
    v_cmp_le_f32 vcc, 0, v253
    v_sub_f32 v249, v249, v251
    v_mfma_f32_32x32x16_bf16 v[176:191], a[196:199], v[48:51], v[176:191]
    v_cos_f32 v224, v249
    v_sin_f32 v225, v249
    v_cndmask_b32 v246, 0, v246, vcc
    v_mul_f32 v224, v246, v224
    v_mul_f32 v225, v246, v225
    v_mul_f32 v246, v254, v247
    s_waitcnt lgkmcnt(10)
    s_waitcnt lgkmcnt(7)
    v_mfma_f32_32x32x16_bf16 v[96:111], a[200:203], v[60:63], v[96:111]
    ds_read_b128 v[40:43], v19 offset:12288
    ds_read_b128 v[44:47], v19 offset:16384
    s_waitcnt lgkmcnt(2)
    s_add_u32 m0, s57, 0
    s_nop 0
    buffer_load_dwordx4 v2, s[8:11], s60 offen lds
    v_mul_f32 v249, v254, v248
    v_exp_f32 v246, v246
    v_mfma_f32_32x32x16_bf16 v[112:127], a[204:207], v[60:63], v[112:127]
    ds_read_b128 v[48:51], v19 offset:20480
    buffer_load_dwordx4 v3, s[8:11], s60 offen offset:1024 lds
    v_rndne_f32 v251, v249
    v_cmp_le_f32 vcc, 0, v254
    v_sub_f32 v249, v249, v251
    v_cos_f32 v226, v249
    v_mfma_f32_32x32x16_bf16 v[128:143], a[200:203], v[64:67], v[128:143]
    buffer_load_dwordx4 v4, s[8:11], s60 offen offset:2048 lds
    v_sin_f32 v227, v249
    v_cndmask_b32 v246, 0, v246, vcc
    v_mul_f32 v226, v246, v226
    v_mul_f32 v227, v246, v227
    v_mfma_f32_32x32x16_bf16 v[144:159], a[204:207], v[64:67], v[144:159]
    buffer_load_dwordx4 v5, s[8:11], s60 offen offset:3072 lds
    v_mfma_f32_32x32x16_bf16 v[160:175], a[200:203], v[68:71], v[160:175]
    s_add_u32 m0, s57, 4096
    s_nop 0
    buffer_load_dwordx4 v6, s[8:11], s60 offen lds
    v_mfma_f32_32x32x16_bf16 v[176:191], a[204:207], v[68:71], v[176:191]
    buffer_load_dwordx4 v7, s[8:11], s60 offen offset:1024 lds
    s_waitcnt lgkmcnt(2)
    v_mfma_f32_32x32x16_bf16 v[96:111], a[208:211], v[40:43], v[96:111]
    ds_read_b128 v[60:63], v20 offset:12288
    ds_read_b128 v[64:67], v20 offset:16384
    buffer_load_dwordx4 v8, s[8:11], s60 offen offset:2048 lds
    v_mfma_f32_32x32x16_bf16 v[112:127], a[212:215], v[40:43], v[112:127]
    ds_read_b128 v[68:71], v20 offset:20480
    buffer_load_dwordx4 v9, s[8:11], s60 offen offset:3072 lds
    s_add_u32 s60, s60, 128
    s_waitcnt lgkmcnt(4)
    v_mfma_f32_32x32x16_bf16 v[128:143], a[208:211], v[44:47], v[128:143]
    v_mfma_f32_32x32x16_bf16 v[144:159], a[212:215], v[44:47], v[144:159]
    s_waitcnt lgkmcnt(3)
    v_mfma_f32_32x32x16_bf16 v[160:175], a[208:211], v[48:51], v[160:175]
    v_mfma_f32_32x32x16_bf16 v[176:191], a[212:215], v[48:51], v[176:191]
    s_waitcnt lgkmcnt(2)
    v_mfma_f32_32x32x16_bf16 v[96:111], a[216:219], v[60:63], v[96:111]
    s_waitcnt lgkmcnt(0)
    s_waitcnt vmcnt(17)
    s_barrier
    ds_read_b128 a[224:227], v13 offset:8192
    ds_read_b128 a[228:231], v13 offset:12288
    v_bfe_u32 v24, v1, 4, 1
    v_lshlrev_b32 v24, 5, v24
    v_lshrrev_b32 v25, 5, v1
    v_mfma_f32_32x32x16_bf16 v[112:127], a[220:223], v[60:63], v[112:127]
    ds_read_b128 v[40:43], v17 offset:24576
    ds_read_b128 v[44:47], v17 offset:28672
    s_add_u32 m0, s59, 12288
    s_nop 0
    buffer_load_dwordx4 v12, s[20:23], s60 offen lds
    v_lshl_add_u32 v24, v25, 2, v24
    v_bfe_u32 v25, v1, 2, 2
    v_add_u32 v24, v24, v25
    v_mfma_f32_32x32x16_bf16 v[128:143], a[216:219], v[64:67], v[128:143]
    ds_read_b128 v[48:51], v17 offset:32768
    ds_read_b128 a[232:235], v14 offset:8192
    s_lshl_b32 s3, s82, 6
    s_lshl_b32 s7, s4, 3
    s_add_u32 s3, s3, s7
    v_add_u32 v24, s3, v24
    v_and_b32 v25, 3, v1
    v_mul_u32_u24 v24, 1280, v24
    v_lshl_add_u32 v24, v25, 3, v24
    v_mfma_f32_32x32x16_bf16 v[144:159], a[220:223], v[64:67], v[144:159]
    ds_read_b128 a[236:239], v14 offset:12288
    s_add_u32 m0, s59, 16384
    s_nop 0
    buffer_load_dwordx4 v10, s[12:15], s60 offen lds
    s_mul_i32 s3, s49, 160
    v_add_u32 v72, s3, v24
    s_mul_i32 s3, s49, 5
    s_lshr_b32 s3, s3, 2
    s_mul_i32 s3, s3, 14
    s_mul_i32 s7, s49, 14
    s_add_u32 s7, s7, 112
    v_mov_b32 v24, s3
    v_mov_b32 v25, s7
    s_mul_i32 s3, s4, 11
    v_min_u32 v73, 10, v1
    v_add_u32 v73, s3, v73
    v_min_u32 v73, 41, v73
    v_cmp_gt_u32 s[98:99], 28, v73
    s_nop 1
    v_cndmask_b32 v24, v25, v24, s[98:99]
    v_add_lshl_u32 v73, v73, v24, 7
    v_cmp_lt_u32 vcc, 9, v1
    v_add_u32 v28, -10, v1
    s_xor_b32 s3, s82, 1
    v_cndmask_b32 v28, v1, v28, vcc
    v_mov_b32 v29, s3
    v_mov_b32 v27, s82
    v_cndmask_b32 v29, v29, v27, vcc
    v_mfma_f32_32x32x16_bf16 v[160:175], a[216:219], v[68:71], v[160:175]
    s_cmp_eq_u32 s83, 0
    s_cselect_b32 s3, 14, 0
    s_add_u32 s3, s3, s4
    v_lshl_add_u32 v28, v28, 2, s3
    v_add_u32 v27, -27, v28
    v_mul_u32_u24 v26, 43, v27
    v_lshrrev_b32 v26, 7, v26
    v_add_u32 v26, 27, v26
    s_cmp_eq_u32 s83, 0
    s_cselect_b64 vcc, -1, 0
    v_cndmask_b32 v27, v26, v27, vcc
    v_mfma_f32_32x32x16_bf16 v[176:191], a[220:223], v[68:71], v[176:191]
    s_add_u32 m0, s59, 20480
    s_nop 0
    buffer_load_dwordx4 v11, s[20:23], s60 offen lds
    v_add_u32 v27, 2048, v27
    s_lshl_b32 s3, s83, 10
    v_add_u32 v26, s3, v28
    v_cmp_gt_u32 vcc, 27, v28
    s_nop 1
    v_cndmask_b32 v27, v27, v26, vcc
    v_cmp_gt_u32 vcc, 20, v1
    v_mov_b32 v26, 2079
    s_nop 0
    v_cndmask_b32 v27, v26, v27, vcc
    v_lshl_add_u32 v29, v29, 5, v27
    v_lshlrev_b32 v29, 7, v29
    s_waitcnt lgkmcnt(5)
    s_waitcnt lgkmcnt(4)
    v_mfma_f32_32x32x16_bf16 v[96:111], a[224:227], v[40:43], v[96:111]
    ds_read_b128 v[60:63], v18 offset:24576
    ds_read_b128 v[64:67], v18 offset:28672
    v_and_b32 v34, 15, v1
    v_lshlrev_b32 v34, 4, v34
    s_lshl_b32 s55, s54, 11
    v_mfma_f32_32x32x16_bf16 v[112:127], a[228:231], v[40:43], v[112:127]
    ds_read_b128 v[68:71], v18 offset:32768
    ds_read_b128 a[240:243], v15 offset:8192
    s_add_u32 s55, s55, 16515072
    s_lshl_b32 s62, s5, 8
    s_add_u32 s62, s62, s55
    s_add_u32 s58, s55, 4096
    s_waitcnt lgkmcnt(7)
    v_mfma_f32_32x32x16_bf16 v[128:143], a[224:227], v[44:47], v[128:143]
    ds_read_b128 a[244:247], v15 offset:12288
    ds_read_b128 a[248:251], v16 offset:8192
    v_mov_b32 v27, 2130706432
    s_cmp_eq_u32 s4, 3
    s_cselect_b32 s3, 48, 64
    v_cmp_le_u32 vcc, s3, v1
    v_lshrrev_b32 v26, 4, v1
    s_nop 0
    v_cndmask_b32 v39, v27, v34, vcc
    v_lshl_add_u32 v24, v26, 8, v34
    v_mfma_f32_32x32x16_bf16 v[144:159], a[228:231], v[44:47], v[144:159]
    ds_read_b128 a[252:255], v16 offset:12288
    v_add_u32 v25, 1024, v24
    v_cmp_le_u32 s[84:85], s5, v26
    v_add_u32 v26, 4, v26
    v_cmp_le_u32 s[86:87], s5, v26
    s_lshl_b32 s90, s5, 2
    s_waitcnt lgkmcnt(9)
    v_mfma_f32_32x32x16_bf16 v[160:175], a[224:227], v[48:51], v[160:175]
    s_add_u32 s90, s90, s4
    v_cndmask_b32 v24, v24, v27, s[84:85]
    v_cndmask_b32 v25, v25, v27, s[86:87]
    s_lshl_b32 s91, s90, 5
    s_add_u32 s91, s91, s6
    v_mfma_f32_32x32x16_bf16 v[176:191], a[228:231], v[48:51], v[176:191]
    s_lshl_b32 s91, s91, 7
    s_mul_i32 s93, s90, 221184
    s_lshl_b32 s92, s6, 12
    s_add_u32 s93, s93, s92
    s_add_u32 s92, s93, 110592
    s_mov_b32 s89, 0xbfb8aa3b
    s_waitcnt lgkmcnt(7)
    s_waitcnt lgkmcnt(6)
    v_mfma_f32_32x32x16_bf16 v[96:111], a[232:235], v[60:63], v[96:111]
    ds_read_b128 v[40:43], v19 offset:24576
    ds_read_b128 v[44:47], v19 offset:28672
    s_waitcnt lgkmcnt(2)
    s_add_u32 m0, s57, 8192
    s_nop 0
    buffer_load_dwordx4 v2, s[8:11], s60 offen lds
    s_mul_i32 s90, s90, 163840
    s_lshl_b32 s94, s54, 12
    v_mfma_f32_32x32x16_bf16 v[112:127], a[236:239], v[60:63], v[112:127]
    ds_read_b128 v[48:51], v19 offset:32768
    buffer_load_dwordx4 v3, s[8:11], s60 offen offset:1024 lds
    s_add_u32 s90, s90, s94
    s_add_u32 s90, s90, 7340032
    v_bfe_u32 v28, v1, 4, 1
    v_lshlrev_b32 v28, 10, v28
    v_mfma_f32_32x32x16_bf16 v[128:143], a[232:235], v[64:67], v[128:143]
    buffer_load_dwordx4 v4, s[8:11], s60 offen offset:2048 lds
    v_lshrrev_b32 v26, 5, v1
    v_lshl_add_u32 v28, v26, 8, v28
    v_add_u32 v28, v28, v34
    s_add_u32 s94, s57, 5120
    v_and_b32 v94, 15, v1
    v_mfma_f32_32x32x16_bf16 v[144:159], a[236:239], v[64:67], v[144:159]
    buffer_load_dwordx4 v5, s[8:11], s60 offen offset:3072 lds
    v_mul_u32_u24 v94, 144, v94
    v_lshrrev_b32 v95, 4, v1
    v_lshl_add_u32 v94, v95, 5, v94
    v_add_u32 v94, s94, v94
    v_lshlrev_b32 v95, 3, v95
    v_mfma_f32_32x32x16_bf16 v[160:175], a[232:235], v[68:71], v[160:175]
    s_add_u32 m0, s57, 12288
    s_nop 0
    buffer_load_dwordx4 v6, s[8:11], s60 offen lds
    v_bfe_u32 v26, v1, 2, 2
    v_add_u32 v95, v95, v26
    v_mul_u32_u24 v95, 144, v95
    v_and_b32 v26, 1, v1
    v_lshl_add_u32 v95, v26, 6, v95
    v_mfma_f32_32x32x16_bf16 v[176:191], a[236:239], v[68:71], v[176:191]
    buffer_load_dwordx4 v7, s[8:11], s60 offen offset:1024 lds
    v_bfe_u32 v26, v1, 1, 1
    v_lshl_add_u32 v95, v26, 3, v95
    v_add_u32 v95, s94, v95
    s_cmp_eq_u32 s83, 0
    s_cselect_b32 s3, 54, 40
    s_mov_b32 s7, 7340032
    s_cmov_b32 s7, 57344
    s_lshl_b32 s3, s3, 12
    s_mul_i32 s79, s82, s3
    s_add_u32 s79, s79, s7
    s_xor_b32 s78, s82, 1
    s_mul_i32 s78, s78, s3
    s_add_u32 s78, s78, s7
    s_add_u32 s3, s4, 1
    s_and_b32 s24, s3, 3
    s_lshl_b32 s3, s24, 10
    s_mul_i32 s7, s82, 221184
    s_add_u32 s66, s7, s3
    s_add_u32 s70, s78, s3
    s_add_u32 s74, s79, s3
    s_waitcnt lgkmcnt(2)
    v_mfma_f32_32x32x16_bf16 v[96:111], a[240:243], v[40:43], v[96:111]
    ds_read_b128 v[60:63], v20 offset:24576
    ds_read_b128 v[64:67], v20 offset:28672
    buffer_load_dwordx4 v8, s[8:11], s60 offen offset:2048 lds
    s_add_u32 s3, s4, 2
    s_and_b32 s25, s3, 3
    s_lshl_b32 s3, s25, 10
    s_mul_i32 s7, s82, 221184
    s_add_u32 s67, s7, s3
    s_add_u32 s71, s78, s3
    s_add_u32 s75, s79, s3
    s_add_u32 s3, s4, 3
    s_and_b32 s26, s3, 3
    s_lshl_b32 s3, s26, 10
    s_mul_i32 s7, s82, 221184
    s_add_u32 s68, s7, s3
    s_add_u32 s72, s78, s3
    s_add_u32 s76, s79, s3
    v_mfma_f32_32x32x16_bf16 v[112:127], a[244:247], v[40:43], v[112:127]
    ds_read_b128 v[68:71], v20 offset:32768
    buffer_load_dwordx4 v9, s[8:11], s60 offen offset:3072 lds
    s_add_u32 s60, s60, 128
    s_add_u32 s3, s4, 4
    s_and_b32 s27, s3, 3
    s_lshl_b32 s3, s27, 10
    s_mul_i32 s7, s82, 221184
    s_add_u32 s69, s7, s3
    s_add_u32 s73, s78, s3
    s_add_u32 s77, s79, s3
    s_waitcnt lgkmcnt(4)
    v_mfma_f32_32x32x16_bf16 v[128:143], a[240:243], v[44:47], v[128:143]
    v_mfma_f32_32x32x16_bf16 v[144:159], a[244:247], v[44:47], v[144:159]
    s_waitcnt lgkmcnt(3)
    v_mfma_f32_32x32x16_bf16 v[160:175], a[240:243], v[48:51], v[160:175]
    v_mfma_f32_32x32x16_bf16 v[176:191], a[244:247], v[48:51], v[176:191]
    s_waitcnt lgkmcnt(2)
    v_mfma_f32_32x32x16_bf16 v[96:111], a[248:251], v[60:63], v[96:111]
    s_waitcnt lgkmcnt(0)
    s_waitcnt vmcnt(11)
    s_barrier
    ds_read_b128 a[192:195], v13 offset:0
    ds_read_b128 a[196:199], v13 offset:4096
    v_mfma_f32_32x32x16_bf16 v[112:127], a[252:255], v[60:63], v[112:127]
    ds_read_b128 v[40:43], v17 offset:0
    ds_read_b128 v[44:47], v17 offset:4096
    s_add_u32 m0, s59, 24576
    s_nop 0
    buffer_load_dwordx4 v12, s[20:23], s60 offen lds
    v_mfma_f32_32x32x16_bf16 v[128:143], a[248:251], v[64:67], v[128:143]
    ds_read_b128 v[48:51], v17 offset:8192
    ds_read_b128 a[200:203], v14 offset:0
    v_mfma_f32_32x32x16_bf16 v[144:159], a[252:255], v[64:67], v[144:159]
    ds_read_b128 a[204:207], v14 offset:4096
    s_add_u32 m0, s59, 28672
    s_nop 0
    buffer_load_dwordx4 v10, s[12:15], s60 offen lds
    v_mfma_f32_32x32x16_bf16 v[160:175], a[248:251], v[68:71], v[160:175]
    v_mfma_f32_32x32x16_bf16 v[176:191], a[252:255], v[68:71], v[176:191]
    s_add_u32 m0, s59, 32768
    s_nop 0
    buffer_load_dwordx4 v11, s[20:23], s60 offen lds
    s_waitcnt lgkmcnt(5)
    s_waitcnt lgkmcnt(4)
    v_mfma_f32_32x32x16_bf16 v[96:111], a[192:195], v[40:43], v[96:111]
    ds_read_b128 v[60:63], v18 offset:0
    ds_read_b128 v[64:67], v18 offset:4096
    v_mfma_f32_32x32x16_bf16 v[112:127], a[196:199], v[40:43], v[112:127]
    ds_read_b128 v[68:71], v18 offset:8192
    ds_read_b128 a[208:211], v15 offset:0
    s_waitcnt lgkmcnt(7)
    v_mfma_f32_32x32x16_bf16 v[128:143], a[192:195], v[44:47], v[128:143]
    ds_read_b128 a[212:215], v15 offset:4096
    ds_read_b128 a[216:219], v16 offset:0
    v_mfma_f32_32x32x16_bf16 v[144:159], a[196:199], v[44:47], v[144:159]
    ds_read_b128 a[220:223], v16 offset:4096
    s_waitcnt lgkmcnt(9)
    v_mfma_f32_32x32x16_bf16 v[160:175], a[192:195], v[48:51], v[160:175]
    v_mfma_f32_32x32x16_bf16 v[176:191], a[196:199], v[48:51], v[176:191]
    s_waitcnt lgkmcnt(7)
    s_waitcnt lgkmcnt(6)
    v_mfma_f32_32x32x16_bf16 v[96:111], a[200:203], v[60:63], v[96:111]
    ds_read_b128 v[40:43], v19 offset:0
    ds_read_b128 v[44:47], v19 offset:4096
    s_waitcnt lgkmcnt(2)
    s_add_u32 m0, s57, 0
    s_nop 0
    buffer_load_dwordx4 v2, s[8:11], s60 offen lds
    v_mfma_f32_32x32x16_bf16 v[112:127], a[204:207], v[60:63], v[112:127]
    ds_read_b128 v[48:51], v19 offset:8192
    buffer_load_dwordx4 v3, s[8:11], s60 offen offset:1024 lds
    v_mfma_f32_32x32x16_bf16 v[128:143], a[200:203], v[64:67], v[128:143]
    buffer_load_dwordx4 v4, s[8:11], s60 offen offset:2048 lds
    v_mfma_f32_32x32x16_bf16 v[144:159], a[204:207], v[64:67], v[144:159]
    buffer_load_dwordx4 v5, s[8:11], s60 offen offset:3072 lds
    v_mfma_f32_32x32x16_bf16 v[160:175], a[200:203], v[68:71], v[160:175]
    s_add_u32 m0, s57, 4096
    s_nop 0
    buffer_load_dwordx4 v6, s[8:11], s60 offen lds
    v_mfma_f32_32x32x16_bf16 v[176:191], a[204:207], v[68:71], v[176:191]
    buffer_load_dwordx4 v7, s[8:11], s60 offen offset:1024 lds
    s_waitcnt lgkmcnt(2)
    v_mfma_f32_32x32x16_bf16 v[96:111], a[208:211], v[40:43], v[96:111]
    ds_read_b128 v[60:63], v20 offset:0
    ds_read_b128 v[64:67], v20 offset:4096
    buffer_load_dwordx4 v8, s[8:11], s60 offen offset:2048 lds
    v_mfma_f32_32x32x16_bf16 v[112:127], a[212:215], v[40:43], v[112:127]
    ds_read_b128 v[68:71], v20 offset:8192
    buffer_load_dwordx4 v9, s[8:11], s60 offen offset:3072 lds
    s_add_u32 s60, s60, 128
    s_waitcnt lgkmcnt(4)
    v_mfma_f32_32x32x16_bf16 v[128:143], a[208:211], v[44:47], v[128:143]
    v_mfma_f32_32x32x16_bf16 v[144:159], a[212:215], v[44:47], v[144:159]
    s_waitcnt lgkmcnt(3)
    v_mfma_f32_32x32x16_bf16 v[160:175], a[208:211], v[48:51], v[160:175]
    v_mfma_f32_32x32x16_bf16 v[176:191], a[212:215], v[48:51], v[176:191]
    s_waitcnt lgkmcnt(2)
    v_mfma_f32_32x32x16_bf16 v[96:111], a[216:219], v[60:63], v[96:111]
    s_waitcnt lgkmcnt(0)
    s_waitcnt vmcnt(11)
    s_barrier
    ds_read_b128 a[224:227], v13 offset:8192
    ds_read_b128 a[228:231], v13 offset:12288
    v_mfma_f32_32x32x16_bf16 v[112:127], a[220:223], v[60:63], v[112:127]
    ds_read_b128 v[40:43], v17 offset:12288
    ds_read_b128 v[44:47], v17 offset:16384
    s_add_u32 m0, s59, 0
    s_nop 0
    buffer_load_dwordx4 v12, s[20:23], s60 offen lds
    v_mfma_f32_32x32x16_bf16 v[128:143], a[216:219], v[64:67], v[128:143]
    ds_read_b128 v[48:51], v17 offset:20480
    ds_read_b128 a[232:235], v14 offset:8192
    v_mfma_f32_32x32x16_bf16 v[144:159], a[220:223], v[64:67], v[144:159]
    ds_read_b128 a[236:239], v14 offset:12288
    s_add_u32 m0, s59, 4096
    s_nop 0
    buffer_load_dwordx4 v10, s[12:15], s60 offen lds
    v_mfma_f32_32x32x16_bf16 v[160:175], a[216:219], v[68:71], v[160:175]
    v_mfma_f32_32x32x16_bf16 v[176:191], a[220:223], v[68:71], v[176:191]
    s_add_u32 m0, s59, 8192
    s_nop 0
    buffer_load_dwordx4 v11, s[20:23], s60 offen lds
    s_waitcnt lgkmcnt(5)
    s_waitcnt lgkmcnt(4)
    v_mfma_f32_32x32x16_bf16 v[96:111], a[224:227], v[40:43], v[96:111]
    ds_read_b128 v[60:63], v18 offset:12288
    ds_read_b128 v[64:67], v18 offset:16384
    v_mfma_f32_32x32x16_bf16 v[112:127], a[228:231], v[40:43], v[112:127]
    ds_read_b128 v[68:71], v18 offset:20480
    ds_read_b128 a[240:243], v15 offset:8192
    s_waitcnt lgkmcnt(7)
    v_mfma_f32_32x32x16_bf16 v[128:143], a[224:227], v[44:47], v[128:143]
    ds_read_b128 a[244:247], v15 offset:12288
    ds_read_b128 a[248:251], v16 offset:8192
    v_mfma_f32_32x32x16_bf16 v[144:159], a[228:231], v[44:47], v[144:159]
    ds_read_b128 a[252:255], v16 offset:12288
    s_waitcnt lgkmcnt(9)
    v_mfma_f32_32x32x16_bf16 v[160:175], a[224:227], v[48:51], v[160:175]
    v_mfma_f32_32x32x16_bf16 v[176:191], a[228:231], v[48:51], v[176:191]
    s_waitcnt lgkmcnt(7)
    s_waitcnt lgkmcnt(6)
    v_mfma_f32_32x32x16_bf16 v[96:111], a[232:235], v[60:63], v[96:111]
    ds_read_b128 v[40:43], v19 offset:12288
    ds_read_b128 v[44:47], v19 offset:16384
    s_waitcnt lgkmcnt(2)
    s_add_u32 m0, s57, 8192
    s_nop 0
    buffer_load_dwordx4 v2, s[8:11], s60 offen lds
    v_mfma_f32_32x32x16_bf16 v[112:127], a[236:239], v[60:63], v[112:127]
    ds_read_b128 v[48:51], v19 offset:20480
    buffer_load_dwordx4 v3, s[8:11], s60 offen offset:1024 lds
    v_mfma_f32_32x32x16_bf16 v[128:143], a[232:235], v[64:67], v[128:143]
    buffer_load_dwordx4 v4, s[8:11], s60 offen offset:2048 lds
    v_mfma_f32_32x32x16_bf16 v[144:159], a[236:239], v[64:67], v[144:159]
    buffer_load_dwordx4 v5, s[8:11], s60 offen offset:3072 lds
    v_mfma_f32_32x32x16_bf16 v[160:175], a[232:235], v[68:71], v[160:175]
    s_add_u32 m0, s57, 12288
    s_nop 0
    buffer_load_dwordx4 v6, s[8:11], s60 offen lds
    v_mfma_f32_32x32x16_bf16 v[176:191], a[236:239], v[68:71], v[176:191]
    buffer_load_dwordx4 v7, s[8:11], s60 offen offset:1024 lds
    s_waitcnt lgkmcnt(2)
    v_mfma_f32_32x32x16_bf16 v[96:111], a[240:243], v[40:43], v[96:111]
    ds_read_b128 v[60:63], v20 offset:12288
    ds_read_b128 v[64:67], v20 offset:16384
    buffer_load_dwordx4 v8, s[8:11], s60 offen offset:2048 lds
    v_mfma_f32_32x32x16_bf16 v[112:127], a[244:247], v[40:43], v[112:127]
    ds_read_b128 v[68:71], v20 offset:20480
    buffer_load_dwordx4 v9, s[8:11], s60 offen offset:3072 lds
    s_add_u32 s60, s60, 128
    s_waitcnt lgkmcnt(4)
    v_mfma_f32_32x32x16_bf16 v[128:143], a[240:243], v[44:47], v[128:143]
    v_mfma_f32_32x32x16_bf16 v[144:159], a[244:247], v[44:47], v[144:159]
    s_waitcnt lgkmcnt(3)
    v_mfma_f32_32x32x16_bf16 v[160:175], a[240:243], v[48:51], v[160:175]
    v_mfma_f32_32x32x16_bf16 v[176:191], a[244:247], v[48:51], v[176:191]
    s_waitcnt lgkmcnt(2)
    v_mfma_f32_32x32x16_bf16 v[96:111], a[248:251], v[60:63], v[96:111]
    s_waitcnt lgkmcnt(0)
    s_waitcnt vmcnt(11)
    s_barrier
    ds_read_b128 a[192:195], v13 offset:0
    ds_read_b128 a[196:199], v13 offset:4096
    v_mfma_f32_32x32x16_bf16 v[112:127], a[252:255], v[60:63], v[112:127]
    ds_read_b128 v[40:43], v17 offset:24576
    ds_read_b128 v[44:47], v17 offset:28672
    s_mov_b64 exec, 0x7ff
    buffer_load_dwordx2 v[92:93], v73, s[32:35], s53 offen sc1
    s_mov_b64 exec, -1
    v_mfma_f32_32x32x16_bf16 v[128:143], a[248:251], v[64:67], v[128:143]
    ds_read_b128 v[48:51], v17 offset:32768
    ds_read_b128 a[200:203], v14 offset:0
    v_mfma_f32_32x32x16_bf16 v[144:159], a[252:255], v[64:67], v[144:159]
    ds_read_b128 a[204:207], v14 offset:4096
    v_mfma_f32_32x32x16_bf16 v[160:175], a[248:251], v[68:71], v[160:175]
    v_mfma_f32_32x32x16_bf16 v[176:191], a[252:255], v[68:71], v[176:191]
    s_waitcnt lgkmcnt(5)
    s_waitcnt lgkmcnt(4)
    v_mfma_f32_32x32x16_bf16 v[96:111], a[192:195], v[40:43], v[96:111]
    ds_read_b128 v[60:63], v18 offset:24576
    ds_read_b128 v[64:67], v18 offset:28672
    v_mfma_f32_32x32x16_bf16 v[112:127], a[196:199], v[40:43], v[112:127]
    ds_read_b128 v[68:71], v18 offset:32768
    ds_read_b128 a[208:211], v15 offset:0
    s_waitcnt lgkmcnt(7)
    v_mfma_f32_32x32x16_bf16 v[128:143], a[192:195], v[44:47], v[128:143]
    ds_read_b128 a[212:215], v15 offset:4096
    ds_read_b128 a[216:219], v16 offset:0
    v_mfma_f32_32x32x16_bf16 v[144:159], a[196:199], v[44:47], v[144:159]
    ds_read_b128 a[220:223], v16 offset:4096
    s_waitcnt lgkmcnt(9)
    v_mfma_f32_32x32x16_bf16 v[160:175], a[192:195], v[48:51], v[160:175]
    v_mfma_f32_32x32x16_bf16 v[176:191], a[196:199], v[48:51], v[176:191]
    s_waitcnt lgkmcnt(7)
    s_waitcnt lgkmcnt(6)
    v_mfma_f32_32x32x16_bf16 v[96:111], a[200:203], v[60:63], v[96:111]
    ds_read_b128 v[40:43], v19 offset:24576
    ds_read_b128 v[44:47], v19 offset:28672
    v_mfma_f32_32x32x16_bf16 v[112:127], a[204:207], v[60:63], v[112:127]
    ds_read_b128 v[48:51], v19 offset:32768
    s_waitcnt lgkmcnt(3)
    v_mfma_f32_32x32x16_bf16 v[128:143], a[200:203], v[64:67], v[128:143]
    v_mfma_f32_32x32x16_bf16 v[144:159], a[204:207], v[64:67], v[144:159]
    v_mfma_f32_32x32x16_bf16 v[160:175], a[200:203], v[68:71], v[160:175]
    v_mfma_f32_32x32x16_bf16 v[176:191], a[204:207], v[68:71], v[176:191]
    s_waitcnt lgkmcnt(2)
    v_mfma_f32_32x32x16_bf16 v[96:111], a[208:211], v[40:43], v[96:111]
    ds_read_b128 v[60:63], v20 offset:24576
    ds_read_b128 v[64:67], v20 offset:28672
    v_mfma_f32_32x32x16_bf16 v[112:127], a[212:215], v[40:43], v[112:127]
    ds_read_b128 v[68:71], v20 offset:32768
    s_waitcnt lgkmcnt(4)
    v_mfma_f32_32x32x16_bf16 v[128:143], a[208:211], v[44:47], v[128:143]
    v_mfma_f32_32x32x16_bf16 v[144:159], a[212:215], v[44:47], v[144:159]
    s_waitcnt lgkmcnt(3)
    v_mfma_f32_32x32x16_bf16 v[160:175], a[208:211], v[48:51], v[160:175]
    v_mfma_f32_32x32x16_bf16 v[176:191], a[212:215], v[48:51], v[176:191]
    s_waitcnt lgkmcnt(2)
    v_mfma_f32_32x32x16_bf16 v[96:111], a[216:219], v[60:63], v[96:111]
    s_waitcnt lgkmcnt(0)
    s_waitcnt vmcnt(1)
    s_waitcnt vmcnt(0)
    v_cmp_eq_u64 vcc, s[50:51], v[92:93]
    s_nop 0
    s_and_b32 s3, vcc_lo, 0x7ff
    s_cmp_eq_u32 s3, 0x7ff
    s_cbranch_scc0 L_prslow_43
L_prok_44:
    s_barrier
    ds_read_b128 a[224:227], v13 offset:8192
    ds_read_b128 a[228:231], v13 offset:12288
    v_mfma_f32_32x32x16_bf16 v[112:127], a[220:223], v[60:63], v[112:127]
    ds_read_b128 v[40:43], v17 offset:0
    ds_read_b128 v[44:47], v17 offset:4096
    buffer_load_dwordx2 v[80:81], v72, s[8:11], 0 offen offset:0
    v_mfma_f32_32x32x16_bf16 v[128:143], a[216:219], v[64:67], v[128:143]
    ds_read_b128 v[48:51], v17 offset:8192
    ds_read_b128 a[232:235], v14 offset:8192
    v_mfma_f32_32x32x16_bf16 v[144:159], a[220:223], v[64:67], v[144:159]
    ds_read_b128 a[236:239], v14 offset:12288
    buffer_load_dwordx2 v[82:83], v72, s[8:11], 0 offen offset:32
    v_mfma_f32_32x32x16_bf16 v[160:175], a[216:219], v[68:71], v[160:175]
    v_mfma_f32_32x32x16_bf16 v[176:191], a[220:223], v[68:71], v[176:191]
    buffer_load_dwordx2 v[84:85], v72, s[8:11], 0 offen offset:64
    s_waitcnt lgkmcnt(5)
    s_waitcnt lgkmcnt(4)
    v_mfma_f32_32x32x16_bf16 v[96:111], a[224:227], v[40:43], v[96:111]
    ds_read_b128 v[60:63], v18 offset:0
    ds_read_b128 v[64:67], v18 offset:4096
    v_mfma_f32_32x32x16_bf16 v[112:127], a[228:231], v[40:43], v[112:127]
    ds_read_b128 v[68:71], v18 offset:8192
    ds_read_b128 a[240:243], v15 offset:8192
    buffer_load_dwordx2 v[86:87], v72, s[8:11], 0 offen offset:96
    s_waitcnt lgkmcnt(7)
    v_mfma_f32_32x32x16_bf16 v[128:143], a[224:227], v[44:47], v[128:143]
    ds_read_b128 a[244:247], v15 offset:12288
    ds_read_b128 a[248:251], v16 offset:8192
    v_mfma_f32_32x32x16_bf16 v[144:159], a[228:231], v[44:47], v[144:159]
    ds_read_b128 a[252:255], v16 offset:12288
    buffer_load_dwordx2 v[88:89], v72, s[8:11], 0 offen offset:128
    s_waitcnt lgkmcnt(9)
    v_mfma_f32_32x32x16_bf16 v[160:175], a[224:227], v[48:51], v[160:175]
    v_mfma_f32_32x32x16_bf16 v[176:191], a[228:231], v[48:51], v[176:191]
    s_mov_b32 s56, 12582912
    buffer_load_dwordx4 a[0:3], v30, s[32:35], s56 offen offset:0 sc1
    buffer_load_dwordx4 a[4:7], v30, s[32:35], s56 offen offset:1024 sc1
    buffer_load_dwordx4 a[8:11], v30, s[32:35], s56 offen offset:2048 sc1
    buffer_load_dwordx4 a[12:15], v30, s[32:35], s56 offen offset:3072 sc1
    buffer_load_dwordx4 a[16:19], v31, s[32:35], s56 offen offset:0 sc1
    s_waitcnt lgkmcnt(7)
    s_waitcnt lgkmcnt(6)
    v_mfma_f32_32x32x16_bf16 v[96:111], a[232:235], v[60:63], v[96:111]
    ds_read_b128 v[40:43], v19 offset:0
    ds_read_b128 v[44:47], v19 offset:4096
    v_mfma_f32_32x32x16_bf16 v[112:127], a[236:239], v[60:63], v[112:127]
    ds_read_b128 v[48:51], v19 offset:8192
    s_waitcnt lgkmcnt(3)
    s_add_u32 s56, s88, 1310720
    s_add_u32 m0, s57, 0
    s_nop 0
    buffer_load_dwordx4 v30, s[32:35], s56 offen offset:0 sc1 lds
    v_mfma_f32_32x32x16_bf16 v[128:143], a[232:235], v[64:67], v[128:143]
    v_mfma_f32_32x32x16_bf16 v[144:159], a[236:239], v[64:67], v[144:159]
    buffer_load_dwordx4 v30, s[32:35], s56 offen offset:1024 sc1 lds
    v_mfma_f32_32x32x16_bf16 v[160:175], a[232:235], v[68:71], v[160:175]
    v_mfma_f32_32x32x16_bf16 v[176:191], a[236:239], v[68:71], v[176:191]
    buffer_load_dwordx4 v30, s[32:35], s56 offen offset:2048 sc1 lds
    s_waitcnt lgkmcnt(2)
    v_mfma_f32_32x32x16_bf16 v[96:111], a[240:243], v[40:43], v[96:111]
    ds_read_b128 v[60:63], v20 offset:0
    ds_read_b128 v[64:67], v20 offset:4096
    v_mfma_f32_32x32x16_bf16 v[112:127], a[244:247], v[40:43], v[112:127]
    ds_read_b128 v[68:71], v20 offset:8192
    buffer_load_dwordx4 v30, s[32:35], s56 offen offset:3072 sc1 lds
    s_waitcnt lgkmcnt(4)
    v_mfma_f32_32x32x16_bf16 v[128:143], a[240:243], v[44:47], v[128:143]
    v_mfma_f32_32x32x16_bf16 v[144:159], a[244:247], v[44:47], v[144:159]
    s_add_u32 m0, s57, 4096
    s_nop 0
    buffer_load_dwordx4 v31, s[32:35], s56 offen offset:0 sc1 lds
    s_waitcnt lgkmcnt(3)
    v_mfma_f32_32x32x16_bf16 v[160:175], a[240:243], v[48:51], v[160:175]
    v_mfma_f32_32x32x16_bf16 v[176:191], a[244:247], v[48:51], v[176:191]
    s_add_u32 s56, s88, 1474560
    s_add_u32 m0, s57, 11264
    s_nop 0
    buffer_load_dwordx4 v30, s[32:35], s56 offen offset:0 sc1 lds
    s_waitcnt lgkmcnt(2)
    v_mfma_f32_32x32x16_bf16 v[96:111], a[248:251], v[60:63], v[96:111]
    v_mfma_f32_32x32x16_bf16 v[112:127], a[252:255], v[60:63], v[112:127]
    buffer_load_dwordx4 v30, s[32:35], s56 offen offset:1024 sc1 lds
    s_waitcnt lgkmcnt(1)
    v_mfma_f32_32x32x16_bf16 v[128:143], a[248:251], v[64:67], v[128:143]
    v_mfma_f32_32x32x16_bf16 v[144:159], a[252:255], v[64:67], v[144:159]
    buffer_load_dwordx4 v30, s[32:35], s56 offen offset:2048 sc1 lds
    s_waitcnt lgkmcnt(0)
    v_mfma_f32_32x32x16_bf16 v[160:175], a[248:251], v[68:71], v[160:175]
    v_mfma_f32_32x32x16_bf16 v[176:191], a[252:255], v[68:71], v[176:191]
    buffer_load_dwordx4 v30, s[32:35], s56 offen offset:3072 sc1 lds
    s_cmp_lg_u32 s6, 31
    s_cbranch_scc1 L_nog_46
    v_and_b32 v26, 31, v1
    v_cmp_eq_u32 vcc, 0, v26
    v_lshlrev_b32 v26, 2, v1
    v_mov_b32 v27, 2130706432
    v_cndmask_b32 v26, v27, v26, vcc
    s_lshl_b32 s3, s5, 2
    s_add_u32 s3, s3, s4
    s_lshl_b32 s3, s3, 8
    s_add_u32 s3, s3, 16613376
    s_nop 4
    buffer_store_dwordx4 v[128:131], v26, s[32:35], s3 offen offset:0 sc1
    buffer_store_dwordx4 v[132:135], v26, s[32:35], s3 offen offset:16 sc1
    buffer_store_dwordx4 v[136:139], v26, s[32:35], s3 offen offset:32 sc1
    buffer_store_dwordx4 v[140:143], v26, s[32:35], s3 offen offset:48 sc1
    buffer_store_dwordx4 v[144:147], v26, s[32:35], s3 offen offset:64 sc1
    buffer_store_dwordx4 v[148:151], v26, s[32:35], s3 offen offset:80 sc1
    buffer_store_dwordx4 v[152:155], v26, s[32:35], s3 offen offset:96 sc1
    buffer_store_dwordx4 v[156:159], v26, s[32:35], s3 offen offset:112 sc1
L_nog_46:
    v_permlane16_swap_b32 v96, v112
    v_permlane16_swap_b32 v128, v144
    v_permlane16_swap_b32 v160, v176
    v_permlane16_swap_b32 v97, v113
    v_permlane16_swap_b32 v129, v145
    v_permlane16_swap_b32 v161, v177
    v_permlane16_swap_b32 v98, v114
    v_permlane16_swap_b32 v130, v146
    v_permlane16_swap_b32 v162, v178
    v_permlane16_swap_b32 v99, v115
    v_permlane16_swap_b32 v131, v147
    v_permlane16_swap_b32 v163, v179
    v_permlane16_swap_b32 v100, v116
    v_permlane16_swap_b32 v132, v148
    v_permlane16_swap_b32 v164, v180
    v_permlane16_swap_b32 v101, v117
    s_add_u32 m0, s57, 15360
    s_nop 0
    buffer_load_dwordx4 v31, s[32:35], s56 offen offset:0 sc1 lds
    v_permlane16_swap_b32 v133, v149
    v_permlane16_swap_b32 v165, v181
    v_permlane16_swap_b32 v102, v118
    v_permlane16_swap_b32 v134, v150
    v_permlane16_swap_b32 v166, v182
    v_permlane16_swap_b32 v103, v119
    v_permlane16_swap_b32 v135, v151
    v_permlane16_swap_b32 v167, v183
    v_permlane16_swap_b32 v104, v120
    v_permlane16_swap_b32 v136, v152
    v_permlane16_swap_b32 v168, v184
    v_permlane16_swap_b32 v105, v121
    v_permlane16_swap_b32 v137, v153
    v_permlane16_swap_b32 v169, v185
    v_permlane16_swap_b32 v106, v122
    v_permlane16_swap_b32 v138, v154
    s_mov_b32 s56, 12746752
    buffer_load_dwordx4 a[20:23], v30, s[32:35], s56 offen offset:0 sc1
    v_permlane16_swap_b32 v170, v186
    v_permlane16_swap_b32 v107, v123
    v_permlane16_swap_b32 v139, v155
    v_permlane16_swap_b32 v171, v187
    v_permlane16_swap_b32 v108, v124
    v_permlane16_swap_b32 v140, v156
    v_permlane16_swap_b32 v172, v188
    v_permlane16_swap_b32 v109, v125
    v_permlane16_swap_b32 v141, v157
    v_permlane16_swap_b32 v173, v189
    v_permlane16_swap_b32 v110, v126
    v_permlane16_swap_b32 v142, v158
    v_permlane16_swap_b32 v174, v190
    v_permlane16_swap_b32 v111, v127
    v_permlane16_swap_b32 v143, v159
    v_permlane16_swap_b32 v175, v191
    buffer_load_dwordx4 a[24:27], v30, s[32:35], s56 offen offset:1024 sc1
    v_pk_mul_f32 v[2:3], v[194:195], v[96:97] op_sel:[0,0] op_sel_hi:[1,0]
    v_pk_mul_f32 v[6:7], v[206:207], v[128:129] op_sel:[0,0] op_sel_hi:[1,0]
    v_pk_mul_f32 v[14:15], v[218:219], v[160:161] op_sel:[0,0] op_sel_hi:[1,0]
    v_pk_mul_f32 v[4:5], v[194:195], v[96:97] op_sel:[0,1] op_sel_hi:[1,1]
    v_pk_mul_f32 v[8:9], v[206:207], v[128:129] op_sel:[0,1] op_sel_hi:[1,1]
    v_pk_mul_f32 v[16:17], v[218:219], v[160:161] op_sel:[0,1] op_sel_hi:[1,1]
    v_pk_fma_f32 v[96:97], v[194:195], v[112:113], v[2:3] op_sel:[1,0,0] op_sel_hi:[0,0,1] neg_lo:[1,0,0]
    v_pk_fma_f32 v[128:129], v[206:207], v[144:145], v[6:7] op_sel:[1,0,0] op_sel_hi:[0,0,1] neg_lo:[1,0,0]
    v_pk_fma_f32 v[160:161], v[218:219], v[176:177], v[14:15] op_sel:[1,0,0] op_sel_hi:[0,0,1] neg_lo:[1,0,0]
    v_pk_fma_f32 v[112:113], v[194:195], v[112:113], v[4:5] op_sel:[1,1,0] op_sel_hi:[0,1,1] neg_lo:[1,0,0]
    v_pk_fma_f32 v[144:145], v[206:207], v[144:145], v[8:9] op_sel:[1,1,0] op_sel_hi:[0,1,1] neg_lo:[1,0,0]
    v_pk_fma_f32 v[176:177], v[218:219], v[176:177], v[16:17] op_sel:[1,1,0] op_sel_hi:[0,1,1] neg_lo:[1,0,0]
    v_pk_mul_f32 v[2:3], v[194:195], v[98:99] op_sel:[0,0] op_sel_hi:[1,0]
    v_pk_mul_f32 v[6:7], v[206:207], v[130:131] op_sel:[0,0] op_sel_hi:[1,0]
    v_pk_mul_f32 v[14:15], v[218:219], v[162:163] op_sel:[0,0] op_sel_hi:[1,0]
    v_pk_mul_f32 v[4:5], v[194:195], v[98:99] op_sel:[0,1] op_sel_hi:[1,1]
    buffer_load_dwordx4 a[28:31], v30, s[32:35], s56 offen offset:2048 sc1
    v_pk_mul_f32 v[8:9], v[206:207], v[130:131] op_sel:[0,1] op_sel_hi:[1,1]
    v_pk_mul_f32 v[16:17], v[218:219], v[162:163] op_sel:[0,1] op_sel_hi:[1,1]
    v_pk_fma_f32 v[98:99], v[194:195], v[114:115], v[2:3] op_sel:[1,0,0] op_sel_hi:[0,0,1] neg_lo:[1,0,0]
    v_pk_fma_f32 v[130:131], v[206:207], v[146:147], v[6:7] op_sel:[1,0,0] op_sel_hi:[0,0,1] neg_lo:[1,0,0]
    v_pk_fma_f32 v[162:163], v[218:219], v[178:179], v[14:15] op_sel:[1,0,0] op_sel_hi:[0,0,1] neg_lo:[1,0,0]
    v_pk_fma_f32 v[114:115], v[194:195], v[114:115], v[4:5] op_sel:[1,1,0] op_sel_hi:[0,1,1] neg_lo:[1,0,0]
    v_pk_fma_f32 v[146:147], v[206:207], v[146:147], v[8:9] op_sel:[1,1,0] op_sel_hi:[0,1,1] neg_lo:[1,0,0]
    v_pk_fma_f32 v[178:179], v[218:219], v[178:179], v[16:17] op_sel:[1,1,0] op_sel_hi:[0,1,1] neg_lo:[1,0,0]
    v_pk_mul_f32 v[2:3], v[194:195], v[100:101] op_sel:[0,0] op_sel_hi:[1,0]
    v_pk_mul_f32 v[6:7], v[206:207], v[132:133] op_sel:[0,0] op_sel_hi:[1,0]
    v_pk_mul_f32 v[14:15], v[218:219], v[164:165] op_sel:[0,0] op_sel_hi:[1,0]
    v_pk_mul_f32 v[4:5], v[194:195], v[100:101] op_sel:[0,1] op_sel_hi:[1,1]
    v_pk_mul_f32 v[8:9], v[206:207], v[132:133] op_sel:[0,1] op_sel_hi:[1,1]
    v_pk_mul_f32 v[16:17], v[218:219], v[164:165] op_sel:[0,1] op_sel_hi:[1,1]
    v_pk_fma_f32 v[100:101], v[194:195], v[116:117], v[2:3] op_sel:[1,0,0] op_sel_hi:[0,0,1] neg_lo:[1,0,0]
    v_pk_fma_f32 v[132:133], v[206:207], v[148:149], v[6:7] op_sel:[1,0,0] op_sel_hi:[0,0,1] neg_lo:[1,0,0]
    buffer_load_dwordx4 a[32:35], v30, s[32:35], s56 offen offset:3072 sc1
    v_pk_fma_f32 v[164:165], v[218:219], v[180:181], v[14:15] op_sel:[1,0,0] op_sel_hi:[0,0,1] neg_lo:[1,0,0]
    v_pk_fma_f32 v[116:117], v[194:195], v[116:117], v[4:5] op_sel:[1,1,0] op_sel_hi:[0,1,1] neg_lo:[1,0,0]
    v_pk_fma_f32 v[148:149], v[206:207], v[148:149], v[8:9] op_sel:[1,1,0] op_sel_hi:[0,1,1] neg_lo:[1,0,0]
    v_pk_fma_f32 v[180:181], v[218:219], v[180:181], v[16:17] op_sel:[1,1,0] op_sel_hi:[0,1,1] neg_lo:[1,0,0]
    v_pk_mul_f32 v[2:3], v[194:195], v[102:103] op_sel:[0,0] op_sel_hi:[1,0]
    v_pk_mul_f32 v[6:7], v[206:207], v[134:135] op_sel:[0,0] op_sel_hi:[1,0]
    v_pk_mul_f32 v[14:15], v[218:219], v[166:167] op_sel:[0,0] op_sel_hi:[1,0]
    v_pk_mul_f32 v[4:5], v[194:195], v[102:103] op_sel:[0,1] op_sel_hi:[1,1]
    v_pk_mul_f32 v[8:9], v[206:207], v[134:135] op_sel:[0,1] op_sel_hi:[1,1]
    v_pk_mul_f32 v[16:17], v[218:219], v[166:167] op_sel:[0,1] op_sel_hi:[1,1]
    v_pk_fma_f32 v[102:103], v[194:195], v[118:119], v[2:3] op_sel:[1,0,0] op_sel_hi:[0,0,1] neg_lo:[1,0,0]
    v_pk_fma_f32 v[134:135], v[206:207], v[150:151], v[6:7] op_sel:[1,0,0] op_sel_hi:[0,0,1] neg_lo:[1,0,0]
    v_pk_fma_f32 v[166:167], v[218:219], v[182:183], v[14:15] op_sel:[1,0,0] op_sel_hi:[0,0,1] neg_lo:[1,0,0]
    v_pk_fma_f32 v[118:119], v[194:195], v[118:119], v[4:5] op_sel:[1,1,0] op_sel_hi:[0,1,1] neg_lo:[1,0,0]
    v_pk_fma_f32 v[150:151], v[206:207], v[150:151], v[8:9] op_sel:[1,1,0] op_sel_hi:[0,1,1] neg_lo:[1,0,0]
    v_pk_fma_f32 v[182:183], v[218:219], v[182:183], v[16:17] op_sel:[1,1,0] op_sel_hi:[0,1,1] neg_lo:[1,0,0]
    buffer_load_dwordx4 a[36:39], v31, s[32:35], s56 offen offset:0 sc1
    v_pk_mul_f32 v[2:3], v[194:195], v[104:105] op_sel:[0,0] op_sel_hi:[1,0]
    v_pk_mul_f32 v[6:7], v[206:207], v[136:137] op_sel:[0,0] op_sel_hi:[1,0]
    v_pk_mul_f32 v[14:15], v[218:219], v[168:169] op_sel:[0,0] op_sel_hi:[1,0]
    v_pk_mul_f32 v[4:5], v[194:195], v[104:105] op_sel:[0,1] op_sel_hi:[1,1]
    v_pk_mul_f32 v[8:9], v[206:207], v[136:137] op_sel:[0,1] op_sel_hi:[1,1]
    v_pk_mul_f32 v[16:17], v[218:219], v[168:169] op_sel:[0,1] op_sel_hi:[1,1]
    v_pk_fma_f32 v[104:105], v[194:195], v[120:121], v[2:3] op_sel:[1,0,0] op_sel_hi:[0,0,1] neg_lo:[1,0,0]
    v_pk_fma_f32 v[136:137], v[206:207], v[152:153], v[6:7] op_sel:[1,0,0] op_sel_hi:[0,0,1] neg_lo:[1,0,0]
    v_pk_fma_f32 v[168:169], v[218:219], v[184:185], v[14:15] op_sel:[1,0,0] op_sel_hi:[0,0,1] neg_lo:[1,0,0]
    v_pk_fma_f32 v[120:121], v[194:195], v[120:121], v[4:5] op_sel:[1,1,0] op_sel_hi:[0,1,1] neg_lo:[1,0,0]
    v_pk_fma_f32 v[152:153], v[206:207], v[152:153], v[8:9] op_sel:[1,1,0] op_sel_hi:[0,1,1] neg_lo:[1,0,0]
    v_pk_fma_f32 v[184:185], v[218:219], v[184:185], v[16:17] op_sel:[1,1,0] op_sel_hi:[0,1,1] neg_lo:[1,0,0]
    v_pk_mul_f32 v[2:3], v[194:195], v[106:107] op_sel:[0,0] op_sel_hi:[1,0]
    v_pk_mul_f32 v[6:7], v[206:207], v[138:139] op_sel:[0,0] op_sel_hi:[1,0]
    v_pk_mul_f32 v[14:15], v[218:219], v[170:171] op_sel:[0,0] op_sel_hi:[1,0]
    v_pk_mul_f32 v[4:5], v[194:195], v[106:107] op_sel:[0,1] op_sel_hi:[1,1]
    s_mov_b32 s56, 12910592
    buffer_load_dwordx4 a[40:43], v30, s[32:35], s56 offen offset:0 sc1
    v_pk_mul_f32 v[8:9], v[206:207], v[138:139] op_sel:[0,1] op_sel_hi:[1,1]
    v_pk_mul_f32 v[16:17], v[218:219], v[170:171] op_sel:[0,1] op_sel_hi:[1,1]
    v_pk_fma_f32 v[106:107], v[194:195], v[122:123], v[2:3] op_sel:[1,0,0] op_sel_hi:[0,0,1] neg_lo:[1,0,0]
    v_pk_fma_f32 v[138:139], v[206:207], v[154:155], v[6:7] op_sel:[1,0,0] op_sel_hi:[0,0,1] neg_lo:[1,0,0]
    v_pk_fma_f32 v[170:171], v[218:219], v[186:187], v[14:15] op_sel:[1,0,0] op_sel_hi:[0,0,1] neg_lo:[1,0,0]
    v_pk_fma_f32 v[122:123], v[194:195], v[122:123], v[4:5] op_sel:[1,1,0] op_sel_hi:[0,1,1] neg_lo:[1,0,0]
    v_pk_fma_f32 v[154:155], v[206:207], v[154:155], v[8:9] op_sel:[1,1,0] op_sel_hi:[0,1,1] neg_lo:[1,0,0]
    v_pk_fma_f32 v[186:187], v[218:219], v[186:187], v[16:17] op_sel:[1,1,0] op_sel_hi:[0,1,1] neg_lo:[1,0,0]
    v_pk_mul_f32 v[2:3], v[194:195], v[108:109] op_sel:[0,0] op_sel_hi:[1,0]
    v_pk_mul_f32 v[6:7], v[206:207], v[140:141] op_sel:[0,0] op_sel_hi:[1,0]
    v_pk_mul_f32 v[14:15], v[218:219], v[172:173] op_sel:[0,0] op_sel_hi:[1,0]
    v_pk_mul_f32 v[4:5], v[194:195], v[108:109] op_sel:[0,1] op_sel_hi:[1,1]
    v_pk_mul_f32 v[8:9], v[206:207], v[140:141] op_sel:[0,1] op_sel_hi:[1,1]
    v_pk_mul_f32 v[16:17], v[218:219], v[172:173] op_sel:[0,1] op_sel_hi:[1,1]
    v_pk_fma_f32 v[108:109], v[194:195], v[124:125], v[2:3] op_sel:[1,0,0] op_sel_hi:[0,0,1] neg_lo:[1,0,0]
    v_pk_fma_f32 v[140:141], v[206:207], v[156:157], v[6:7] op_sel:[1,0,0] op_sel_hi:[0,0,1] neg_lo:[1,0,0]
    buffer_load_dwordx4 a[44:47], v30, s[32:35], s56 offen offset:1024 sc1
    v_pk_fma_f32 v[172:173], v[218:219], v[188:189], v[14:15] op_sel:[1,0,0] op_sel_hi:[0,0,1] neg_lo:[1,0,0]
    v_pk_fma_f32 v[124:125], v[194:195], v[124:125], v[4:5] op_sel:[1,1,0] op_sel_hi:[0,1,1] neg_lo:[1,0,0]
    v_pk_fma_f32 v[156:157], v[206:207], v[156:157], v[8:9] op_sel:[1,1,0] op_sel_hi:[0,1,1] neg_lo:[1,0,0]
    v_pk_fma_f32 v[188:189], v[218:219], v[188:189], v[16:17] op_sel:[1,1,0] op_sel_hi:[0,1,1] neg_lo:[1,0,0]
    v_pk_mul_f32 v[2:3], v[194:195], v[110:111] op_sel:[0,0] op_sel_hi:[1,0]
    v_pk_mul_f32 v[6:7], v[206:207], v[142:143] op_sel:[0,0] op_sel_hi:[1,0]
    v_pk_mul_f32 v[14:15], v[218:219], v[174:175] op_sel:[0,0] op_sel_hi:[1,0]
    v_pk_mul_f32 v[4:5], v[194:195], v[110:111] op_sel:[0,1] op_sel_hi:[1,1]
    v_pk_mul_f32 v[8:9], v[206:207], v[142:143] op_sel:[0,1] op_sel_hi:[1,1]
    v_pk_mul_f32 v[16:17], v[218:219], v[174:175] op_sel:[0,1] op_sel_hi:[1,1]
    v_pk_fma_f32 v[110:111], v[194:195], v[126:127], v[2:3] op_sel:[1,0,0] op_sel_hi:[0,0,1] neg_lo:[1,0,0]
    v_pk_fma_f32 v[142:143], v[206:207], v[158:159], v[6:7] op_sel:[1,0,0] op_sel_hi:[0,0,1] neg_lo:[1,0,0]
    v_pk_fma_f32 v[174:175], v[218:219], v[190:191], v[14:15] op_sel:[1,0,0] op_sel_hi:[0,0,1] neg_lo:[1,0,0]
    v_pk_fma_f32 v[126:127], v[194:195], v[126:127], v[4:5] op_sel:[1,1,0] op_sel_hi:[0,1,1] neg_lo:[1,0,0]
    v_pk_fma_f32 v[158:159], v[206:207], v[158:159], v[8:9] op_sel:[1,1,0] op_sel_hi:[0,1,1] neg_lo:[1,0,0]
    v_pk_fma_f32 v[190:191], v[218:219], v[190:191], v[16:17] op_sel:[1,1,0] op_sel_hi:[0,1,1] neg_lo:[1,0,0]
    buffer_load_dwordx4 a[48:51], v30, s[32:35], s56 offen offset:2048 sc1
    v_pk_fma_f32 v[2:3], v[192:193], v[96:97], v[112:113] op_sel:[0,0,0] op_sel_hi:[0,1,1]
    v_pk_fma_f32 v[6:7], v[204:205], v[128:129], v[144:145] op_sel:[0,0,0] op_sel_hi:[0,1,1]
    v_pk_fma_f32 v[14:15], v[216:217], v[160:161], v[176:177] op_sel:[0,0,0] op_sel_hi:[0,1,1]
    v_pk_fma_f32 v[2:3], v[192:193], v[96:97], v[2:3] op_sel:[1,1,0] op_sel_hi:[1,0,1] neg_lo:[1,0,0]
    v_pk_fma_f32 v[6:7], v[204:205], v[128:129], v[6:7] op_sel:[1,1,0] op_sel_hi:[1,0,1] neg_lo:[1,0,0]
    v_pk_fma_f32 v[14:15], v[216:217], v[160:161], v[14:15] op_sel:[1,1,0] op_sel_hi:[1,0,1] neg_lo:[1,0,0]
    v_pk_fma_f32 v[4:5], v[192:193], v[2:3], v[98:99] op_sel:[0,0,0] op_sel_hi:[0,1,1]
    v_pk_fma_f32 v[8:9], v[204:205], v[6:7], v[130:131] op_sel:[0,0,0] op_sel_hi:[0,1,1]
    v_pk_fma_f32 v[16:17], v[216:217], v[14:15], v[162:163] op_sel:[0,0,0] op_sel_hi:[0,1,1]
    v_pk_fma_f32 v[4:5], v[192:193], v[2:3], v[4:5] op_sel:[1,1,0] op_sel_hi:[1,0,1] neg_lo:[1,0,0]
    v_pk_fma_f32 v[8:9], v[204:205], v[6:7], v[8:9] op_sel:[1,1,0] op_sel_hi:[1,0,1] neg_lo:[1,0,0]
    v_pk_fma_f32 v[16:17], v[216:217], v[14:15], v[16:17] op_sel:[1,1,0] op_sel_hi:[1,0,1] neg_lo:[1,0,0]
    v_pk_fma_f32 v[2:3], v[192:193], v[4:5], v[114:115] op_sel:[0,0,0] op_sel_hi:[0,1,1]
    v_pk_fma_f32 v[6:7], v[204:205], v[8:9], v[146:147] op_sel:[0,0,0] op_sel_hi:[0,1,1]
    v_pk_fma_f32 v[14:15], v[216:217], v[16:17], v[178:179] op_sel:[0,0,0] op_sel_hi:[0,1,1]
    v_pk_fma_f32 v[2:3], v[192:193], v[4:5], v[2:3] op_sel:[1,1,0] op_sel_hi:[1,0,1] neg_lo:[1,0,0]
    buffer_load_dwordx4 a[52:55], v30, s[32:35], s56 offen offset:3072 sc1
    v_pk_fma_f32 v[6:7], v[204:205], v[8:9], v[6:7] op_sel:[1,1,0] op_sel_hi:[1,0,1] neg_lo:[1,0,0]
    v_pk_fma_f32 v[14:15], v[216:217], v[16:17], v[14:15] op_sel:[1,1,0] op_sel_hi:[1,0,1] neg_lo:[1,0,0]
    v_pk_fma_f32 v[4:5], v[192:193], v[2:3], v[100:101] op_sel:[0,0,0] op_sel_hi:[0,1,1]
    v_pk_fma_f32 v[8:9], v[204:205], v[6:7], v[132:133] op_sel:[0,0,0] op_sel_hi:[0,1,1]
    v_pk_fma_f32 v[16:17], v[216:217], v[14:15], v[164:165] op_sel:[0,0,0] op_sel_hi:[0,1,1]
    v_pk_fma_f32 v[4:5], v[192:193], v[2:3], v[4:5] op_sel:[1,1,0] op_sel_hi:[1,0,1] neg_lo:[1,0,0]
    v_pk_fma_f32 v[8:9], v[204:205], v[6:7], v[8:9] op_sel:[1,1,0] op_sel_hi:[1,0,1] neg_lo:[1,0,0]
    v_pk_fma_f32 v[16:17], v[216:217], v[14:15], v[16:17] op_sel:[1,1,0] op_sel_hi:[1,0,1] neg_lo:[1,0,0]
    v_pk_fma_f32 v[2:3], v[192:193], v[4:5], v[116:117] op_sel:[0,0,0] op_sel_hi:[0,1,1]
    v_pk_fma_f32 v[6:7], v[204:205], v[8:9], v[148:149] op_sel:[0,0,0] op_sel_hi:[0,1,1]
    v_pk_fma_f32 v[14:15], v[216:217], v[16:17], v[180:181] op_sel:[0,0,0] op_sel_hi:[0,1,1]
    v_pk_fma_f32 v[2:3], v[192:193], v[4:5], v[2:3] op_sel:[1,1,0] op_sel_hi:[1,0,1] neg_lo:[1,0,0]
    v_pk_fma_f32 v[6:7], v[204:205], v[8:9], v[6:7] op_sel:[1,1,0] op_sel_hi:[1,0,1] neg_lo:[1,0,0]
    v_pk_fma_f32 v[14:15], v[216:217], v[16:17], v[14:15] op_sel:[1,1,0] op_sel_hi:[1,0,1] neg_lo:[1,0,0]
    v_pk_fma_f32 v[4:5], v[192:193], v[2:3], v[102:103] op_sel:[0,0,0] op_sel_hi:[0,1,1]
    v_pk_fma_f32 v[8:9], v[204:205], v[6:7], v[134:135] op_sel:[0,0,0] op_sel_hi:[0,1,1]
    buffer_load_dwordx4 a[56:59], v31, s[32:35], s56 offen offset:0 sc1
    v_pk_fma_f32 v[16:17], v[216:217], v[14:15], v[166:167] op_sel:[0,0,0] op_sel_hi:[0,1,1]
    v_pk_fma_f32 v[4:5], v[192:193], v[2:3], v[4:5] op_sel:[1,1,0] op_sel_hi:[1,0,1] neg_lo:[1,0,0]
    v_pk_fma_f32 v[8:9], v[204:205], v[6:7], v[8:9] op_sel:[1,1,0] op_sel_hi:[1,0,1] neg_lo:[1,0,0]
    v_pk_fma_f32 v[16:17], v[216:217], v[14:15], v[16:17] op_sel:[1,1,0] op_sel_hi:[1,0,1] neg_lo:[1,0,0]
    v_pk_fma_f32 v[2:3], v[192:193], v[4:5], v[118:119] op_sel:[0,0,0] op_sel_hi:[0,1,1]
    v_pk_fma_f32 v[6:7], v[204:205], v[8:9], v[150:151] op_sel:[0,0,0] op_sel_hi:[0,1,1]
    v_pk_fma_f32 v[14:15], v[216:217], v[16:17], v[182:183] op_sel:[0,0,0] op_sel_hi:[0,1,1]
    v_pk_fma_f32 v[2:3], v[192:193], v[4:5], v[2:3] op_sel:[1,1,0] op_sel_hi:[1,0,1] neg_lo:[1,0,0]
    v_pk_fma_f32 v[6:7], v[204:205], v[8:9], v[6:7] op_sel:[1,1,0] op_sel_hi:[1,0,1] neg_lo:[1,0,0]
    v_pk_fma_f32 v[14:15], v[216:217], v[16:17], v[14:15] op_sel:[1,1,0] op_sel_hi:[1,0,1] neg_lo:[1,0,0]
    v_pk_fma_f32 v[4:5], v[192:193], v[2:3], v[104:105] op_sel:[0,0,0] op_sel_hi:[0,1,1]
    v_pk_fma_f32 v[8:9], v[204:205], v[6:7], v[136:137] op_sel:[0,0,0] op_sel_hi:[0,1,1]
    v_pk_fma_f32 v[16:17], v[216:217], v[14:15], v[168:169] op_sel:[0,0,0] op_sel_hi:[0,1,1]
    v_pk_fma_f32 v[4:5], v[192:193], v[2:3], v[4:5] op_sel:[1,1,0] op_sel_hi:[1,0,1] neg_lo:[1,0,0]
    v_pk_fma_f32 v[8:9], v[204:205], v[6:7], v[8:9] op_sel:[1,1,0] op_sel_hi:[1,0,1] neg_lo:[1,0,0]
    v_pk_fma_f32 v[16:17], v[216:217], v[14:15], v[16:17] op_sel:[1,1,0] op_sel_hi:[1,0,1] neg_lo:[1,0,0]
    s_mov_b32 s56, 13074432
    buffer_load_dwordx4 a[60:63], v32, s[32:35], s56 offen offset:0 sc1
    v_pk_fma_f32 v[2:3], v[192:193], v[4:5], v[120:121] op_sel:[0,0,0] op_sel_hi:[0,1,1]
    v_pk_fma_f32 v[6:7], v[204:205], v[8:9], v[152:153] op_sel:[0,0,0] op_sel_hi:[0,1,1]
    v_pk_fma_f32 v[14:15], v[216:217], v[16:17], v[184:185] op_sel:[0,0,0] op_sel_hi:[0,1,1]
    v_pk_fma_f32 v[2:3], v[192:193], v[4:5], v[2:3] op_sel:[1,1,0] op_sel_hi:[1,0,1] neg_lo:[1,0,0]
    v_pk_fma_f32 v[6:7], v[204:205], v[8:9], v[6:7] op_sel:[1,1,0] op_sel_hi:[1,0,1] neg_lo:[1,0,0]
    v_pk_fma_f32 v[14:15], v[216:217], v[16:17], v[14:15] op_sel:[1,1,0] op_sel_hi:[1,0,1] neg_lo:[1,0,0]
    v_pk_fma_f32 v[4:5], v[192:193], v[2:3], v[106:107] op_sel:[0,0,0] op_sel_hi:[0,1,1]
    v_pk_fma_f32 v[8:9], v[204:205], v[6:7], v[138:139] op_sel:[0,0,0] op_sel_hi:[0,1,1]
    v_pk_fma_f32 v[16:17], v[216:217], v[14:15], v[170:171] op_sel:[0,0,0] op_sel_hi:[0,1,1]
    v_pk_fma_f32 v[4:5], v[192:193], v[2:3], v[4:5] op_sel:[1,1,0] op_sel_hi:[1,0,1] neg_lo:[1,0,0]
    v_pk_fma_f32 v[8:9], v[204:205], v[6:7], v[8:9] op_sel:[1,1,0] op_sel_hi:[1,0,1] neg_lo:[1,0,0]
    v_pk_fma_f32 v[16:17], v[216:217], v[14:15], v[16:17] op_sel:[1,1,0] op_sel_hi:[1,0,1] neg_lo:[1,0,0]
    v_pk_fma_f32 v[2:3], v[192:193], v[4:5], v[122:123] op_sel:[0,0,0] op_sel_hi:[0,1,1]
    v_pk_fma_f32 v[6:7], v[204:205], v[8:9], v[154:155] op_sel:[0,0,0] op_sel_hi:[0,1,1]
    v_pk_fma_f32 v[14:15], v[216:217], v[16:17], v[186:187] op_sel:[0,0,0] op_sel_hi:[0,1,1]
    v_pk_fma_f32 v[2:3], v[192:193], v[4:5], v[2:3] op_sel:[1,1,0] op_sel_hi:[1,0,1] neg_lo:[1,0,0]
    buffer_load_dwordx4 a[64:67], v32, s[32:35], s56 offen offset:1024 sc1
    v_pk_fma_f32 v[6:7], v[204:205], v[8:9], v[6:7] op_sel:[1,1,0] op_sel_hi:[1,0,1] neg_lo:[1,0,0]
    v_pk_fma_f32 v[14:15], v[216:217], v[16:17], v[14:15] op_sel:[1,1,0] op_sel_hi:[1,0,1] neg_lo:[1,0,0]
    v_pk_fma_f32 v[4:5], v[192:193], v[2:3], v[108:109] op_sel:[0,0,0] op_sel_hi:[0,1,1]
    v_pk_fma_f32 v[8:9], v[204:205], v[6:7], v[140:141] op_sel:[0,0,0] op_sel_hi:[0,1,1]
    v_pk_fma_f32 v[16:17], v[216:217], v[14:15], v[172:173] op_sel:[0,0,0] op_sel_hi:[0,1,1]
    v_pk_fma_f32 v[4:5], v[192:193], v[2:3], v[4:5] op_sel:[1,1,0] op_sel_hi:[1,0,1] neg_lo:[1,0,0]
    v_pk_fma_f32 v[8:9], v[204:205], v[6:7], v[8:9] op_sel:[1,1,0] op_sel_hi:[1,0,1] neg_lo:[1,0,0]
    v_pk_fma_f32 v[16:17], v[216:217], v[14:15], v[16:17] op_sel:[1,1,0] op_sel_hi:[1,0,1] neg_lo:[1,0,0]
    v_pk_fma_f32 v[2:3], v[192:193], v[4:5], v[124:125] op_sel:[0,0,0] op_sel_hi:[0,1,1]
    v_pk_fma_f32 v[6:7], v[204:205], v[8:9], v[156:157] op_sel:[0,0,0] op_sel_hi:[0,1,1]
    v_pk_fma_f32 v[14:15], v[216:217], v[16:17], v[188:189] op_sel:[0,0,0] op_sel_hi:[0,1,1]
    v_pk_fma_f32 v[2:3], v[192:193], v[4:5], v[2:3] op_sel:[1,1,0] op_sel_hi:[1,0,1] neg_lo:[1,0,0]
    v_pk_fma_f32 v[6:7], v[204:205], v[8:9], v[6:7] op_sel:[1,1,0] op_sel_hi:[1,0,1] neg_lo:[1,0,0]
    v_pk_fma_f32 v[14:15], v[216:217], v[16:17], v[14:15] op_sel:[1,1,0] op_sel_hi:[1,0,1] neg_lo:[1,0,0]
    v_pk_fma_f32 v[4:5], v[192:193], v[2:3], v[110:111] op_sel:[0,0,0] op_sel_hi:[0,1,1]
    v_pk_fma_f32 v[8:9], v[204:205], v[6:7], v[142:143] op_sel:[0,0,0] op_sel_hi:[0,1,1]
    buffer_load_dwordx4 a[68:71], v32, s[32:35], s56 offen offset:2048 sc1
    v_pk_fma_f32 v[16:17], v[216:217], v[14:15], v[174:175] op_sel:[0,0,0] op_sel_hi:[0,1,1]
    v_pk_fma_f32 v[4:5], v[192:193], v[2:3], v[4:5] op_sel:[1,1,0] op_sel_hi:[1,0,1] neg_lo:[1,0,0]
    v_pk_fma_f32 v[8:9], v[204:205], v[6:7], v[8:9] op_sel:[1,1,0] op_sel_hi:[1,0,1] neg_lo:[1,0,0]
    v_pk_fma_f32 v[16:17], v[216:217], v[14:15], v[16:17] op_sel:[1,1,0] op_sel_hi:[1,0,1] neg_lo:[1,0,0]
    v_pk_fma_f32 v[2:3], v[192:193], v[4:5], v[126:127] op_sel:[0,0,0] op_sel_hi:[0,1,1]
    v_pk_fma_f32 v[6:7], v[204:205], v[8:9], v[158:159] op_sel:[0,0,0] op_sel_hi:[0,1,1]
    v_pk_fma_f32 v[14:15], v[216:217], v[16:17], v[190:191] op_sel:[0,0,0] op_sel_hi:[0,1,1]
    v_pk_fma_f32 v[2:3], v[192:193], v[4:5], v[2:3] op_sel:[1,1,0] op_sel_hi:[1,0,1] neg_lo:[1,0,0]
    v_pk_fma_f32 v[6:7], v[204:205], v[8:9], v[6:7] op_sel:[1,1,0] op_sel_hi:[1,0,1] neg_lo:[1,0,0]
    v_pk_fma_f32 v[14:15], v[216:217], v[16:17], v[14:15] op_sel:[1,1,0] op_sel_hi:[1,0,1] neg_lo:[1,0,0]
    ds_write_b64 v35, v[2:3] offset:2048
    ds_write_b64 v35, v[6:7] offset:6144
    ds_write_b64 v35, v[14:15] offset:10240
    s_waitcnt lgkmcnt(0)
    s_barrier
    ds_read_b64 v[40:41], v35 offset:0
    ds_read_b64 v[42:43], v35 offset:128
    buffer_load_dwordx4 a[72:75], v32, s[32:35], s56 offen offset:3072 sc1
    ds_read_b64 v[44:45], v35 offset:256
    ds_read_b64 v[46:47], v35 offset:384
    ds_read_b64 v[48:49], v35 offset:512
    ds_read_b64 v[50:51], v35 offset:640
    ds_read_b64 v[52:53], v35 offset:768
    ds_read_b64 v[54:55], v35 offset:896
    ds_read_b64 v[56:57], v35 offset:4096
    ds_read_b64 v[58:59], v35 offset:4224
    ds_read_b64 v[60:61], v35 offset:4352
    ds_read_b64 v[62:63], v35 offset:4480
    ds_read_b64 v[64:65], v35 offset:4608
    ds_read_b64 v[66:67], v35 offset:4736
    ds_read_b64 v[68:69], v35 offset:4864
    ds_read_b64 v[70:71], v35 offset:4992
    ds_read_b64 v[228:229], v35 offset:8192
    ds_read_b64 v[230:231], v35 offset:8320
    buffer_load_dwordx4 a[76:79], v33, s[32:35], s56 offen offset:0 sc1
    ds_read_b64 v[232:233], v35 offset:8448
    ds_read_b64 v[234:235], v35 offset:8576
    ds_read_b64 v[236:237], v35 offset:8704
    ds_read_b64 v[238:239], v35 offset:8832
    ds_read_b64 v[240:241], v35 offset:8960
    ds_read_b64 v[242:243], v35 offset:9088
    s_waitcnt lgkmcnt(0)
    v_pk_fma_f32 v[4:5], v[196:197], v[42:43], v[44:45] op_sel:[0,0,0] op_sel_hi:[0,1,1]
    v_pk_fma_f32 v[8:9], v[208:209], v[58:59], v[60:61] op_sel:[0,0,0] op_sel_hi:[0,1,1]
    v_pk_fma_f32 v[16:17], v[220:221], v[230:231], v[232:233] op_sel:[0,0,0] op_sel_hi:[0,1,1]
    v_pk_fma_f32 v[4:5], v[196:197], v[42:43], v[4:5] op_sel:[1,1,0] op_sel_hi:[1,0,1] neg_lo:[1,0,0]
    v_pk_fma_f32 v[8:9], v[208:209], v[58:59], v[8:9] op_sel:[1,1,0] op_sel_hi:[1,0,1] neg_lo:[1,0,0]
    v_pk_fma_f32 v[16:17], v[220:221], v[230:231], v[16:17] op_sel:[1,1,0] op_sel_hi:[1,0,1] neg_lo:[1,0,0]
    v_pk_fma_f32 v[10:11], v[196:197], v[4:5], v[46:47] op_sel:[0,0,0] op_sel_hi:[0,1,1]
    v_pk_fma_f32 v[18:19], v[208:209], v[8:9], v[62:63] op_sel:[0,0,0] op_sel_hi:[0,1,1]
    v_pk_fma_f32 v[20:21], v[220:221], v[16:17], v[234:235] op_sel:[0,0,0] op_sel_hi:[0,1,1]
    s_add_u32 s56, s88, 0
    buffer_load_dwordx4 a[80:83], v30, s[32:35], s56 offen offset:0 sc1
    v_pk_fma_f32 v[10:11], v[196:197], v[4:5], v[10:11] op_sel:[1,1,0] op_sel_hi:[1,0,1] neg_lo:[1,0,0]
    v_pk_fma_f32 v[18:19], v[208:209], v[8:9], v[18:19] op_sel:[1,1,0] op_sel_hi:[1,0,1] neg_lo:[1,0,0]
    v_pk_fma_f32 v[20:21], v[220:221], v[16:17], v[20:21] op_sel:[1,1,0] op_sel_hi:[1,0,1] neg_lo:[1,0,0]
    v_pk_fma_f32 v[4:5], v[196:197], v[10:11], v[48:49] op_sel:[0,0,0] op_sel_hi:[0,1,1]
    v_pk_fma_f32 v[8:9], v[208:209], v[18:19], v[64:65] op_sel:[0,0,0] op_sel_hi:[0,1,1]
    v_pk_fma_f32 v[16:17], v[220:221], v[20:21], v[236:237] op_sel:[0,0,0] op_sel_hi:[0,1,1]
    v_pk_fma_f32 v[4:5], v[196:197], v[10:11], v[4:5] op_sel:[1,1,0] op_sel_hi:[1,0,1] neg_lo:[1,0,0]
    v_pk_fma_f32 v[8:9], v[208:209], v[18:19], v[8:9] op_sel:[1,1,0] op_sel_hi:[1,0,1] neg_lo:[1,0,0]
    v_pk_fma_f32 v[16:17], v[220:221], v[20:21], v[16:17] op_sel:[1,1,0] op_sel_hi:[1,0,1] neg_lo:[1,0,0]
    v_pk_fma_f32 v[10:11], v[196:197], v[4:5], v[50:51] op_sel:[0,0,0] op_sel_hi:[0,1,1]
    v_pk_fma_f32 v[18:19], v[208:209], v[8:9], v[66:67] op_sel:[0,0,0] op_sel_hi:[0,1,1]
    v_pk_fma_f32 v[20:21], v[220:221], v[16:17], v[238:239] op_sel:[0,0,0] op_sel_hi:[0,1,1]
    v_pk_fma_f32 v[10:11], v[196:197], v[4:5], v[10:11] op_sel:[1,1,0] op_sel_hi:[1,0,1] neg_lo:[1,0,0]
    v_pk_fma_f32 v[18:19], v[208:209], v[8:9], v[18:19] op_sel:[1,1,0] op_sel_hi:[1,0,1] neg_lo:[1,0,0]
    v_pk_fma_f32 v[20:21], v[220:221], v[16:17], v[20:21] op_sel:[1,1,0] op_sel_hi:[1,0,1] neg_lo:[1,0,0]
    v_pk_fma_f32 v[4:5], v[196:197], v[10:11], v[52:53] op_sel:[0,0,0] op_sel_hi:[0,1,1]
    buffer_load_dwordx4 a[84:87], v30, s[32:35], s56 offen offset:1024 sc1
    v_pk_fma_f32 v[8:9], v[208:209], v[18:19], v[68:69] op_sel:[0,0,0] op_sel_hi:[0,1,1]
    v_pk_fma_f32 v[16:17], v[220:221], v[20:21], v[240:241] op_sel:[0,0,0] op_sel_hi:[0,1,1]
    v_pk_fma_f32 v[4:5], v[196:197], v[10:11], v[4:5] op_sel:[1,1,0] op_sel_hi:[1,0,1] neg_lo:[1,0,0]
    v_pk_fma_f32 v[8:9], v[208:209], v[18:19], v[8:9] op_sel:[1,1,0] op_sel_hi:[1,0,1] neg_lo:[1,0,0]
    v_pk_fma_f32 v[16:17], v[220:221], v[20:21], v[16:17] op_sel:[1,1,0] op_sel_hi:[1,0,1] neg_lo:[1,0,0]
    v_pk_fma_f32 v[10:11], v[196:197], v[4:5], v[54:55] op_sel:[0,0,0] op_sel_hi:[0,1,1]
    v_pk_fma_f32 v[18:19], v[208:209], v[8:9], v[70:71] op_sel:[0,0,0] op_sel_hi:[0,1,1]
    v_pk_fma_f32 v[20:21], v[220:221], v[16:17], v[242:243] op_sel:[0,0,0] op_sel_hi:[0,1,1]
    v_pk_fma_f32 v[10:11], v[196:197], v[4:5], v[10:11] op_sel:[1,1,0] op_sel_hi:[1,0,1] neg_lo:[1,0,0]
    v_pk_fma_f32 v[18:19], v[208:209], v[8:9], v[18:19] op_sel:[1,1,0] op_sel_hi:[1,0,1] neg_lo:[1,0,0]
    v_pk_fma_f32 v[20:21], v[220:221], v[16:17], v[20:21] op_sel:[1,1,0] op_sel_hi:[1,0,1] neg_lo:[1,0,0]
    ds_read_b64 v[40:41], v35 offset:1024
    ds_read_b64 v[42:43], v35 offset:1152
    ds_read_b64 v[44:45], v35 offset:1280
    ds_read_b64 v[46:47], v35 offset:1408
    ds_read_b64 v[48:49], v35 offset:1536
    buffer_load_dwordx4 a[88:91], v30, s[32:35], s56 offen offset:2048 sc1
    ds_read_b64 v[50:51], v35 offset:1664
    ds_read_b64 v[52:53], v35 offset:1792
    ds_read_b64 v[54:55], v35 offset:1920
    ds_read_b64 v[56:57], v35 offset:5120
    ds_read_b64 v[58:59], v35 offset:5248
    ds_read_b64 v[60:61], v35 offset:5376
    ds_read_b64 v[62:63], v35 offset:5504
    ds_read_b64 v[64:65], v35 offset:5632
    ds_read_b64 v[66:67], v35 offset:5760
    ds_read_b64 v[68:69], v35 offset:5888
    ds_read_b64 v[70:71], v35 offset:6016
    ds_read_b64 v[228:229], v35 offset:9216
    ds_read_b64 v[230:231], v35 offset:9344
    ds_read_b64 v[232:233], v35 offset:9472
    ds_read_b64 v[234:235], v35 offset:9600
    ds_read_b64 v[236:237], v35 offset:9728
    buffer_load_dwordx4 a[92:95], v30, s[32:35], s56 offen offset:3072 sc1
    ds_read_b64 v[238:239], v35 offset:9856
    ds_read_b64 v[240:241], v35 offset:9984
    ds_read_b64 v[242:243], v35 offset:10112
    s_waitcnt lgkmcnt(0)
    v_pk_fma_f32 v[4:5], v[196:197], v[10:11], v[40:41] op_sel:[0,0,0] op_sel_hi:[0,1,1]
    v_pk_fma_f32 v[8:9], v[208:209], v[18:19], v[56:57] op_sel:[0,0,0] op_sel_hi:[0,1,1]
    v_pk_fma_f32 v[16:17], v[220:221], v[20:21], v[228:229] op_sel:[0,0,0] op_sel_hi:[0,1,1]
    v_pk_fma_f32 v[4:5], v[196:197], v[10:11], v[4:5] op_sel:[1,1,0] op_sel_hi:[1,0,1] neg_lo:[1,0,0]
    v_pk_fma_f32 v[8:9], v[208:209], v[18:19], v[8:9] op_sel:[1,1,0] op_sel_hi:[1,0,1] neg_lo:[1,0,0]
    v_pk_fma_f32 v[16:17], v[220:221], v[20:21], v[16:17] op_sel:[1,1,0] op_sel_hi:[1,0,1] neg_lo:[1,0,0]
    v_pk_fma_f32 v[10:11], v[196:197], v[4:5], v[42:43] op_sel:[0,0,0] op_sel_hi:[0,1,1]
    v_pk_fma_f32 v[18:19], v[208:209], v[8:9], v[58:59] op_sel:[0,0,0] op_sel_hi:[0,1,1]
    v_pk_fma_f32 v[20:21], v[220:221], v[16:17], v[230:231] op_sel:[0,0,0] op_sel_hi:[0,1,1]
    v_pk_fma_f32 v[10:11], v[196:197], v[4:5], v[10:11] op_sel:[1,1,0] op_sel_hi:[1,0,1] neg_lo:[1,0,0]
    v_pk_fma_f32 v[18:19], v[208:209], v[8:9], v[18:19] op_sel:[1,1,0] op_sel_hi:[1,0,1] neg_lo:[1,0,0]
    v_pk_fma_f32 v[20:21], v[220:221], v[16:17], v[20:21] op_sel:[1,1,0] op_sel_hi:[1,0,1] neg_lo:[1,0,0]
    buffer_load_dwordx4 a[96:99], v31, s[32:35], s56 offen offset:0 sc1
    v_pk_fma_f32 v[4:5], v[196:197], v[10:11], v[44:45] op_sel:[0,0,0] op_sel_hi:[0,1,1]
    v_pk_fma_f32 v[8:9], v[208:209], v[18:19], v[60:61] op_sel:[0,0,0] op_sel_hi:[0,1,1]
    v_pk_fma_f32 v[16:17], v[220:221], v[20:21], v[232:233] op_sel:[0,0,0] op_sel_hi:[0,1,1]
    v_pk_fma_f32 v[4:5], v[196:197], v[10:11], v[4:5] op_sel:[1,1,0] op_sel_hi:[1,0,1] neg_lo:[1,0,0]
    v_pk_fma_f32 v[8:9], v[208:209], v[18:19], v[8:9] op_sel:[1,1,0] op_sel_hi:[1,0,1] neg_lo:[1,0,0]
    v_pk_fma_f32 v[16:17], v[220:221], v[20:21], v[16:17] op_sel:[1,1,0] op_sel_hi:[1,0,1] neg_lo:[1,0,0]
    v_pk_fma_f32 v[10:11], v[196:197], v[4:5], v[46:47] op_sel:[0,0,0] op_sel_hi:[0,1,1]
    v_pk_fma_f32 v[18:19], v[208:209], v[8:9], v[62:63] op_sel:[0,0,0] op_sel_hi:[0,1,1]
    v_pk_fma_f32 v[20:21], v[220:221], v[16:17], v[234:235] op_sel:[0,0,0] op_sel_hi:[0,1,1]
    v_pk_fma_f32 v[10:11], v[196:197], v[4:5], v[10:11] op_sel:[1,1,0] op_sel_hi:[1,0,1] neg_lo:[1,0,0]
    v_pk_fma_f32 v[18:19], v[208:209], v[8:9], v[18:19] op_sel:[1,1,0] op_sel_hi:[1,0,1] neg_lo:[1,0,0]
    v_pk_fma_f32 v[20:21], v[220:221], v[16:17], v[20:21] op_sel:[1,1,0] op_sel_hi:[1,0,1] neg_lo:[1,0,0]
    v_pk_fma_f32 v[4:5], v[196:197], v[10:11], v[48:49] op_sel:[0,0,0] op_sel_hi:[0,1,1]
    v_pk_fma_f32 v[8:9], v[208:209], v[18:19], v[64:65] op_sel:[0,0,0] op_sel_hi:[0,1,1]
    v_pk_fma_f32 v[16:17], v[220:221], v[20:21], v[236:237] op_sel:[0,0,0] op_sel_hi:[0,1,1]
    v_pk_fma_f32 v[4:5], v[196:197], v[10:11], v[4:5] op_sel:[1,1,0] op_sel_hi:[1,0,1] neg_lo:[1,0,0]
    s_add_u32 s56, s88, 163840
    buffer_load_dwordx4 a[100:103], v30, s[32:35], s56 offen offset:0 sc1
    v_pk_fma_f32 v[8:9], v[208:209], v[18:19], v[8:9] op_sel:[1,1,0] op_sel_hi:[1,0,1] neg_lo:[1,0,0]
    v_pk_fma_f32 v[16:17], v[220:221], v[20:21], v[16:17] op_sel:[1,1,0] op_sel_hi:[1,0,1] neg_lo:[1,0,0]
    v_pk_fma_f32 v[10:11], v[196:197], v[4:5], v[50:51] op_sel:[0,0,0] op_sel_hi:[0,1,1]
    v_pk_fma_f32 v[18:19], v[208:209], v[8:9], v[66:67] op_sel:[0,0,0] op_sel_hi:[0,1,1]
    v_pk_fma_f32 v[20:21], v[220:221], v[16:17], v[238:239] op_sel:[0,0,0] op_sel_hi:[0,1,1]
    v_pk_fma_f32 v[10:11], v[196:197], v[4:5], v[10:11] op_sel:[1,1,0] op_sel_hi:[1,0,1] neg_lo:[1,0,0]
    v_pk_fma_f32 v[18:19], v[208:209], v[8:9], v[18:19] op_sel:[1,1,0] op_sel_hi:[1,0,1] neg_lo:[1,0,0]
    v_pk_fma_f32 v[20:21], v[220:221], v[16:17], v[20:21] op_sel:[1,1,0] op_sel_hi:[1,0,1] neg_lo:[1,0,0]
    v_pk_fma_f32 v[4:5], v[196:197], v[10:11], v[52:53] op_sel:[0,0,0] op_sel_hi:[0,1,1]
    v_pk_fma_f32 v[8:9], v[208:209], v[18:19], v[68:69] op_sel:[0,0,0] op_sel_hi:[0,1,1]
    v_pk_fma_f32 v[16:17], v[220:221], v[20:21], v[240:241] op_sel:[0,0,0] op_sel_hi:[0,1,1]
    v_pk_fma_f32 v[4:5], v[196:197], v[10:11], v[4:5] op_sel:[1,1,0] op_sel_hi:[1,0,1] neg_lo:[1,0,0]
    v_pk_fma_f32 v[8:9], v[208:209], v[18:19], v[8:9] op_sel:[1,1,0] op_sel_hi:[1,0,1] neg_lo:[1,0,0]
    v_pk_fma_f32 v[16:17], v[220:221], v[20:21], v[16:17] op_sel:[1,1,0] op_sel_hi:[1,0,1] neg_lo:[1,0,0]
    v_pk_fma_f32 v[10:11], v[196:197], v[4:5], v[54:55] op_sel:[0,0,0] op_sel_hi:[0,1,1]
    v_pk_fma_f32 v[18:19], v[208:209], v[8:9], v[70:71] op_sel:[0,0,0] op_sel_hi:[0,1,1]
    buffer_load_dwordx4 a[104:107], v30, s[32:35], s56 offen offset:1024 sc1
    v_pk_fma_f32 v[20:21], v[220:221], v[16:17], v[242:243] op_sel:[0,0,0] op_sel_hi:[0,1,1]
    v_pk_fma_f32 v[10:11], v[196:197], v[4:5], v[10:11] op_sel:[1,1,0] op_sel_hi:[1,0,1] neg_lo:[1,0,0]
    v_pk_fma_f32 v[18:19], v[208:209], v[8:9], v[18:19] op_sel:[1,1,0] op_sel_hi:[1,0,1] neg_lo:[1,0,0]
    v_pk_fma_f32 v[20:21], v[220:221], v[16:17], v[20:21] op_sel:[1,1,0] op_sel_hi:[1,0,1] neg_lo:[1,0,0]
    v_pk_fma_f32 v[40:41], v[196:197], v[10:11], v[2:3] op_sel:[0,0,0] op_sel_hi:[0,1,1]
    v_pk_fma_f32 v[40:41], v[196:197], v[10:11], v[40:41] op_sel:[1,1,0] op_sel_hi:[1,0,1] neg_lo:[1,0,0]
    v_mov_b32 v42, s50
    v_mov_b32 v43, s51
    buffer_store_dwordx4 v[40:43], v39, s[32:35], s62 offen offset:0 sc1
    v_pk_fma_f32 v[56:57], v[208:209], v[18:19], v[6:7] op_sel:[0,0,0] op_sel_hi:[0,1,1]
    v_pk_fma_f32 v[56:57], v[208:209], v[18:19], v[56:57] op_sel:[1,1,0] op_sel_hi:[1,0,1] neg_lo:[1,0,0]
    v_mov_b32 v58, s50
    v_mov_b32 v59, s51
    buffer_store_dwordx4 v[56:59], v39, s[32:35], s62 offen offset:2048 sc1
    v_pk_fma_f32 v[228:229], v[220:221], v[20:21], v[14:15] op_sel:[0,0,0] op_sel_hi:[0,1,1]
    v_pk_fma_f32 v[228:229], v[220:221], v[20:21], v[228:229] op_sel:[1,1,0] op_sel_hi:[1,0,1] neg_lo:[1,0,0]
    buffer_load_dwordx4 a[108:111], v30, s[32:35], s56 offen offset:2048 sc1
    v_mov_b32 v230, s50
    v_mov_b32 v231, s51
    s_add_u32 s3, s62, 4096
    buffer_store_dwordx4 v[228:231], v39, s[32:35], s3 offen sc1
    buffer_load_dwordx4 a[112:115], v30, s[32:35], s56 offen offset:3072 sc1
    buffer_load_dwordx4 a[116:119], v31, s[32:35], s56 offen offset:0 sc1
    s_add_u32 s56, s88, 327680
    buffer_load_dwordx4 a[120:123], v30, s[32:35], s56 offen offset:0 sc1
    buffer_load_dwordx4 a[124:127], v30, s[32:35], s56 offen offset:1024 sc1
    buffer_load_dwordx4 a[128:131], v30, s[32:35], s56 offen offset:2048 sc1
    buffer_load_dwordx4 a[132:135], v30, s[32:35], s56 offen offset:3072 sc1
    buffer_load_dwordx4 a[136:139], v31, s[32:35], s56 offen offset:0 sc1
    s_add_u32 s56, s88, 491520
    buffer_load_dwordx4 a[140:143], v30, s[32:35], s56 offen offset:0 sc1
    buffer_load_dwordx4 a[144:147], v30, s[32:35], s56 offen offset:1024 sc1
    buffer_load_dwordx4 a[148:151], v30, s[32:35], s56 offen offset:2048 sc1
    buffer_load_dwordx4 a[152:155], v30, s[32:35], s56 offen offset:3072 sc1
    buffer_load_dwordx4 a[156:159], v31, s[32:35], s56 offen offset:0 sc1
    s_add_u32 s56, s88, 655360
    buffer_load_dwordx4 a[160:163], v30, s[32:35], s56 offen offset:0 sc1
    buffer_load_dwordx4 a[164:167], v30, s[32:35], s56 offen offset:1024 sc1
    buffer_load_dwordx4 a[168:171], v30, s[32:35], s56 offen offset:2048 sc1
    buffer_load_dwordx4 a[172:175], v30, s[32:35], s56 offen offset:3072 sc1
    buffer_load_dwordx4 a[176:179], v31, s[32:35], s56 offen offset:0 sc1
    s_add_u32 s56, s88, 819200
    buffer_load_dwordx4 a[180:183], v30, s[32:35], s56 offen offset:0 sc1
    buffer_load_dwordx4 a[184:187], v30, s[32:35], s56 offen offset:1024 sc1
    buffer_load_dwordx4 a[188:191], v30, s[32:35], s56 offen offset:2048 sc1
    s_add_u32 s56, s88, 819200
    buffer_load_dwordx4 a[192:195], v30, s[32:35], s56 offen offset:3072 sc1
    buffer_load_dwordx4 a[196:199], v31, s[32:35], s56 offen offset:0 sc1
    s_add_u32 s56, s88, 983040
    buffer_load_dwordx4 a[200:203], v30, s[32:35], s56 offen offset:0 sc1
    buffer_load_dwordx4 a[204:207], v30, s[32:35], s56 offen offset:1024 sc1
    buffer_load_dwordx4 a[208:211], v30, s[32:35], s56 offen offset:2048 sc1
    buffer_load_dwordx4 a[212:215], v30, s[32:35], s56 offen offset:3072 sc1
    buffer_load_dwordx4 a[216:219], v31, s[32:35], s56 offen offset:0 sc1
    s_add_u32 s56, s88, 1146880
    buffer_load_dwordx4 a[220:223], v30, s[32:35], s56 offen offset:0 sc1
    buffer_load_dwordx4 a[224:227], v30, s[32:35], s56 offen offset:1024 sc1
    buffer_load_dwordx4 a[228:231], v30, s[32:35], s56 offen offset:2048 sc1
    buffer_load_dwordx4 a[232:235], v30, s[32:35], s56 offen offset:3072 sc1
    buffer_load_dwordx4 a[236:239], v31, s[32:35], s56 offen offset:0 sc1
    buffer_load_dwordx4 v[44:47], v24, s[32:35], s55 offen offset:0 sc1
    buffer_load_dwordx4 v[48:51], v25, s[32:35], s55 offen offset:0 sc1
    buffer_load_dwordx4 v[60:63], v24, s[32:35], s55 offen offset:2048 sc1
    buffer_load_dwordx4 v[64:67], v25, s[32:35], s55 offen offset:2048 sc1
    buffer_load_dwordx4 v[232:235], v24, s[32:35], s58 offen offset:0 sc1
    buffer_load_dwordx4 v[236:239], v25, s[32:35], s58 offen offset:0 sc1
    s_waitcnt vmcnt(0)
    s_mov_b64 s[52:53], -1
    v_cmp_eq_u64 vcc, s[50:51], v[46:47]
    s_nop 0
    s_or_b64 vcc, vcc, s[84:85]
    s_and_b64 s[52:53], s[52:53], vcc
    v_cmp_eq_u64 vcc, s[50:51], v[50:51]
    s_nop 0
    s_or_b64 vcc, vcc, s[86:87]
    s_and_b64 s[52:53], s[52:53], vcc
    v_cmp_eq_u64 vcc, s[50:51], v[62:63]
    s_nop 0
    s_or_b64 vcc, vcc, s[84:85]
    s_and_b64 s[52:53], s[52:53], vcc
    v_cmp_eq_u64 vcc, s[50:51], v[66:67]
    s_nop 0
    s_or_b64 vcc, vcc, s[86:87]
    s_and_b64 s[52:53], s[52:53], vcc
    v_cmp_eq_u64 vcc, s[50:51], v[234:235]
    s_nop 0
    s_or_b64 vcc, vcc, s[84:85]
    s_and_b64 s[52:53], s[52:53], vcc
    v_cmp_eq_u64 vcc, s[50:51], v[238:239]
    s_nop 0
    s_or_b64 vcc, vcc, s[86:87]
    s_and_b64 s[52:53], s[52:53], vcc
    s_cmp_eq_u64 s[52:53], -1
    s_cbranch_scc0 L_aggslow_47
L_aggok_48:
    v_and_b32 v7, 3, v1
    v_lshl_add_u32 v7, v7, 2, s4
    v_min_u32 v7, 13, v7
    v_lshlrev_b32 v7, 7, v7
    s_lshl_b32 s58, s82, 12
    s_add_u32 s58, s58, 22052864
    v_lshlrev_b32 v15, 4, v1
    v_lshl_add_u32 v2, s4, 12, v15
    s_nop 0
    v_add_u32 v3, s63, v2
    s_mul_i32 s52, s82, 221184
    v_mul_f32 v46, v200, v44
    v_mul_f32 v62, v212, v60
    v_mul_f32 v234, v224, v232
    v_mul_f32 v47, v200, v45
    v_mul_f32 v63, v212, v61
    v_mul_f32 v235, v224, v233
    v_fma_f32 v46, -v201, v45, v46
    v_fma_f32 v62, -v213, v61, v62
    v_fma_f32 v234, -v225, v233, v234
    v_fmac_f32 v47, v201, v44
    v_fmac_f32 v63, v213, v60
    v_fmac_f32 v235, v225, v232
    v_fmac_f32 v46, v202, v48
    v_fmac_f32 v62, v214, v64
    v_fmac_f32 v234, v226, v236
    v_fmac_f32 v47, v202, v49
    v_fmac_f32 v63, v214, v65
    v_fmac_f32 v235, v226, v237
    v_fma_f32 v46, -v203, v49, v46
    v_fma_f32 v62, -v215, v65, v62
    v_fma_f32 v234, -v227, v237, v234
    v_fmac_f32 v47, v203, v48
    v_fmac_f32 v63, v215, v64
    v_fmac_f32 v235, v227, v236
    v_mov_b32 v44, v46
    v_mov_b32 v60, v62
    v_mov_b32 v232, v234
    v_mov_b32 v45, v47
    v_mov_b32 v61, v63
    v_mov_b32 v233, v235
    v_permlane16_swap_b32 v46, v44
    v_permlane16_swap_b32 v62, v60
    v_permlane16_swap_b32 v234, v232
    v_permlane16_swap_b32 v47, v45
    v_permlane16_swap_b32 v63, v61
    v_permlane16_swap_b32 v235, v233
    v_add_f32 v46, v46, v44
    v_add_f32 v62, v62, v60
    v_add_f32 v234, v234, v232
    v_add_f32 v47, v47, v45
    v_add_f32 v63, v63, v61
    v_add_f32 v235, v235, v233
    v_mov_b32 v44, v46
    v_mov_b32 v60, v62
    v_mov_b32 v232, v234
    v_mov_b32 v45, v47
    v_mov_b32 v61, v63
    v_mov_b32 v233, v235
    v_permlane32_swap_b32 v46, v44
    v_permlane32_swap_b32 v62, v60
    v_permlane32_swap_b32 v234, v232
    v_permlane32_swap_b32 v47, v45
    v_permlane32_swap_b32 v63, v61
    v_permlane32_swap_b32 v235, v233
    v_add_f32 v46, v46, v44
    v_add_f32 v62, v62, v60
    v_add_f32 v234, v234, v232
    v_add_f32 v47, v47, v45
    v_add_f32 v63, v63, v61
    v_add_f32 v235, v235, v233
    v_fmac_f32 v10, v198, v46
    v_fmac_f32 v18, v210, v62
    v_fmac_f32 v20, v222, v234
    v_fmac_f32 v11, v198, v47
    v_fmac_f32 v19, v210, v63
    v_fmac_f32 v21, v222, v235
    v_fma_f32 v10, -v199, v47, v10
    v_fma_f32 v18, -v211, v63, v18
    v_fma_f32 v20, -v223, v235, v20
    v_fmac_f32 v11, v199, v46
    v_fmac_f32 v19, v211, v62
    v_fmac_f32 v21, v223, v234
    v_pk_fma_f32 v[96:97], v[192:193], v[10:11], v[96:97] op_sel:[0,0,0] op_sel_hi:[0,1,1]
    v_pk_fma_f32 v[96:97], v[192:193], v[10:11], v[96:97] op_sel:[1,1,0] op_sel_hi:[1,0,1] neg_lo:[1,0,0]
    v_pk_fma_f32 v[112:113], v[192:193], v[96:97], v[112:113] op_sel:[0,0,0] op_sel_hi:[0,1,1]
    v_pk_fma_f32 v[112:113], v[192:193], v[96:97], v[112:113] op_sel:[1,1,0] op_sel_hi:[1,0,1] neg_lo:[1,0,0]
    v_cvt_pk_bf16_f32 v40, v96, v112
    v_cvt_pk_bf16_f32 v48, -v97, -v113
    v_pk_fma_f32 v[98:99], v[192:193], v[112:113], v[98:99] op_sel:[0,0,0] op_sel_hi:[0,1,1]
    v_pk_fma_f32 v[98:99], v[192:193], v[112:113], v[98:99] op_sel:[1,1,0] op_sel_hi:[1,0,1] neg_lo:[1,0,0]
    v_pk_fma_f32 v[114:115], v[192:193], v[98:99], v[114:115] op_sel:[0,0,0] op_sel_hi:[0,1,1]
    v_pk_fma_f32 v[114:115], v[192:193], v[98:99], v[114:115] op_sel:[1,1,0] op_sel_hi:[1,0,1] neg_lo:[1,0,0]
    v_cvt_pk_bf16_f32 v41, v98, v114
    v_cvt_pk_bf16_f32 v49, -v99, -v115
    v_pk_fma_f32 v[100:101], v[192:193], v[114:115], v[100:101] op_sel:[0,0,0] op_sel_hi:[0,1,1]
    v_pk_fma_f32 v[100:101], v[192:193], v[114:115], v[100:101] op_sel:[1,1,0] op_sel_hi:[1,0,1] neg_lo:[1,0,0]
    v_pk_fma_f32 v[116:117], v[192:193], v[100:101], v[116:117] op_sel:[0,0,0] op_sel_hi:[0,1,1]
    v_pk_fma_f32 v[116:117], v[192:193], v[100:101], v[116:117] op_sel:[1,1,0] op_sel_hi:[1,0,1] neg_lo:[1,0,0]
    v_cvt_pk_bf16_f32 v42, v100, v116
    v_cvt_pk_bf16_f32 v50, -v101, -v117
    v_pk_fma_f32 v[102:103], v[192:193], v[116:117], v[102:103] op_sel:[0,0,0] op_sel_hi:[0,1,1]
    v_pk_fma_f32 v[102:103], v[192:193], v[116:117], v[102:103] op_sel:[1,1,0] op_sel_hi:[1,0,1] neg_lo:[1,0,0]
    v_pk_fma_f32 v[118:119], v[192:193], v[102:103], v[118:119] op_sel:[0,0,0] op_sel_hi:[0,1,1]
    v_pk_fma_f32 v[118:119], v[192:193], v[102:103], v[118:119] op_sel:[1,1,0] op_sel_hi:[1,0,1] neg_lo:[1,0,0]
    v_cvt_pk_bf16_f32 v43, v102, v118
    v_cvt_pk_bf16_f32 v51, -v103, -v119
    v_pk_fma_f32 v[104:105], v[192:193], v[118:119], v[104:105] op_sel:[0,0,0] op_sel_hi:[0,1,1]
    v_pk_fma_f32 v[104:105], v[192:193], v[118:119], v[104:105] op_sel:[1,1,0] op_sel_hi:[1,0,1] neg_lo:[1,0,0]
    v_pk_fma_f32 v[120:121], v[192:193], v[104:105], v[120:121] op_sel:[0,0,0] op_sel_hi:[0,1,1]
    v_pk_fma_f32 v[120:121], v[192:193], v[104:105], v[120:121] op_sel:[1,1,0] op_sel_hi:[1,0,1] neg_lo:[1,0,0]
    v_cvt_pk_bf16_f32 v44, v104, v120
    v_cvt_pk_bf16_f32 v52, -v105, -v121
    v_pk_fma_f32 v[106:107], v[192:193], v[120:121], v[106:107] op_sel:[0,0,0] op_sel_hi:[0,1,1]
    v_pk_fma_f32 v[106:107], v[192:193], v[120:121], v[106:107] op_sel:[1,1,0] op_sel_hi:[1,0,1] neg_lo:[1,0,0]
    v_pk_fma_f32 v[122:123], v[192:193], v[106:107], v[122:123] op_sel:[0,0,0] op_sel_hi:[0,1,1]
    v_pk_fma_f32 v[122:123], v[192:193], v[106:107], v[122:123] op_sel:[1,1,0] op_sel_hi:[1,0,1] neg_lo:[1,0,0]
    v_cvt_pk_bf16_f32 v45, v106, v122
    v_cvt_pk_bf16_f32 v53, -v107, -v123
    v_pk_fma_f32 v[108:109], v[192:193], v[122:123], v[108:109] op_sel:[0,0,0] op_sel_hi:[0,1,1]
    v_pk_fma_f32 v[108:109], v[192:193], v[122:123], v[108:109] op_sel:[1,1,0] op_sel_hi:[1,0,1] neg_lo:[1,0,0]
    v_pk_fma_f32 v[124:125], v[192:193], v[108:109], v[124:125] op_sel:[0,0,0] op_sel_hi:[0,1,1]
    v_pk_fma_f32 v[124:125], v[192:193], v[108:109], v[124:125] op_sel:[1,1,0] op_sel_hi:[1,0,1] neg_lo:[1,0,0]
    v_cvt_pk_bf16_f32 v46, v108, v124
    v_cvt_pk_bf16_f32 v54, -v109, -v125
    v_pk_fma_f32 v[110:111], v[192:193], v[124:125], v[110:111] op_sel:[0,0,0] op_sel_hi:[0,1,1]
    v_pk_fma_f32 v[110:111], v[192:193], v[124:125], v[110:111] op_sel:[1,1,0] op_sel_hi:[1,0,1] neg_lo:[1,0,0]
    v_pk_fma_f32 v[126:127], v[192:193], v[110:111], v[126:127] op_sel:[0,0,0] op_sel_hi:[0,1,1]
    v_pk_fma_f32 v[126:127], v[192:193], v[110:111], v[126:127] op_sel:[1,1,0] op_sel_hi:[1,0,1] neg_lo:[1,0,0]
    v_cvt_pk_bf16_f32 v47, v110, v126
    v_cvt_pk_bf16_f32 v55, -v111, -v127
    ds_write_b128 v94, v[40:43] offset:0
    ds_write_b128 v94, v[44:47] offset:16
    ds_write_b128 v94, v[48:51] offset:2304
    ds_write_b128 v94, v[52:55] offset:2320
    ds_read_b64_tr_b16 v[40:41], v95 offset:0
    ds_read_b64_tr_b16 v[42:43], v95 offset:576
    ds_read_b64_tr_b16 v[44:45], v95 offset:16
    ds_read_b64_tr_b16 v[46:47], v95 offset:592
    ds_read_b64_tr_b16 v[48:49], v95 offset:32
    s_mov_b64 exec, 0xf
    buffer_load_dwordx2 v[8:9], v7, s[32:35], s58 offen sc1
    s_mov_b64 exec, -1
    ds_read_b64_tr_b16 v[50:51], v95 offset:608
    ds_read_b64_tr_b16 v[52:53], v95 offset:48
    ds_read_b64_tr_b16 v[54:55], v95 offset:624
    v_pk_fma_f32 v[128:129], v[204:205], v[18:19], v[128:129] op_sel:[0,0,0] op_sel_hi:[0,1,1]
    v_pk_fma_f32 v[128:129], v[204:205], v[18:19], v[128:129] op_sel:[1,1,0] op_sel_hi:[1,0,1] neg_lo:[1,0,0]
    v_pk_fma_f32 v[144:145], v[204:205], v[128:129], v[144:145] op_sel:[0,0,0] op_sel_hi:[0,1,1]
    v_pk_fma_f32 v[144:145], v[204:205], v[128:129], v[144:145] op_sel:[1,1,0] op_sel_hi:[1,0,1] neg_lo:[1,0,0]
    v_cvt_pk_bf16_f32 v56, v128, v144
    v_cvt_pk_bf16_f32 v64, -v129, -v145
    v_pk_fma_f32 v[130:131], v[204:205], v[144:145], v[130:131] op_sel:[0,0,0] op_sel_hi:[0,1,1]
    v_pk_fma_f32 v[130:131], v[204:205], v[144:145], v[130:131] op_sel:[1,1,0] op_sel_hi:[1,0,1] neg_lo:[1,0,0]
    v_pk_fma_f32 v[146:147], v[204:205], v[130:131], v[146:147] op_sel:[0,0,0] op_sel_hi:[0,1,1]
    v_pk_fma_f32 v[146:147], v[204:205], v[130:131], v[146:147] op_sel:[1,1,0] op_sel_hi:[1,0,1] neg_lo:[1,0,0]
    v_cvt_pk_bf16_f32 v57, v130, v146
    v_cvt_pk_bf16_f32 v65, -v131, -v147
    v_pk_fma_f32 v[132:133], v[204:205], v[146:147], v[132:133] op_sel:[0,0,0] op_sel_hi:[0,1,1]
    v_pk_fma_f32 v[132:133], v[204:205], v[146:147], v[132:133] op_sel:[1,1,0] op_sel_hi:[1,0,1] neg_lo:[1,0,0]
    s_waitcnt lgkmcnt(0)
    buffer_store_dwordx4 v[40:43], v23, s[32:35], s90 offen offset:0 sc1
    v_pk_fma_f32 v[148:149], v[204:205], v[132:133], v[148:149] op_sel:[0,0,0] op_sel_hi:[0,1,1]
    v_pk_fma_f32 v[148:149], v[204:205], v[132:133], v[148:149] op_sel:[1,1,0] op_sel_hi:[1,0,1] neg_lo:[1,0,0]
    v_cvt_pk_bf16_f32 v58, v132, v148
    v_cvt_pk_bf16_f32 v66, -v133, -v149
    v_pk_fma_f32 v[134:135], v[204:205], v[148:149], v[134:135] op_sel:[0,0,0] op_sel_hi:[0,1,1]
    v_pk_fma_f32 v[134:135], v[204:205], v[148:149], v[134:135] op_sel:[1,1,0] op_sel_hi:[1,0,1] neg_lo:[1,0,0]
    v_pk_fma_f32 v[150:151], v[204:205], v[134:135], v[150:151] op_sel:[0,0,0] op_sel_hi:[0,1,1]
    v_pk_fma_f32 v[150:151], v[204:205], v[134:135], v[150:151] op_sel:[1,1,0] op_sel_hi:[1,0,1] neg_lo:[1,0,0]
    v_cvt_pk_bf16_f32 v59, v134, v150
    v_cvt_pk_bf16_f32 v67, -v135, -v151
    buffer_store_dwordx4 v[44:47], v23, s[32:35], s90 offen offset:1024 sc1
    v_pk_fma_f32 v[136:137], v[204:205], v[150:151], v[136:137] op_sel:[0,0,0] op_sel_hi:[0,1,1]
    v_pk_fma_f32 v[136:137], v[204:205], v[150:151], v[136:137] op_sel:[1,1,0] op_sel_hi:[1,0,1] neg_lo:[1,0,0]
    v_pk_fma_f32 v[152:153], v[204:205], v[136:137], v[152:153] op_sel:[0,0,0] op_sel_hi:[0,1,1]
    v_pk_fma_f32 v[152:153], v[204:205], v[136:137], v[152:153] op_sel:[1,1,0] op_sel_hi:[1,0,1] neg_lo:[1,0,0]
    v_cvt_pk_bf16_f32 v60, v136, v152
    v_cvt_pk_bf16_f32 v68, -v137, -v153
    v_pk_fma_f32 v[138:139], v[204:205], v[152:153], v[138:139] op_sel:[0,0,0] op_sel_hi:[0,1,1]
    v_pk_fma_f32 v[138:139], v[204:205], v[152:153], v[138:139] op_sel:[1,1,0] op_sel_hi:[1,0,1] neg_lo:[1,0,0]
    v_pk_fma_f32 v[154:155], v[204:205], v[138:139], v[154:155] op_sel:[0,0,0] op_sel_hi:[0,1,1]
    v_pk_fma_f32 v[154:155], v[204:205], v[138:139], v[154:155] op_sel:[1,1,0] op_sel_hi:[1,0,1] neg_lo:[1,0,0]
    buffer_store_dwordx4 v[48:51], v23, s[32:35], s90 offen offset:2048 sc1
    v_cvt_pk_bf16_f32 v61, v138, v154
    v_cvt_pk_bf16_f32 v69, -v139, -v155
    v_pk_fma_f32 v[140:141], v[204:205], v[154:155], v[140:141] op_sel:[0,0,0] op_sel_hi:[0,1,1]
    v_pk_fma_f32 v[140:141], v[204:205], v[154:155], v[140:141] op_sel:[1,1,0] op_sel_hi:[1,0,1] neg_lo:[1,0,0]
    v_pk_fma_f32 v[156:157], v[204:205], v[140:141], v[156:157] op_sel:[0,0,0] op_sel_hi:[0,1,1]
    v_pk_fma_f32 v[156:157], v[204:205], v[140:141], v[156:157] op_sel:[1,1,0] op_sel_hi:[1,0,1] neg_lo:[1,0,0]
    v_cvt_pk_bf16_f32 v62, v140, v156
    v_cvt_pk_bf16_f32 v70, -v141, -v157
    v_pk_fma_f32 v[142:143], v[204:205], v[156:157], v[142:143] op_sel:[0,0,0] op_sel_hi:[0,1,1]
    v_pk_fma_f32 v[142:143], v[204:205], v[156:157], v[142:143] op_sel:[1,1,0] op_sel_hi:[1,0,1] neg_lo:[1,0,0]
    buffer_store_dwordx4 v[52:55], v23, s[32:35], s90 offen offset:3072 sc1
    v_pk_fma_f32 v[158:159], v[204:205], v[142:143], v[158:159] op_sel:[0,0,0] op_sel_hi:[0,1,1]
    v_pk_fma_f32 v[158:159], v[204:205], v[142:143], v[158:159] op_sel:[1,1,0] op_sel_hi:[1,0,1] neg_lo:[1,0,0]
    v_cvt_pk_bf16_f32 v63, v142, v158
    v_cvt_pk_bf16_f32 v71, -v143, -v159
    ds_write_b128 v94, v[56:59] offset:0
    ds_write_b128 v94, v[60:63] offset:16
    ds_write_b128 v94, v[64:67] offset:2304
    ds_write_b128 v94, v[68:71] offset:2320
    ds_read_b64_tr_b16 v[56:57], v95 offset:0
    ds_read_b64_tr_b16 v[58:59], v95 offset:576
    ds_read_b64_tr_b16 v[60:61], v95 offset:16
    ds_read_b64_tr_b16 v[62:63], v95 offset:592
    ds_read_b64_tr_b16 v[64:65], v95 offset:32
    ds_read_b64_tr_b16 v[66:67], v95 offset:608
    ds_read_b64_tr_b16 v[68:69], v95 offset:48
    ds_read_b64_tr_b16 v[70:71], v95 offset:624
    v_pk_fma_f32 v[160:161], v[216:217], v[20:21], v[160:161] op_sel:[0,0,0] op_sel_hi:[0,1,1]
    v_pk_fma_f32 v[160:161], v[216:217], v[20:21], v[160:161] op_sel:[1,1,0] op_sel_hi:[1,0,1] neg_lo:[1,0,0]
    v_pk_fma_f32 v[176:177], v[216:217], v[160:161], v[176:177] op_sel:[0,0,0] op_sel_hi:[0,1,1]
    v_pk_fma_f32 v[176:177], v[216:217], v[160:161], v[176:177] op_sel:[1,1,0] op_sel_hi:[1,0,1] neg_lo:[1,0,0]
    v_cvt_pk_bf16_f32 v228, v160, v176
    v_cvt_pk_bf16_f32 v236, -v161, -v177
    v_pk_fma_f32 v[162:163], v[216:217], v[176:177], v[162:163] op_sel:[0,0,0] op_sel_hi:[0,1,1]
    v_pk_fma_f32 v[162:163], v[216:217], v[176:177], v[162:163] op_sel:[1,1,0] op_sel_hi:[1,0,1] neg_lo:[1,0,0]
    v_pk_fma_f32 v[178:179], v[216:217], v[162:163], v[178:179] op_sel:[0,0,0] op_sel_hi:[0,1,1]
    v_pk_fma_f32 v[178:179], v[216:217], v[162:163], v[178:179] op_sel:[1,1,0] op_sel_hi:[1,0,1] neg_lo:[1,0,0]
    v_cvt_pk_bf16_f32 v229, v162, v178
    v_cvt_pk_bf16_f32 v237, -v163, -v179
    v_pk_fma_f32 v[164:165], v[216:217], v[178:179], v[164:165] op_sel:[0,0,0] op_sel_hi:[0,1,1]
    v_pk_fma_f32 v[164:165], v[216:217], v[178:179], v[164:165] op_sel:[1,1,0] op_sel_hi:[1,0,1] neg_lo:[1,0,0]
    s_add_u32 s90, s90, 4096
    s_add_u32 s3, s54, 1
    s_cmp_lt_u32 s3, 40
    s_cselect_b32 s3, 0, 2130706432
    v_or_b32 v23, s3, v23
    s_waitcnt lgkmcnt(0)
    buffer_store_dwordx4 v[56:59], v23, s[32:35], s90 offen offset:0 sc1
    v_pk_fma_f32 v[180:181], v[216:217], v[164:165], v[180:181] op_sel:[0,0,0] op_sel_hi:[0,1,1]
    v_pk_fma_f32 v[180:181], v[216:217], v[164:165], v[180:181] op_sel:[1,1,0] op_sel_hi:[1,0,1] neg_lo:[1,0,0]
    v_cvt_pk_bf16_f32 v230, v164, v180
    v_cvt_pk_bf16_f32 v238, -v165, -v181
    v_pk_fma_f32 v[166:167], v[216:217], v[180:181], v[166:167] op_sel:[0,0,0] op_sel_hi:[0,1,1]
    v_pk_fma_f32 v[166:167], v[216:217], v[180:181], v[166:167] op_sel:[1,1,0] op_sel_hi:[1,0,1] neg_lo:[1,0,0]
    v_pk_fma_f32 v[182:183], v[216:217], v[166:167], v[182:183] op_sel:[0,0,0] op_sel_hi:[0,1,1]
    v_pk_fma_f32 v[182:183], v[216:217], v[166:167], v[182:183] op_sel:[1,1,0] op_sel_hi:[1,0,1] neg_lo:[1,0,0]
    v_cvt_pk_bf16_f32 v231, v166, v182
    v_cvt_pk_bf16_f32 v239, -v167, -v183
    buffer_store_dwordx4 v[60:63], v23, s[32:35], s90 offen offset:1024 sc1
    v_pk_fma_f32 v[168:169], v[216:217], v[182:183], v[168:169] op_sel:[0,0,0] op_sel_hi:[0,1,1]
    v_pk_fma_f32 v[168:169], v[216:217], v[182:183], v[168:169] op_sel:[1,1,0] op_sel_hi:[1,0,1] neg_lo:[1,0,0]
    v_pk_fma_f32 v[184:185], v[216:217], v[168:169], v[184:185] op_sel:[0,0,0] op_sel_hi:[0,1,1]
    v_pk_fma_f32 v[184:185], v[216:217], v[168:169], v[184:185] op_sel:[1,1,0] op_sel_hi:[1,0,1] neg_lo:[1,0,0]
    v_cvt_pk_bf16_f32 v232, v168, v184
    v_cvt_pk_bf16_f32 v240, -v169, -v185
    v_pk_fma_f32 v[170:171], v[216:217], v[184:185], v[170:171] op_sel:[0,0,0] op_sel_hi:[0,1,1]
    v_pk_fma_f32 v[170:171], v[216:217], v[184:185], v[170:171] op_sel:[1,1,0] op_sel_hi:[1,0,1] neg_lo:[1,0,0]
    v_pk_fma_f32 v[186:187], v[216:217], v[170:171], v[186:187] op_sel:[0,0,0] op_sel_hi:[0,1,1]
    v_pk_fma_f32 v[186:187], v[216:217], v[170:171], v[186:187] op_sel:[1,1,0] op_sel_hi:[1,0,1] neg_lo:[1,0,0]
    buffer_store_dwordx4 v[64:67], v23, s[32:35], s90 offen offset:2048 sc1
    v_cvt_pk_bf16_f32 v233, v170, v186
    v_cvt_pk_bf16_f32 v241, -v171, -v187
    v_pk_fma_f32 v[172:173], v[216:217], v[186:187], v[172:173] op_sel:[0,0,0] op_sel_hi:[0,1,1]
    v_pk_fma_f32 v[172:173], v[216:217], v[186:187], v[172:173] op_sel:[1,1,0] op_sel_hi:[1,0,1] neg_lo:[1,0,0]
    v_pk_fma_f32 v[188:189], v[216:217], v[172:173], v[188:189] op_sel:[0,0,0] op_sel_hi:[0,1,1]
    v_pk_fma_f32 v[188:189], v[216:217], v[172:173], v[188:189] op_sel:[1,1,0] op_sel_hi:[1,0,1] neg_lo:[1,0,0]
    v_cvt_pk_bf16_f32 v234, v172, v188
    v_cvt_pk_bf16_f32 v242, -v173, -v189
    v_pk_fma_f32 v[174:175], v[216:217], v[188:189], v[174:175] op_sel:[0,0,0] op_sel_hi:[0,1,1]
    v_pk_fma_f32 v[174:175], v[216:217], v[188:189], v[174:175] op_sel:[1,1,0] op_sel_hi:[1,0,1] neg_lo:[1,0,0]
    buffer_store_dwordx4 v[68:71], v23, s[32:35], s90 offen offset:3072 sc1
    v_pk_fma_f32 v[190:191], v[216:217], v[174:175], v[190:191] op_sel:[0,0,0] op_sel_hi:[0,1,1]
    v_pk_fma_f32 v[190:191], v[216:217], v[174:175], v[190:191] op_sel:[1,1,0] op_sel_hi:[1,0,1] neg_lo:[1,0,0]
    v_cvt_pk_bf16_f32 v235, v174, v190
    v_cvt_pk_bf16_f32 v243, -v175, -v191
    ds_write_b128 v94, v[228:231] offset:0
    ds_write_b128 v94, v[232:235] offset:16
    ds_write_b128 v94, v[236:239] offset:2304
    ds_write_b128 v94, v[240:243] offset:2320
    ds_read_b64_tr_b16 v[228:229], v95 offset:0
    ds_read_b64_tr_b16 v[230:231], v95 offset:576
    ds_read_b64_tr_b16 v[232:233], v95 offset:16
    ds_read_b64_tr_b16 v[234:235], v95 offset:592
    ds_read_b64_tr_b16 v[236:237], v95 offset:32
    ds_read_b64_tr_b16 v[238:239], v95 offset:608
    ds_read_b64_tr_b16 v[240:241], v95 offset:48
    ds_read_b64_tr_b16 v[242:243], v95 offset:624
    s_waitcnt vmcnt(8)
    v_cmp_eq_u64 vcc, s[50:51], v[8:9]
    s_nop 0
    s_and_b32 s3, vcc_lo, 0xf
    s_cmp_eq_u32 s3, 0xf
    s_cselect_b32 s62, 0, 2130706432
    v_or_b32 v4, s62, v2
    v_or_b32 v5, s62, v3
    s_add_u32 s55, s66, 0
    buffer_load_dwordx4 v[96:99], v4, s[32:35], s55 offen sc1
    s_add_u32 s55, s67, 0
    buffer_load_dwordx4 v[100:103], v4, s[32:35], s55 offen sc1
    s_add_u32 s55, s68, 0
    buffer_load_dwordx4 v[104:107], v4, s[32:35], s55 offen sc1
    s_add_u32 s55, s69, 0
    buffer_load_dwordx4 v[108:111], v4, s[32:35], s55 offen sc1
    s_add_u32 s55, s66, 16384
    buffer_load_dwordx4 v[112:115], v4, s[32:35], s55 offen sc1
    s_add_u32 s55, s67, 16384
    buffer_load_dwordx4 v[116:119], v4, s[32:35], s55 offen sc1
    s_add_u32 s55, s68, 16384
    buffer_load_dwordx4 v[120:123], v4, s[32:35], s55 offen sc1
    s_add_u32 s55, s69, 16384
    buffer_load_dwordx4 v[124:127], v4, s[32:35], s55 offen sc1
    s_add_u32 s90, s90, 4096
    s_add_u32 s3, s54, 2
    s_cmp_lt_u32 s3, 40
    s_cselect_b32 s3, 0, 2130706432
    v_or_b32 v23, s3, v23
    s_waitcnt lgkmcnt(0)
    buffer_store_dwordx4 v[228:231], v23, s[32:35], s90 offen offset:0 sc1
    buffer_store_dwordx4 v[232:235], v23, s[32:35], s90 offen offset:1024 sc1
    buffer_store_dwordx4 v[236:239], v23, s[32:35], s90 offen offset:2048 sc1
    buffer_store_dwordx4 v[240:243], v23, s[32:35], s90 offen offset:3072 sc1
    v_mov_b32 v48, v80
    v_mov_b32 v49, v81
    v_mov_b32 v50, v82
    v_mov_b32 v51, v83
    v_mov_b32 v52, v84
    v_mov_b32 v53, v85
    v_mov_b32 v54, v86
    v_mov_b32 v55, v87
    v_mov_b32 v56, v88
    v_mov_b32 v57, v89
    s_nop 4
    s_branch L_p1done
L_tagslow_6:
    s_nop 7
    s_nop 3
    s_mov_b32 s3, 0
L_tag_8:
    s_add_u32 s3, s3, 1
    s_cmp_gt_u32 s3, 200000
    s_cbranch_scc1 L_tagok_7
    v_mov_b32 v93, 0
    s_mov_b64 exec, 0x1
    buffer_load_dwordx2 v[92:93], v93, s[40:43], 0 offen sc1
    s_mov_b64 exec, -1
    s_waitcnt vmcnt(0)
    v_readfirstlane_b32 s50, v92
    v_readfirstlane_b32 s51, v93
    s_nop 0
    s_cmp_lg_u64 s[50:51], 0
    s_cbranch_scc1 L_tagok_7
    s_sleep 1
    s_branch L_tag_8
L_prslow_9:
    s_nop 7
    s_nop 3
    s_mov_b32 s7, 0
L_pr_11:
    s_add_u32 s7, s7, 1
    s_cmp_gt_u32 s7, 200000
    s_cbranch_scc1 L_prok_10
    s_mov_b64 exec, 0x7ff
    buffer_load_dwordx2 v[92:93], v73, s[32:35], s53 offen sc1
    s_mov_b64 exec, -1
    s_waitcnt vmcnt(0)
    v_cmp_eq_u64 vcc, s[50:51], v[92:93]
    s_nop 0
    s_and_b32 s3, vcc_lo, 0x7ff
    s_cmp_eq_u32 s3, 0x7ff
    s_cbranch_scc1 L_prok_10
    s_sleep 6
    s_branch L_pr_11
L_aggslow_12:
    s_nop 7
    s_nop 3
    s_mov_b32 s61, 0
L_agg_14:
    s_add_u32 s61, s61, 1
    s_cmp_gt_u32 s61, 200000
    s_cbranch_scc1 L_aggok_13
    s_waitcnt vmcnt(0)
    s_add_u32 s3, s91, 22052864
    buffer_store_dwordx2 v[36:37], v38, s[32:35], s3 offen sc1
    buffer_load_dwordx4 v[68:71], v24, s[32:35], s55 offen offset:0 sc1
    buffer_load_dwordx4 v[72:75], v25, s[32:35], s55 offen offset:0 sc1
    s_waitcnt vmcnt(0)
    s_mov_b64 s[52:53], -1
    v_cmp_eq_u64 vcc, s[50:51], v[70:71]
    s_nop 0
    s_or_b64 vcc, vcc, s[84:85]
    s_and_b64 s[52:53], s[52:53], vcc
    v_cmp_eq_u64 vcc, s[50:51], v[74:75]
    s_nop 0
    s_or_b64 vcc, vcc, s[86:87]
    s_and_b64 s[52:53], s[52:53], vcc
    s_cmp_eq_u64 s[52:53], -1
    s_cbranch_scc1 L_aggok_13
    s_sleep 2
    s_branch L_agg_14
L_gateslow_15:
    s_nop 7
    s_nop 3
    s_mov_b64 exec, 0xf
    buffer_load_dwordx2 v[8:9], v7, s[32:35], s58 offen sc1
    s_mov_b64 exec, -1
    s_waitcnt vmcnt(0)
    s_add_u32 s3, s91, 22315008
    buffer_store_dwordx2 v[12:13], v14, s[32:35], s3 offen sc1
    v_cmp_eq_u64 vcc, s[50:51], v[8:9]
    s_nop 0
    s_and_b32 s3, vcc_lo, 0xf
    s_cmp_eq_u32 s3, 0xf
    s_cbranch_scc1 L_gateredo_17
    s_mov_b32 s61, 0
L_g_18:
    s_add_u32 s61, s61, 1
    s_cmp_gt_u32 s61, 200000
    s_cbranch_scc1 L_gateredo_17
    s_mov_b64 exec, 0xf
    buffer_load_dwordx2 v[8:9], v7, s[32:35], s58 offen sc1
    s_mov_b64 exec, -1
    s_waitcnt vmcnt(0)
    v_cmp_eq_u64 vcc, s[50:51], v[8:9]
    s_nop 0
    s_and_b32 s3, vcc_lo, 0xf
    s_cmp_eq_u32 s3, 0xf
    s_cbranch_scc1 L_gateredo_17
    s_sleep 1
    s_branch L_g_18
L_gateredo_17:
    s_add_u32 s55, s66, 0
    buffer_load_dwordx4 v[96:99], v2, s[32:35], s55 offen sc1
    s_add_u32 s55, s67, 0
    buffer_load_dwordx4 v[100:103], v2, s[32:35], s55 offen sc1
    s_add_u32 s55, s68, 0
    buffer_load_dwordx4 v[104:107], v2, s[32:35], s55 offen sc1
    s_add_u32 s55, s69, 0
    buffer_load_dwordx4 v[108:111], v2, s[32:35], s55 offen sc1
    s_add_u32 s55, s66, 16384
    buffer_load_dwordx4 v[112:115], v2, s[32:35], s55 offen sc1
    s_add_u32 s55, s67, 16384
    buffer_load_dwordx4 v[116:119], v2, s[32:35], s55 offen sc1
    s_add_u32 s55, s68, 16384
    buffer_load_dwordx4 v[120:123], v2, s[32:35], s55 offen sc1
    s_add_u32 s55, s69, 16384
    buffer_load_dwordx4 v[124:127], v2, s[32:35], s55 offen sc1
    s_branch L_gateok_16
L_gateslow_19:
    s_nop 7
    s_nop 3
    s_mov_b32 s61, 0
L_g_22:
    s_add_u32 s61, s61, 1
    s_cmp_gt_u32 s61, 200000
    s_cbranch_scc1 L_gateredo_21
    s_mov_b64 exec, 0x7
    buffer_load_dwordx2 v[8:9], v89, s[32:35], s60 offen sc1
    s_mov_b64 exec, -1
    s_waitcnt vmcnt(0)
    v_cmp_eq_u64 vcc, s[50:51], v[8:9]
    s_nop 0
    s_and_b32 s3, vcc_lo, 0x7
    s_cmp_eq_u32 s3, 0x7
    s_cbranch_scc1 L_gateredo_21
    s_sleep 1
    s_branch L_g_22
L_gateredo_21:
    s_add_u32 s55, s70, 0
    buffer_load_dwordx4 v[16:19], v2, s[32:35], s55 offen sc1
    s_add_u32 s55, s71, 0
    buffer_load_dwordx4 v[20:23], v2, s[32:35], s55 offen sc1
    s_add_u32 s55, s72, 0
    buffer_load_dwordx4 v[24:27], v2, s[32:35], s55 offen sc1
    s_add_u32 s55, s73, 0
    buffer_load_dwordx4 v[28:31], v2, s[32:35], s55 offen sc1
    s_add_u32 s55, s70, 16384
    buffer_load_dwordx4 v[32:35], v2, s[32:35], s55 offen sc1
    s_add_u32 s55, s71, 16384
    buffer_load_dwordx4 v[36:39], v2, s[32:35], s55 offen sc1
    s_waitcnt vmcnt(0)
    s_branch L_gateok_20
L_gateslow_23:
    s_nop 7
    s_nop 3
    s_mov_b32 s61, 0
L_g_26:
    s_add_u32 s61, s61, 1
    s_cmp_gt_u32 s61, 200000
    s_cbranch_scc1 L_gateredo_25
    s_mov_b64 exec, 0x38
    buffer_load_dwordx2 v[62:63], v89, s[32:35], s60 offen sc1
    s_mov_b64 exec, -1
    s_waitcnt vmcnt(0)
    v_cmp_eq_u64 vcc, s[50:51], v[62:63]
    s_nop 0
    s_and_b32 s3, vcc_lo, 0x38
    s_cmp_eq_u32 s3, 0x38
    s_cbranch_scc1 L_gateredo_25
    s_sleep 1
    s_branch L_g_26
L_gateredo_25:
    s_add_u32 s55, s70, 49152
    buffer_load_dwordx4 a[0:3], v2, s[32:35], s55 offen sc1
    s_add_u32 s55, s71, 49152
    buffer_load_dwordx4 a[4:7], v2, s[32:35], s55 offen sc1
    s_add_u32 s55, s72, 49152
    buffer_load_dwordx4 a[8:11], v2, s[32:35], s55 offen sc1
    s_add_u32 s55, s73, 49152
    buffer_load_dwordx4 a[12:15], v2, s[32:35], s55 offen sc1
    s_add_u32 s55, s70, 65536
    buffer_load_dwordx4 a[16:19], v2, s[32:35], s55 offen sc1
    s_add_u32 s55, s71, 65536
    buffer_load_dwordx4 a[20:23], v2, s[32:35], s55 offen sc1
    s_waitcnt vmcnt(0)
    s_branch L_gateok_24
L_gateslow_27:
    s_nop 7
    s_nop 3
    s_mov_b32 s61, 0
L_g_30:
    s_add_u32 s61, s61, 1
    s_cmp_gt_u32 s61, 200000
    s_cbranch_scc1 L_gateredo_29
    s_mov_b64 exec, 0x1fffc0
    buffer_load_dwordx2 v[8:9], v89, s[32:35], s60 offen sc1
    s_mov_b64 exec, -1
    s_waitcnt vmcnt(0)
    v_cmp_eq_u64 vcc, s[50:51], v[8:9]
    s_nop 0
    s_and_b32 s3, vcc_lo, 0x1fffc0
    s_cmp_eq_u32 s3, 0x1fffc0
    s_cbranch_scc1 L_gateredo_29
    s_sleep 1
    s_branch L_g_30
L_gateredo_29:
    s_add_u32 s55, s70, 98304
    buffer_load_dwordx4 v[24:27], v2, s[32:35], s55 offen sc1
    s_add_u32 s55, s70, 114688
    buffer_load_dwordx4 v[28:31], v2, s[32:35], s55 offen sc1
    s_add_u32 s55, s70, 131072
    buffer_load_dwordx4 v[32:35], v2, s[32:35], s55 offen sc1
    s_add_u32 s55, s70, 147456
    buffer_load_dwordx4 v[36:39], v2, s[32:35], s55 offen sc1
    s_add_u32 s55, s71, 98304
    buffer_load_dwordx4 v[40:43], v2, s[32:35], s55 offen sc1
    s_add_u32 s55, s71, 114688
    buffer_load_dwordx4 v[44:47], v2, s[32:35], s55 offen sc1
    s_add_u32 s55, s71, 131072
    buffer_load_dwordx4 a[240:243], v2, s[32:35], s55 offen sc1
    s_add_u32 s55, s71, 147456
    buffer_load_dwordx4 a[244:247], v2, s[32:35], s55 offen sc1
    s_add_u32 s55, s72, 98304
    buffer_load_dwordx4 a[248:251], v2, s[32:35], s55 offen sc1
    s_add_u32 s55, s72, 114688
    buffer_load_dwordx4 a[252:255], v2, s[32:35], s55 offen sc1
    s_add_u32 s55, s72, 131072
    buffer_load_dwordx4 a[0:3], v2, s[32:35], s55 offen sc1
    s_add_u32 s55, s72, 147456
    buffer_load_dwordx4 a[4:7], v2, s[32:35], s55 offen sc1
    s_add_u32 s55, s73, 98304
    buffer_load_dwordx4 a[8:11], v2, s[32:35], s55 offen sc1
    s_waitcnt vmcnt(0)
    s_branch L_gateok_28
L_gateslow_31:
    s_nop 7
    s_nop 3
    s_mov_b32 s61, 0
L_g_34:
    s_add_u32 s61, s61, 1
    s_cmp_gt_u32 s61, 200000
    s_cbranch_scc1 L_gateredo_33
    s_mov_b64 exec, 0x1
    buffer_load_dwordx2 v[8:9], v14, s[32:35], s58 offen sc1
    s_mov_b64 exec, -1
    s_waitcnt vmcnt(0)
    v_cmp_eq_u64 vcc, s[50:51], v[8:9]
    s_nop 0
    s_and_b32 s3, vcc_lo, 0x1
    s_cmp_eq_u32 s3, 0x1
    s_cbranch_scc1 L_gateredo_33
    s_sleep 1
    s_branch L_g_34
L_gateredo_33:
    buffer_load_dwordx4 v[64:67], v15, s[32:35], s56 offen offset:0 sc1
    buffer_load_dwordx4 v[68:71], v15, s[32:35], s56 offen offset:1024 sc1
    buffer_load_dwordx4 v[72:75], v15, s[32:35], s56 offen offset:2048 sc1
    buffer_load_dwordx4 v[76:79], v15, s[32:35], s56 offen offset:3072 sc1
    buffer_load_dwordx4 v[80:83], v62, s[32:35], s56 offen offset:0 sc1
    s_waitcnt vmcnt(0)
    s_branch L_gateok_32
L_tagslow_40:
    s_nop 7
    s_nop 3
    s_mov_b32 s3, 0
L_tag_42:
    s_add_u32 s3, s3, 1
    s_cmp_gt_u32 s3, 200000
    s_cbranch_scc1 L_tagok_41
    v_mov_b32 v93, 0
    s_mov_b64 exec, 0x1
    buffer_load_dwordx2 v[92:93], v93, s[40:43], 0 offen sc1
    s_mov_b64 exec, -1
    s_waitcnt vmcnt(0)
    v_readfirstlane_b32 s50, v92
    v_readfirstlane_b32 s51, v93
    s_nop 0
    s_cmp_lg_u64 s[50:51], 0
    s_cbranch_scc1 L_tagok_41
    s_sleep 1
    s_branch L_tag_42
L_prslow_43:
    s_nop 7
    s_nop 3
    s_mov_b32 s7, 0
L_pr_45:
    s_add_u32 s7, s7, 1
    s_cmp_gt_u32 s7, 200000
    s_cbranch_scc1 L_prok_44
    s_mov_b64 exec, 0x7ff
    buffer_load_dwordx2 v[92:93], v73, s[32:35], s53 offen sc1
    s_mov_b64 exec, -1
    s_waitcnt vmcnt(0)
    v_cmp_eq_u64 vcc, s[50:51], v[92:93]
    s_nop 0
    s_and_b32 s3, vcc_lo, 0x7ff
    s_cmp_eq_u32 s3, 0x7ff
    s_cbranch_scc1 L_prok_44
    s_sleep 6
    s_branch L_pr_45
L_aggslow_47:
    s_nop 7
    s_nop 3
    s_mov_b32 s61, 0
L_agg_49:
    s_add_u32 s61, s61, 1
    s_cmp_gt_u32 s61, 200000
    s_cbranch_scc1 L_aggok_48
    buffer_load_dwordx4 v[44:47], v24, s[32:35], s55 offen offset:0 sc1
    buffer_load_dwordx4 v[48:51], v25, s[32:35], s55 offen offset:0 sc1
    buffer_load_dwordx4 v[60:63], v24, s[32:35], s55 offen offset:2048 sc1
    buffer_load_dwordx4 v[64:67], v25, s[32:35], s55 offen offset:2048 sc1
    buffer_load_dwordx4 v[232:235], v24, s[32:35], s58 offen offset:0 sc1
    buffer_load_dwordx4 v[236:239], v25, s[32:35], s58 offen offset:0 sc1
    s_waitcnt vmcnt(0)
    s_mov_b64 s[52:53], -1
    v_cmp_eq_u64 vcc, s[50:51], v[46:47]
    s_nop 0
    s_or_b64 vcc, vcc, s[84:85]
    s_and_b64 s[52:53], s[52:53], vcc
    v_cmp_eq_u64 vcc, s[50:51], v[50:51]
    s_nop 0
    s_or_b64 vcc, vcc, s[86:87]
    s_and_b64 s[52:53], s[52:53], vcc
    v_cmp_eq_u64 vcc, s[50:51], v[62:63]
    s_nop 0
    s_or_b64 vcc, vcc, s[84:85]
    s_and_b64 s[52:53], s[52:53], vcc
    v_cmp_eq_u64 vcc, s[50:51], v[66:67]
    s_nop 0
    s_or_b64 vcc, vcc, s[86:87]
    s_and_b64 s[52:53], s[52:53], vcc
    v_cmp_eq_u64 vcc, s[50:51], v[234:235]
    s_nop 0
    s_or_b64 vcc, vcc, s[84:85]
    s_and_b64 s[52:53], s[52:53], vcc
    v_cmp_eq_u64 vcc, s[50:51], v[238:239]
    s_nop 0
    s_or_b64 vcc, vcc, s[86:87]
    s_and_b64 s[52:53], s[52:53], vcc
    s_cmp_eq_u64 s[52:53], -1
    s_cbranch_scc1 L_aggok_48
    s_sleep 2
    s_branch L_agg_49
L_codeend:
    s_endpgm
.section .rodata,"a"
.p2align 6
.amdhsa_kernel gated_mix__ssm_conv_s5__glu_gated_swiglu__prompt_kernel
  .amdhsa_next_free_vgpr 512
  .amdhsa_next_free_sgpr 102
  .amdhsa_accum_offset 256
  .amdhsa_group_segment_fixed_size 0
  .amdhsa_kernarg_size 136
  .amdhsa_user_sgpr_count 2
  .amdhsa_user_sgpr_kernarg_segment_ptr 1
  .amdhsa_system_sgpr_workgroup_id_x 1
  .amdhsa_float_denorm_mode_32 3
.end_amdhsa_kernel
```
